```python
import torch

def _softmax(x, axis=-1):
    return torch.softmax(x, dim=axis)
def _gelu(x):
    return torch.nn.functional.gelu(x, approximate="tanh")
def _silu(x):
    return torch.nn.functional.silu(x)
def _sigmoid(x):
    return torch.sigmoid(x)
def _layernorm(x, axis=-1, eps=1e-5):
    m = x.mean(dim=axis, keepdim=True)
    v = x.var(dim=axis, keepdim=True, unbiased=False)
    return (x - m) / torch.sqrt(v + eps)
def _scatter_add(tgt, idx, src, axis=0):
    return tgt.clone().index_add_(axis, idx, src)
def _segment_sum(src, seg, n):
    out = torch.zeros((n,) + src.shape[1:], dtype=src.dtype)
    return out.index_add_(0, seg, src)
def _pad(x, pw):
    flat = tuple(v for pair in reversed(pw) for v in pair)
    return torch.nn.functional.pad(x, flat)

kernel_name = 'concat_heads__linear_kernel_hedgehog__ssm_conv_s4d__prompt'

def setup_inputs():

    _w = (lambda a: (lambda t: t.to(torch.bfloat16) if t.is_floating_point() else t)(torch.as_tensor(a)))
    def _A_setup():
        B, S, D, H = 1, 2048, 640, 32
        Dh = D // H
        return {
            "x": _w((lambda *s: torch.randn(*s, dtype=torch.bfloat16) * 0.4)(B, S, D)),
            "wqkv": _w((lambda *s: torch.randn(*s, dtype=torch.bfloat16) * 0.4)(D, 3 * D)),
            "w_phi": _w((lambda *s: torch.randn(*s, dtype=torch.bfloat16) * 0.4)(H, Dh, Dh) * (Dh ** -0.5)),
            "wo": _w((lambda *s: torch.randn(*s, dtype=torch.bfloat16) * 0.05)(D, D)),
        }
    _A_in = _A_setup()

    def _B_setup():
        Bsz, L, D, N = 1, 2048, 640, 192
        return {
            "u": _w((lambda *s: torch.randn(*s, dtype=torch.bfloat16) * 0.05)(Bsz, L, D)),
            "log_A_real": _w((lambda *s: torch.randn(*s, dtype=torch.bfloat16) * 3.2)(D, N) * 0.5),
            "A_imag": _w((lambda *s: torch.randn(*s, dtype=torch.bfloat16) * 0.2)(D, N) * 3.14),
            "C_real": _w((lambda *s: torch.randn(*s, dtype=torch.bfloat16) * 3.2)(D, N) / N ** 0.5),
            "C_imag": _w((lambda *s: torch.randn(*s, dtype=torch.bfloat16) * 3.2)(D, N) / N ** 0.5),
            "log_dt": _w((lambda *s: torch.randn(*s, dtype=torch.bfloat16) * 0.2)(D) * 0.5 - 4.0),
            "D_skip": _w((lambda *s: torch.randn(*s, dtype=torch.bfloat16) * 0.4)(D)),
        }
    _B_in = _B_setup()

    return {
        "A_x": _A_in["x"],
        "A_wqkv": _A_in["wqkv"],
        "A_w_phi": _A_in["w_phi"],
        "A_wo": _A_in["wo"],
        "B_u": _B_in["u"],
        "B_log_A_real": _B_in["log_A_real"],
        "B_A_imag": _B_in["A_imag"],
        "B_C_real": _B_in["C_real"],
        "B_C_imag": _B_in["C_imag"],
        "B_log_dt": _B_in["log_dt"],
        "B_D_skip": _B_in["D_skip"],
    }

def reference(A_x, A_wqkv, A_w_phi, A_wo, B_u, B_log_A_real, B_A_imag, B_C_real, B_C_imag, B_log_dt, B_D_skip):
    def _A_ref(x, wqkv, w_phi, wo):
        B, S, D = x.shape
        H = 32; Dh = D // H
        qkv = (lambda x, *d: x.permute(*d))((x @ wqkv).reshape(B, S, 3, H, Dh), 2, 0, 3, 1, 4)
        q, k, v = qkv[0], qkv[1], qkv[2]
        pq = torch.einsum("bhsd,hdf->bhsf", q, w_phi)
        pk = torch.einsum("bhsd,hdf->bhsf", k, w_phi)
        phi_q = torch.concatenate([_softmax(pq, axis=-1), _softmax(-pq, axis=-1)], axis=-1)
        phi_k = torch.concatenate([_softmax(pk, axis=-1), _softmax(-pk, axis=-1)], axis=-1)
        kv = torch.einsum("bhsf,bhsd->bhfd", phi_k, v)
        z  = torch.einsum("bhsf->bhf", phi_k)
        num = torch.einsum("bhqf,bhfd->bhqd", phi_q, kv)
        den = torch.einsum("bhqf,bhf->bhq", phi_q, z)[..., None] + 1e-6
        o = num / den
        return (lambda x, *d: x.permute(*d))(o, 0, 2, 1, 3).reshape(B, S, D) @ wo

    def _B_ref(u, log_A_real, A_imag, C_real, C_imag, log_dt, D_skip):
        L = u.shape[1]
        dt = torch.exp(log_dt)
        A = -torch.exp(log_A_real) + 1j * A_imag
        C = (C_real + 1j * C_imag) * dt[:, None]
        pos = (lambda x, dt: x.to(dt))(torch.arange(L), log_dt.dtype)
        P = torch.exp((A * dt[:, None])[:, :, None] * pos[None, None, :])
        K = 2.0 * torch.einsum("dn,dnl->dl", C, P).real
        L2 = 2 * L
        u_t = (lambda x, *d: x.permute(*d))(u, 0, 2, 1)
        Kf = (lambda x, *a, **k: torch.fft.rfft(x.float(), *a, **k))(K, L2)
        Uf = (lambda x, *a, **k: torch.fft.rfft(x.float(), *a, **k))(u_t, L2)
        y = (lambda x, *a, **k: torch.fft.irfft(x, *a, **k).to(torch.bfloat16))(Uf * Kf[None, :, :], L2)[:, :, :L]
        y = (lambda x, *d: x.permute(*d))(y, 0, 2, 1)
        return y + u * D_skip[None, None, :]

    a = _A_ref(A_x, A_wqkv, A_w_phi, A_wo)
    b = _B_ref(B_u, B_log_A_real, B_A_imag, B_C_real, B_C_imag, B_log_dt, B_D_skip)
    return torch.concatenate([a, b], axis=-1)
```

```asm
; @launch grid=(256,1,1) block=(256,1,1) lds=161728
.amdgcn_target "amdgcn-amd-amdhsa--gfx950"
.text
.p2align 12
.globl concat_heads__linear_kernel_hedgehog__ssm_conv_s4d__prompt_kernel
.p2align 8
.type concat_heads__linear_kernel_hedgehog__ssm_conv_s4d__prompt_kernel,@function
concat_heads__linear_kernel_hedgehog__ssm_conv_s4d__prompt_kernel:
L_begin:
    s_load_dwordx16 s[4:19], s[0:1], 0
    s_load_dwordx8 s[20:27], s[0:1], 64
    s_load_dwordx4 s[28:31], s[0:1], 96
    v_lshrrev_b32 v1, 6, v0
    s_lshr_b32 s34, s2, 3
    v_readfirstlane_b32 s32, v1
    s_and_b32 s33, s2, 7
    s_cmp_lt_u32 s34, 16
    s_cbranch_scc1 L_A
    s_cmp_ge_u32 s34, 32
    s_cbranch_scc1 L_exit
    s_getpc_b64 s[56:57]
    s_and_b32 s56, s56, 0xffffff00
    s_sub_u32 s43, s34, 16
    v_lshl_add_u32 v24, s43, 8, v0
    v_lshlrev_b32 v24, 4, v24
    global_load_dword v63, v24, s[56:57]
    v_and_b32 v1, 63, v0
    s_xor_b32 s48, s43, 12
    s_lshl4_add_u32 s48, s32, s48
    s_add_u32 s48, s48, 8
    s_lshr_b32 s60, s33, 2
    s_mul_i32 s60, s60, 40
    s_lshl_b32 s61, s33, 2
    s_lshr_b32 s61, 2204140384, s61
    s_and_b32 s61, s61, 15
    s_lshl2_add_u32 s60, s61, s60
    s_add_u32 s60, s60, s43
    s_lshl_b32 s61, s60, 2
    s_add_u32 s61, s61, s32
    s_mul_i32 s62, s61, 768
    v_mul_u32_u24 v2, 12, v1
    v_add_u32 v2, s62, v2
    s_lshl_b32 s61, s61, 2
    s_bitcmp0_b32 s33, 0
    s_cselect_b32 s44, 28, 24
    s_cmp_lt_u32 s34, s44
    s_cselect_b32 s3, 1, 0
WU_loop:
    s_min_u32 s47, s48, 179
    s_mul_i32 s46, s47, 911
    s_lshr_b32 s46, s46, 14
    s_mul_i32 s44, s46, 18
    s_sub_u32 s47, s47, s44
    s_and_b32 s44, s33, 1
    s_cmp_ge_u32 s47, 13
    s_addc_u32 s44, s44, 0
    s_mul_i32 s44, s44, 5
    s_add_u32 s44, s44, s47
    s_mul_i32 s45, s46, 1920
    s_add_u32 s44, s44, s45
    s_add_u32 s44, s44, 2
    s_and_b32 s45, s33, 6
    s_lshl2_add_u32 s45, s45, s47
    s_mulk_i32 s45, 640
    s_add_u32 s45, s45, s46
    s_cmp_lt_u32 s47, 8
    s_cselect_b32 s44, s45, s44
    s_cselect_b32 s45, 10, 30
    v_mul_u32_u24 v24, s45, v1
    v_add_lshl_u32 v24, v24, s44, 7
    s_waitcnt lgkmcnt(0)
    s_cselect_b64 s[52:53], s[4:5], s[6:7]
    s_cmp_eq_u32 s3, 1
    s_cbranch_scc1 WU_b
    s_cmp_lt_u32 s48, 36
    s_cbranch_scc1 WU_go
    s_waitcnt vmcnt(0)
WU_go:
    global_load_dword v63, v24, s[52:53]
    s_add_u32 s48, s48, 64
    s_cmp_lt_u32 s48, 180
    s_cbranch_scc1 WU_loop
    s_branch L_H
WU_b:
    s_load_dword s38, s[22:23], s61
    s_load_dword s39, s[24:25], s61
    global_load_dwordx3 v[8:10], v2, s[14:15]
    global_load_dwordx3 v[12:14], v2, s[16:17]
    global_load_dwordx3 v[16:18], v2, s[18:19]
    global_load_dwordx3 v[20:22], v2, s[20:21]
    s_barrier
    s_cmp_ge_u32 s48, 36
    s_cbranch_scc1 L_B
    global_load_dword v63, v24, s[52:53]
    s_branch L_B
L_A:
    s_lshr_b32 s36, s33, 1
    s_and_b32 s37, s33, 1
    s_and_b32 s38, s34, 3
    s_lshr_b32 s39, s34, 2
    s_lshl2_add_u32 s40, s36, s38
    s_lshl2_add_u32 s41, s37, s39
    v_and_b32 v1, 63, v0
    v_and_b32 v2, 15, v0
    v_bfe_u32 v3, v0, 4, 2
    v_bfe_u32 v4, v0, 2, 2
    v_and_b32 v5, 3, v0
    s_lshl_b32 s44, s40, 2
    s_add_u32 s44, s44, s32
    s_mul_i32 s44, s44, 40960
    v_lshrrev_b32 v6, 3, v1
    v_mul_u32_u24 v6, 1280, v6
    v_add_u32 v6, s44, v6
    v_and_b32 v7, 7, v1
    v_xor_b32 v7, v7, v3
    v_lshl_add_u32 v232, v7, 4, v6
    v_xor_b32 v233, 64, v232
    v_add_u32 v233, 9216, v233
    v_add_u32 v234, 18432, v232
    v_add_u32 v235, 18432, v233
    s_mul_i32 s78, s32, 5120
    s_mul_i32 s44, s41, 160
    v_lshl_add_u32 v9, v1, 4, s44
    v_mul_u32_u24 v8, 6554, v1
    s_movk_i32 s44, 3680
    s_movk_i32 s45, 15360
    v_add_u32 v6, 0, v8
    v_lshrrev_b32 v7, 16, v6
    v_mad_u32_u24 v12, v7, s44, v9
    v_bfe_u32 v7, v6, 18, 1
    v_bfe_u32 v6, v6, 19, 1
    v_sub_u32_e64 v6, v7, v6
    v_mad_i32_i24 v12, v6, s45, v12
    v_add_u32 v6, 419456, v8
    v_lshrrev_b32_e64 v7, 16, v6
    v_mad_u32_u24 v13, v7, s44, v9
    v_bfe_u32 v7, v6, 18, 1
    v_bfe_u32 v6, v6, 19, 1
    v_sub_u32_e64 v6, v7, v6
    v_mad_i32_i24 v13, v6, s45, v13
    v_add_u32 v6, 838912, v8
    v_lshrrev_b32_e64 v7, 16, v6
    v_mad_u32_u24 v14, v7, s44, v9
    v_bfe_u32 v7, v6, 18, 1
    v_bfe_u32 v6, v6, 19, 1
    v_sub_u32_e64 v6, v7, v6
    v_mad_i32_i24 v14, v6, s45, v14
    v_add_u32 v6, 1258368, v8
    v_lshrrev_b32_e64 v7, 16, v6
    v_mad_u32_u24 v15, v7, s44, v9
    v_bfe_u32 v7, v6, 18, 1
    v_bfe_u32 v6, v6, 19, 1
    v_sub_u32_e64 v6, v7, v6
    v_mad_i32_i24 v15, v6, s45, v15
    v_add_u32 v6, 1677824, v8
    v_lshrrev_b32_e64 v7, 16, v6
    v_mad_u32_u24 v16, v7, s44, v9
    v_bfe_u32 v7, v6, 18, 1
    v_bfe_u32 v6, v6, 19, 1
    v_sub_u32_e64 v6, v7, v6
    v_mad_i32_i24 v16, v6, s45, v16
    v_add_u32 v16, 4096, v16
    s_lshr_b32 s44, s32, 1
    s_mul_i32 s46, s44, 122880
    s_and_b32 s44, s32, 1
    s_add_u32 s44, s44, 1
    s_mul_i32 s44, s44, 1280
    s_add_u32 s46, s46, s44
    s_mul_i32 s48, s32, 5120
    s_mov_b32 s54, 2621440
    s_mov_b32 s55, 0x20000
    s_mov_b32 s58, 2457600
    s_mov_b32 s59, 0x20000
    s_waitcnt lgkmcnt(0)
    s_mov_b32 s52, s4
    s_and_b32 s53, s5, 0xffff
    s_mov_b32 s56, s6
    s_and_b32 s57, s7, 0xffff
    s_add_u32 m0, s78, 51712
    s_movk_i32 s74, 0
    buffer_load_dwordx4 v232, s[52:55], s74 offen offset:0 lds
    buffer_load_dwordx4 v233, s[52:55], s74 offen offset:1024 lds
    buffer_load_dwordx4 v234, s[52:55], s74 offen offset:2048 lds
    buffer_load_dwordx4 v235, s[52:55], s74 offen offset:3072 lds
    s_add_u32 s47, s46, 0
    s_add_u32 m0, s48, 10752
    s_nop 0
    buffer_load_dwordx4 v12, s[56:59], s47 offen offset:0 lds
    buffer_load_dwordx4 v13, s[56:59], s47 offen offset:1024 lds
    buffer_load_dwordx4 v14, s[56:59], s47 offen offset:2048 lds
    buffer_load_dwordx4 v15, s[56:59], s47 offen offset:3072 lds
    s_add_u32 m0, s48, 14848
    s_nop 0
    buffer_load_dwordx4 v16, s[56:59], s47 offen offset:0 lds
    v_lshrrev_b32 v6, 1, v2
    v_xor_b32 v6, v6, v3
    v_lshlrev_b32 v6, 4, v6
    v_lshl_add_u32 v6, v2, 7, v6
    s_add_u32 s44, s78, 51712
    v_add_u32 v10, s44, v6
    v_xor_b32 v11, 64, v10
    v_lshrrev_b32 v6, 1, v3
    v_lshlrev_b32 v6, 2, v6
    v_and_b32 v7, 1, v3
    v_add_u32 v6, v6, v7
    v_lshl_add_u32 v6, v6, 2, v4
    v_lshl_add_u32 v6, v6, 2, v5
    v_mul_u32_u24_e64 v17, 40, v6
    v_add_u32 v18, 0x10000, v17
    v_add_u32 v19, 0x20000, v17
    s_mov_b32 s68, s8
    s_and_b32 s69, s9, 0xffff
    s_mov_b32 s70, 25600
    s_mov_b32 s71, 0x20000
    v_lshlrev_b32 v31, 4, v0
    s_mul_i32 s75, s41, 3200
    s_lshl_b32 s43, s32, 10
    v_mov_b32 v8, 0
    v_mov_b32 v9, 0
    v_lshlrev_b32 v7, 3, v0
    ds_write_b64 v7, v[8:9] offset:0
    ds_write_b64 v7, v[8:9] offset:256
    s_mul_i32 s79, s32, 122880
    v_mul_u32_u24 v6, 800, v3
    v_mul_u32_u24 v7, 40, v4
    v_add_u32 v6, v6, v7
    v_add_u32 v6, 2304, v6
    v_cmp_eq_u32 vcc, v5, v3
    s_nop 1
    v_cndmask_b32 v29, 0, v6, vcc
    v_cmp_eq_u32 vcc, v4, v3
    v_mul_u32_u24 v6, 2112, v3
    v_lshl_add_u32 v6, v5, 4, v6
    v_add_u32 v6, 2304, v6
    v_bfe_u32 v7, v1, 5, 1
    v_xor_b32 v7, 1, v7
    v_lshlrev_b32 v7, 7, v7
    v_cndmask_b32_e64 v27, v7, v6, vcc
    v_accvgpr_write_b32 a170, 0
    v_accvgpr_write_b32 a171, 0
    v_accvgpr_write_b32 a182, 0
    v_accvgpr_write_b32 a183, 0
    v_accvgpr_write_b32 a194, 0
    v_accvgpr_write_b32 a195, 0
    v_accvgpr_write_b32 a206, 0
    v_accvgpr_write_b32 a207, 0
    v_accvgpr_write_b32 a218, 0
    v_accvgpr_write_b32 a219, 0
    s_mov_b32 s72, 0x3fb8aa3b
    s_mov_b32 s73, 0xbfb8aa3b
    s_add_u32 s49, s41, s37
    s_mov_b32 s51, s41
    s_mov_b32 s60, s30
    s_and_b32 s61, s31, 0xffff
    s_mov_b32 s62, 4194304
    s_mov_b32 s63, 0x20000
    s_mov_b32 s64, s10
    s_and_b32 s65, s11, 0xffff
    s_mov_b32 s66, 819200
    s_mov_b32 s67, 0x20000
    s_mov_b32 s12, s28
    s_and_b32 s13, s29, 0xffff
    s_mov_b32 s14, 256
    s_mov_b32 s15, 0x20000
    v_lshrrev_b32 v6, 3, v1
    v_mul_u32_u24 v6, 1280, v6
    v_and_b32 v7, 7, v1
    v_lshlrev_b32 v8, 1, v3
    v_xor_b32_e64 v7, v7, v8
    v_lshl_add_u32 v20, v7, 4, v6
    s_lshl_b32 s44, s49, 7
    v_add_u32 v20, s44, v20
    s_lshl_b32 s35, s51, 1
    s_xor_b32 s35, s35, s32
    s_mul_i32 s48, s32, 5120
    s_lshl_b32 s44, s32, 5
    v_lshl_add_u32 v6, v3, 7, v2
    v_add_u32 v6, s44, v6
    v_mul_u32_u24_e64 v21, 48, v6
    v_add_u32 v21, 92672, v21
    v_mul_u32_u24 v22, 80, v6
    v_add_u32 v22, 117248, v22
    v_lshlrev_b32 v6, 3, v3
    v_lshl_add_u32 v6, v4, 1, v6
    s_lshl_b32 s44, s32, 7
    v_add_u32 v6, s44, v6
    v_mul_u32_u24 v23, 48, v6
    v_lshl_add_u32 v23, v5, 3, v23
    v_add_u32 v23, 92672, v23
    v_mul_u32_u24 v24, 80, v6
    v_lshl_add_u32 v24, v5, 3, v24
    v_add_u32 v24, 117248, v24
    v_mov_b32 v6, 1073741824
    v_lshlrev_b32 v25, 4, v1
    v_cmp_gt_u32 vcc, 32, v1
    v_lshl_add_u32 v7, v3, 3, v2
    v_lshlrev_b32 v7, 4, v7
    v_cndmask_b32 v28, v6, v25, vcc
    v_cmp_gt_u32 vcc, 8, v2
    s_lshl2_add_u32 s44, s38, s39
    s_lshl2_add_u32 s44, s44, s32
    s_mul_i32 s45, s33, 524288
    s_mul_i32 s76, s44, 2176
    s_add_u32 s76, s76, s45
    v_cndmask_b32 v30, v6, v7, vcc
    v_mov_b32 v26, 0
    v_mov_b32 v154, 0
    v_mov_b32 v155, 0
    v_mov_b32 v166, 0
    v_mov_b32 v167, 0
    s_mov_b64 exec, 0
    s_cmp_eq_u32 s32, 0
    s_cbranch_scc1 WA_P0
    s_cmp_eq_u32 s32, 1
    s_cbranch_scc1 WA_P1
    s_cmp_eq_u32 s32, 2
    s_cbranch_scc1 WA_P2
    s_branch WA_P3
WA_R:
    s_mov_b64 exec, -1
    s_add_u32 m0, s78, 72192
    s_movk_i32 s74, 128
    s_nop 0
    buffer_load_dwordx4 v232, s[52:55], s74 offen offset:0 lds
    buffer_load_dwordx4 v233, s[52:55], s74 offen offset:1024 lds
    buffer_load_dwordx4 v234, s[52:55], s74 offen offset:2048 lds
    buffer_load_dwordx4 v235, s[52:55], s74 offen offset:3072 lds
    s_add_u32 s47, s46, 245760
    s_add_u32 m0, s48, 31232
    s_nop 0
    buffer_load_dwordx4 v12, s[56:59], s47 offen offset:0 lds
    buffer_load_dwordx4 v13, s[56:59], s47 offen offset:1024 lds
    buffer_load_dwordx4 v14, s[56:59], s47 offen offset:2048 lds
    buffer_load_dwordx4 v15, s[56:59], s47 offen offset:3072 lds
    s_add_u32 m0, s48, 35328
    s_nop 0
    buffer_load_dwordx4 v16, s[56:59], s47 offen offset:0 lds
    s_waitcnt vmcnt(9)
    s_barrier
    ds_read_b128 a[0:3], v10 offset:0
    ds_read_b128 a[80:83], v10 offset:2048
    ds_read_b128 a[4:7], v11 offset:0
    ds_read_b128 a[84:87], v11 offset:2048
    ds_read_b64_tr_b16 v[112:113], v17 offset:10752
    ds_read_b64_tr_b16 v[114:115], v17 offset:12032
    ds_read_b64_tr_b16 v[116:117], v17 offset:10760
    ds_read_b64_tr_b16 v[118:119], v17 offset:12040
    ds_read_b64_tr_b16 v[120:121], v17 offset:10768
    ds_read_b64_tr_b16 v[122:123], v17 offset:12048
    ds_read_b64_tr_b16 v[124:125], v17 offset:10776
    ds_read_b64_tr_b16 v[126:127], v17 offset:12056
    ds_read_b64_tr_b16 v[128:129], v17 offset:10784
    ds_read_b64_tr_b16 v[130:131], v17 offset:12064
    ds_read_b64_tr_b16 v[132:133], v17 offset:15872
    ds_read_b64_tr_b16 v[134:135], v17 offset:17152
    s_waitcnt lgkmcnt(8)
    v_mfma_f32_16x16x32_bf16 v[32:35], v[112:115], a[0:3], 0
    ds_read_b64_tr_b16 v[136:137], v17 offset:15880
    s_add_u32 m0, s78, 51712
    v_mfma_f32_16x16x32_bf16 v[52:55], v[112:115], a[80:83], 0
    ds_read_b64_tr_b16 v[138:139], v17 offset:17160
    v_mfma_f32_16x16x32_bf16 v[36:39], v[116:119], a[0:3], 0
    ds_read_b64_tr_b16 v[140:141], v17 offset:15888
    s_movk_i32 s74, 256
    v_mfma_f32_16x16x32_bf16 v[56:59], v[116:119], a[80:83], 0
    ds_read_b64_tr_b16 v[142:143], v17 offset:17168
    s_waitcnt lgkmcnt(8)
    v_mfma_f32_16x16x32_bf16 v[40:43], v[120:123], a[0:3], 0
    ds_read_b64_tr_b16 v[112:113], v17 offset:15896
    buffer_load_dwordx4 v232, s[52:55], s74 offen offset:0 lds
    v_mfma_f32_16x16x32_bf16 v[60:63], v[120:123], a[80:83], 0
    ds_read_b64_tr_b16 v[114:115], v17 offset:17176
    v_mfma_f32_16x16x32_bf16 v[44:47], v[124:127], a[0:3], 0
    ds_read_b64_tr_b16 v[116:117], v17 offset:15904
    buffer_load_dwordx4 v233, s[52:55], s74 offen offset:1024 lds
    v_mfma_f32_16x16x32_bf16 v[64:67], v[124:127], a[80:83], 0
    ds_read_b64_tr_b16 v[118:119], v17 offset:17184
    s_waitcnt lgkmcnt(8)
    v_mfma_f32_16x16x32_bf16 v[48:51], v[128:131], a[0:3], 0
    ds_read_b64_tr_b16 v[120:121], v17 offset:20992
    v_mfma_f32_16x16x32_bf16 v[68:71], v[128:131], a[80:83], 0
    ds_read_b64_tr_b16 v[122:123], v17 offset:22272
    v_mfma_f32_16x16x32_bf16 v[72:75], v[132:135], a[0:3], 0
    ds_read_b64_tr_b16 v[124:125], v17 offset:21000
    buffer_load_dwordx4 v234, s[52:55], s74 offen offset:2048 lds
    v_mfma_f32_16x16x32_bf16 v[92:95], v[132:135], a[80:83], 0
    ds_read_b64_tr_b16 v[126:127], v17 offset:22280
    s_waitcnt lgkmcnt(8)
    v_mfma_f32_16x16x32_bf16 v[76:79], v[136:139], a[0:3], 0
    ds_read_b64_tr_b16 v[128:129], v17 offset:21008
    buffer_load_dwordx4 v235, s[52:55], s74 offen offset:3072 lds
    v_mfma_f32_16x16x32_bf16 v[96:99], v[136:139], a[80:83], 0
    ds_read_b64_tr_b16 v[130:131], v17 offset:22288
    v_mfma_f32_16x16x32_bf16 v[80:83], v[140:143], a[0:3], 0
    ds_read_b64_tr_b16 v[132:133], v17 offset:21016
    s_add_u32 s47, s46, 491520
    v_mfma_f32_16x16x32_bf16 v[100:103], v[140:143], a[80:83], 0
    ds_read_b64_tr_b16 v[134:135], v17 offset:22296
    s_waitcnt lgkmcnt(8)
    v_mfma_f32_16x16x32_bf16 v[84:87], v[112:115], a[0:3], 0
    ds_read_b64_tr_b16 v[136:137], v17 offset:21024
    v_mfma_f32_16x16x32_bf16 v[104:107], v[112:115], a[80:83], 0
    ds_read_b64_tr_b16 v[138:139], v17 offset:22304
    v_mfma_f32_16x16x32_bf16 v[88:91], v[116:119], a[0:3], 0
    ds_read_b64_tr_b16 v[140:141], v17 offset:26112
    s_add_u32 m0, s48, 96768
    v_mfma_f32_16x16x32_bf16 v[108:111], v[116:119], a[80:83], 0
    ds_read_b64_tr_b16 v[142:143], v17 offset:27392
    s_waitcnt lgkmcnt(8)
    v_mfma_f32_16x16x32_bf16 v[32:35], v[120:123], a[4:7], v[32:35]
    ds_read_b64_tr_b16 v[112:113], v17 offset:26120
    buffer_load_dwordx4 v12, s[56:59], s47 offen offset:0 lds
    v_mfma_f32_16x16x32_bf16 v[52:55], v[120:123], a[84:87], v[52:55]
    ds_read_b64_tr_b16 v[114:115], v17 offset:27400
    v_mfma_f32_16x16x32_bf16 v[36:39], v[124:127], a[4:7], v[36:39]
    ds_read_b64_tr_b16 v[116:117], v17 offset:26128
    buffer_load_dwordx4 v13, s[56:59], s47 offen offset:1024 lds
    v_mfma_f32_16x16x32_bf16 v[56:59], v[124:127], a[84:87], v[56:59]
    ds_read_b64_tr_b16 v[118:119], v17 offset:27408
    s_waitcnt lgkmcnt(8)
    v_mfma_f32_16x16x32_bf16 v[40:43], v[128:131], a[4:7], v[40:43]
    ds_read_b64_tr_b16 v[120:121], v17 offset:26136
    buffer_load_dwordx4 v14, s[56:59], s47 offen offset:2048 lds
    v_mfma_f32_16x16x32_bf16 v[60:63], v[128:131], a[84:87], v[60:63]
    ds_read_b64_tr_b16 v[122:123], v17 offset:27416
    v_mfma_f32_16x16x32_bf16 v[44:47], v[132:135], a[4:7], v[44:47]
    ds_read_b64_tr_b16 v[124:125], v17 offset:26144
    v_mfma_f32_16x16x32_bf16 v[64:67], v[132:135], a[84:87], v[64:67]
    ds_read_b64_tr_b16 v[126:127], v17 offset:27424
    s_waitcnt lgkmcnt(8)
    v_mfma_f32_16x16x32_bf16 v[48:51], v[136:139], a[4:7], v[48:51]
    s_waitcnt vmcnt(7)
    s_barrier
    ds_read_b64_tr_b16 v[128:129], v17 offset:31232
    v_mfma_f32_16x16x32_bf16 v[68:71], v[136:139], a[84:87], v[68:71]
    ds_read_b64_tr_b16 v[130:131], v17 offset:32512
    ds_read_b128 a[8:11], v10 offset:20480
    v_mfma_f32_16x16x32_bf16 v[72:75], v[140:143], a[4:7], v[72:75]
    ds_read_b64_tr_b16 v[132:133], v17 offset:31240
    ds_read_b128 a[88:91], v10 offset:22528
    v_mfma_f32_16x16x32_bf16 v[92:95], v[140:143], a[84:87], v[92:95]
    ds_read_b64_tr_b16 v[134:135], v17 offset:32520
    s_waitcnt lgkmcnt(10)
    v_mfma_f32_16x16x32_bf16 v[76:79], v[112:115], a[4:7], v[76:79]
    ds_read_b64_tr_b16 v[136:137], v17 offset:31248
    buffer_load_dwordx4 v15, s[56:59], s47 offen offset:3072 lds
    v_mfma_f32_16x16x32_bf16 v[96:99], v[112:115], a[84:87], v[96:99]
    ds_read_b64_tr_b16 v[138:139], v17 offset:32528
    ds_read_b128 a[12:15], v11 offset:20480
    v_mfma_f32_16x16x32_bf16 v[80:83], v[116:119], a[4:7], v[80:83]
    ds_read_b64_tr_b16 v[140:141], v17 offset:31256
    ds_read_b128 a[92:95], v11 offset:22528
    v_mfma_f32_16x16x32_bf16 v[100:103], v[116:119], a[84:87], v[100:103]
    ds_read_b64_tr_b16 v[142:143], v17 offset:32536
    s_waitcnt lgkmcnt(12)
    v_mfma_f32_16x16x32_bf16 v[84:87], v[120:123], a[4:7], v[84:87]
    ds_read_b64_tr_b16 v[112:113], v17 offset:31264
    s_add_u32 m0, s48, 100864
    v_mfma_f32_16x16x32_bf16 v[104:107], v[120:123], a[84:87], v[104:107]
    ds_read_b64_tr_b16 v[114:115], v17 offset:32544
    buffer_load_dwordx4 v16, s[56:59], s47 offen offset:0 lds
    v_mfma_f32_16x16x32_bf16 v[88:91], v[124:127], a[4:7], v[88:91]
    ds_read_b64_tr_b16 v[116:117], v17 offset:36352
    v_mfma_f32_16x16x32_bf16 v[108:111], v[124:127], a[84:87], v[108:111]
    ds_read_b64_tr_b16 v[118:119], v17 offset:37632
    s_waitcnt lgkmcnt(10)
    s_waitcnt lgkmcnt(5)
    v_mfma_f32_16x16x32_bf16 v[32:35], v[128:131], a[8:11], v[32:35]
    ds_read_b64_tr_b16 v[120:121], v17 offset:36360
    s_add_u32 m0, s78, 72192
    v_mfma_f32_16x16x32_bf16 v[52:55], v[128:131], a[88:91], v[52:55]
    ds_read_b64_tr_b16 v[122:123], v17 offset:37640
    v_mfma_f32_16x16x32_bf16 v[36:39], v[132:135], a[8:11], v[36:39]
    ds_read_b64_tr_b16 v[124:125], v17 offset:36368
    s_movk_i32 s74, 384
    v_mfma_f32_16x16x32_bf16 v[56:59], v[132:135], a[88:91], v[56:59]
    ds_read_b64_tr_b16 v[126:127], v17 offset:37648
    s_waitcnt lgkmcnt(8)
    v_mfma_f32_16x16x32_bf16 v[40:43], v[136:139], a[8:11], v[40:43]
    ds_read_b64_tr_b16 v[128:129], v17 offset:36376
    buffer_load_dwordx4 v232, s[52:55], s74 offen offset:0 lds
    v_mfma_f32_16x16x32_bf16 v[60:63], v[136:139], a[88:91], v[60:63]
    ds_read_b64_tr_b16 v[130:131], v17 offset:37656
    v_mfma_f32_16x16x32_bf16 v[44:47], v[140:143], a[8:11], v[44:47]
    ds_read_b64_tr_b16 v[132:133], v17 offset:36384
    buffer_load_dwordx4 v233, s[52:55], s74 offen offset:1024 lds
    v_mfma_f32_16x16x32_bf16 v[64:67], v[140:143], a[88:91], v[64:67]
    ds_read_b64_tr_b16 v[134:135], v17 offset:37664
    s_waitcnt lgkmcnt(8)
    v_mfma_f32_16x16x32_bf16 v[48:51], v[112:115], a[8:11], v[48:51]
    ds_read_b64_tr_b16 v[136:137], v17 offset:41472
    v_mfma_f32_16x16x32_bf16 v[68:71], v[112:115], a[88:91], v[68:71]
    ds_read_b64_tr_b16 v[138:139], v17 offset:42752
    v_mfma_f32_16x16x32_bf16 v[72:75], v[116:119], a[8:11], v[72:75]
    ds_read_b64_tr_b16 v[140:141], v17 offset:41480
    buffer_load_dwordx4 v234, s[52:55], s74 offen offset:2048 lds
    v_mfma_f32_16x16x32_bf16 v[92:95], v[116:119], a[88:91], v[92:95]
    ds_read_b64_tr_b16 v[142:143], v17 offset:42760
    s_waitcnt lgkmcnt(8)
    v_mfma_f32_16x16x32_bf16 v[76:79], v[120:123], a[8:11], v[76:79]
    ds_read_b64_tr_b16 v[112:113], v17 offset:41488
    buffer_load_dwordx4 v235, s[52:55], s74 offen offset:3072 lds
    v_mfma_f32_16x16x32_bf16 v[96:99], v[120:123], a[88:91], v[96:99]
    ds_read_b64_tr_b16 v[114:115], v17 offset:42768
    v_mfma_f32_16x16x32_bf16 v[80:83], v[124:127], a[8:11], v[80:83]
    ds_read_b64_tr_b16 v[116:117], v17 offset:41496
    s_add_u32 s47, s46, 737280
    v_mfma_f32_16x16x32_bf16 v[100:103], v[124:127], a[88:91], v[100:103]
    ds_read_b64_tr_b16 v[118:119], v17 offset:42776
    s_waitcnt lgkmcnt(8)
    v_mfma_f32_16x16x32_bf16 v[84:87], v[128:131], a[8:11], v[84:87]
    ds_read_b64_tr_b16 v[120:121], v17 offset:41504
    v_mfma_f32_16x16x32_bf16 v[104:107], v[128:131], a[88:91], v[104:107]
    ds_read_b64_tr_b16 v[122:123], v17 offset:42784
    v_mfma_f32_16x16x32_bf16 v[88:91], v[132:135], a[8:11], v[88:91]
    ds_read_b64_tr_b16 v[124:125], v17 offset:46592
    s_add_u32 m0, s48, 117248
    v_mfma_f32_16x16x32_bf16 v[108:111], v[132:135], a[88:91], v[108:111]
    ds_read_b64_tr_b16 v[126:127], v17 offset:47872
    s_waitcnt lgkmcnt(8)
    v_mfma_f32_16x16x32_bf16 v[32:35], v[136:139], a[12:15], v[32:35]
    ds_read_b64_tr_b16 v[128:129], v17 offset:46600
    buffer_load_dwordx4 v12, s[56:59], s47 offen offset:0 lds
WA_P0:
    s_cbranch_execz WA_P4
    s_nop 0
    v_mfma_f32_16x16x32_bf16 v[52:55], v[136:139], a[92:95], v[52:55]
    ds_read_b64_tr_b16 v[130:131], v17 offset:47880
    v_mfma_f32_16x16x32_bf16 v[36:39], v[140:143], a[12:15], v[36:39]
    ds_read_b64_tr_b16 v[132:133], v17 offset:46608
    buffer_load_dwordx4 v13, s[56:59], s47 offen offset:1024 lds
    v_mfma_f32_16x16x32_bf16 v[56:59], v[140:143], a[92:95], v[56:59]
    ds_read_b64_tr_b16 v[134:135], v17 offset:47888
    s_waitcnt lgkmcnt(8)
    v_mfma_f32_16x16x32_bf16 v[40:43], v[112:115], a[12:15], v[40:43]
    ds_read_b64_tr_b16 v[136:137], v17 offset:46616
    buffer_load_dwordx4 v14, s[56:59], s47 offen offset:2048 lds
    v_mfma_f32_16x16x32_bf16 v[60:63], v[112:115], a[92:95], v[60:63]
    ds_read_b64_tr_b16 v[138:139], v17 offset:47896
    v_mfma_f32_16x16x32_bf16 v[44:47], v[116:119], a[12:15], v[44:47]
    ds_read_b64_tr_b16 v[140:141], v17 offset:46624
    v_mfma_f32_16x16x32_bf16 v[64:67], v[116:119], a[92:95], v[64:67]
    ds_read_b64_tr_b16 v[142:143], v17 offset:47904
    s_waitcnt lgkmcnt(8)
    v_mfma_f32_16x16x32_bf16 v[48:51], v[120:123], a[12:15], v[48:51]
    s_waitcnt vmcnt(7)
    s_barrier
    ds_read_b64_tr_b16 v[112:113], v18 offset:31232
    v_mfma_f32_16x16x32_bf16 v[68:71], v[120:123], a[92:95], v[68:71]
    ds_read_b64_tr_b16 v[114:115], v18 offset:32512
    ds_read_b128 a[16:19], v10 offset:0
    v_mfma_f32_16x16x32_bf16 v[72:75], v[124:127], a[12:15], v[72:75]
    ds_read_b64_tr_b16 v[116:117], v18 offset:31240
    ds_read_b128 a[96:99], v10 offset:2048
    v_mfma_f32_16x16x32_bf16 v[92:95], v[124:127], a[92:95], v[92:95]
    ds_read_b64_tr_b16 v[118:119], v18 offset:32520
    s_waitcnt lgkmcnt(10)
    v_mfma_f32_16x16x32_bf16 v[76:79], v[128:131], a[12:15], v[76:79]
    ds_read_b64_tr_b16 v[120:121], v18 offset:31248
    buffer_load_dwordx4 v15, s[56:59], s47 offen offset:3072 lds
    v_mfma_f32_16x16x32_bf16 v[96:99], v[128:131], a[92:95], v[96:99]
    ds_read_b64_tr_b16 v[122:123], v18 offset:32528
    ds_read_b128 a[20:23], v11 offset:0
    v_mfma_f32_16x16x32_bf16 v[80:83], v[132:135], a[12:15], v[80:83]
    ds_read_b64_tr_b16 v[124:125], v18 offset:31256
    ds_read_b128 a[100:103], v11 offset:2048
    v_mfma_f32_16x16x32_bf16 v[100:103], v[132:135], a[92:95], v[100:103]
    ds_read_b64_tr_b16 v[126:127], v18 offset:32536
    s_waitcnt lgkmcnt(12)
    v_mfma_f32_16x16x32_bf16 v[84:87], v[136:139], a[12:15], v[84:87]
    ds_read_b64_tr_b16 v[128:129], v18 offset:31264
    s_add_u32 m0, s48, 121344
    v_mfma_f32_16x16x32_bf16 v[104:107], v[136:139], a[92:95], v[104:107]
    ds_read_b64_tr_b16 v[130:131], v18 offset:32544
    buffer_load_dwordx4 v16, s[56:59], s47 offen offset:0 lds
    v_mfma_f32_16x16x32_bf16 v[88:91], v[140:143], a[12:15], v[88:91]
    ds_read_b64_tr_b16 v[132:133], v18 offset:36352
    v_mfma_f32_16x16x32_bf16 v[108:111], v[140:143], a[92:95], v[108:111]
    ds_read_b64_tr_b16 v[134:135], v18 offset:37632
    s_waitcnt lgkmcnt(10)
    s_waitcnt lgkmcnt(5)
    v_mfma_f32_16x16x32_bf16 v[32:35], v[112:115], a[16:19], v[32:35]
    ds_read_b64_tr_b16 v[136:137], v18 offset:36360
    s_add_u32 m0, s43, 2304
    v_mfma_f32_16x16x32_bf16 v[52:55], v[112:115], a[96:99], v[52:55]
    ds_read_b64_tr_b16 v[138:139], v18 offset:37640
    v_mfma_f32_16x16x32_bf16 v[36:39], v[116:119], a[16:19], v[36:39]
    ds_read_b64_tr_b16 v[140:141], v18 offset:36368
    buffer_load_dwordx4 v31, s[68:71], s75 offen lds
    v_mfma_f32_16x16x32_bf16 v[56:59], v[116:119], a[96:99], v[56:59]
    ds_read_b64_tr_b16 v[142:143], v18 offset:37648
    s_waitcnt lgkmcnt(8)
    v_mfma_f32_16x16x32_bf16 v[40:43], v[120:123], a[16:19], v[40:43]
    ds_read_b64_tr_b16 v[112:113], v18 offset:36376
    s_add_u32 m0, s78, 51712
    v_mfma_f32_16x16x32_bf16 v[60:63], v[120:123], a[96:99], v[60:63]
    ds_read_b64_tr_b16 v[114:115], v18 offset:37656
    v_mfma_f32_16x16x32_bf16 v[44:47], v[124:127], a[16:19], v[44:47]
    ds_read_b64_tr_b16 v[116:117], v18 offset:36384
    s_movk_i32 s74, 512
    v_mfma_f32_16x16x32_bf16 v[64:67], v[124:127], a[96:99], v[64:67]
    ds_read_b64_tr_b16 v[118:119], v18 offset:37664
    s_waitcnt lgkmcnt(8)
    v_mfma_f32_16x16x32_bf16 v[48:51], v[128:131], a[16:19], v[48:51]
    ds_read_b64_tr_b16 v[120:121], v18 offset:41472
    buffer_load_dwordx4 v232, s[52:55], s74 offen offset:0 lds
    v_mfma_f32_16x16x32_bf16 v[68:71], v[128:131], a[96:99], v[68:71]
    ds_read_b64_tr_b16 v[122:123], v18 offset:42752
    v_mfma_f32_16x16x32_bf16 v[72:75], v[132:135], a[16:19], v[72:75]
    ds_read_b64_tr_b16 v[124:125], v18 offset:41480
    buffer_load_dwordx4 v233, s[52:55], s74 offen offset:1024 lds
    v_mfma_f32_16x16x32_bf16 v[92:95], v[132:135], a[96:99], v[92:95]
    ds_read_b64_tr_b16 v[126:127], v18 offset:42760
    s_waitcnt lgkmcnt(8)
    v_mfma_f32_16x16x32_bf16 v[76:79], v[136:139], a[16:19], v[76:79]
    ds_read_b64_tr_b16 v[128:129], v18 offset:41488
    buffer_load_dwordx4 v234, s[52:55], s74 offen offset:2048 lds
    v_mfma_f32_16x16x32_bf16 v[96:99], v[136:139], a[96:99], v[96:99]
    ds_read_b64_tr_b16 v[130:131], v18 offset:42768
    v_mfma_f32_16x16x32_bf16 v[80:83], v[140:143], a[16:19], v[80:83]
    ds_read_b64_tr_b16 v[132:133], v18 offset:41496
    buffer_load_dwordx4 v235, s[52:55], s74 offen offset:3072 lds
    v_mfma_f32_16x16x32_bf16 v[100:103], v[140:143], a[96:99], v[100:103]
    ds_read_b64_tr_b16 v[134:135], v18 offset:42776
    s_waitcnt lgkmcnt(8)
    v_mfma_f32_16x16x32_bf16 v[84:87], v[112:115], a[16:19], v[84:87]
    ds_read_b64_tr_b16 v[136:137], v18 offset:41504
    v_mfma_f32_16x16x32_bf16 v[104:107], v[112:115], a[96:99], v[104:107]
    ds_read_b64_tr_b16 v[138:139], v18 offset:42784
    v_mfma_f32_16x16x32_bf16 v[88:91], v[116:119], a[16:19], v[88:91]
    ds_read_b64_tr_b16 v[140:141], v18 offset:46592
    s_add_u32 s47, s46, 983040
    v_mfma_f32_16x16x32_bf16 v[108:111], v[116:119], a[96:99], v[108:111]
    ds_read_b64_tr_b16 v[142:143], v18 offset:47872
    s_waitcnt lgkmcnt(8)
    v_mfma_f32_16x16x32_bf16 v[32:35], v[120:123], a[20:23], v[32:35]
    ds_read_b64_tr_b16 v[112:113], v18 offset:46600
    s_add_u32 m0, s48, 137728
    v_mfma_f32_16x16x32_bf16 v[52:55], v[120:123], a[100:103], v[52:55]
    ds_read_b64_tr_b16 v[114:115], v18 offset:47880
    v_mfma_f32_16x16x32_bf16 v[36:39], v[124:127], a[20:23], v[36:39]
    ds_read_b64_tr_b16 v[116:117], v18 offset:46608
    buffer_load_dwordx4 v12, s[56:59], s47 offen offset:0 lds
    v_mfma_f32_16x16x32_bf16 v[56:59], v[124:127], a[100:103], v[56:59]
    ds_read_b64_tr_b16 v[118:119], v18 offset:47888
    s_waitcnt lgkmcnt(8)
    v_mfma_f32_16x16x32_bf16 v[40:43], v[128:131], a[20:23], v[40:43]
    ds_read_b64_tr_b16 v[120:121], v18 offset:46616
    buffer_load_dwordx4 v13, s[56:59], s47 offen offset:1024 lds
    v_mfma_f32_16x16x32_bf16 v[60:63], v[128:131], a[100:103], v[60:63]
    ds_read_b64_tr_b16 v[122:123], v18 offset:47896
    v_mfma_f32_16x16x32_bf16 v[44:47], v[132:135], a[20:23], v[44:47]
    ds_read_b64_tr_b16 v[124:125], v18 offset:46624
    buffer_load_dwordx4 v14, s[56:59], s47 offen offset:2048 lds
    v_mfma_f32_16x16x32_bf16 v[64:67], v[132:135], a[100:103], v[64:67]
    ds_read_b64_tr_b16 v[126:127], v18 offset:47904
    s_waitcnt lgkmcnt(8)
    v_mfma_f32_16x16x32_bf16 v[48:51], v[136:139], a[20:23], v[48:51]
    s_waitcnt vmcnt(8)
    s_barrier
    ds_read_b64_tr_b16 v[128:129], v18 offset:51712
    v_mfma_f32_16x16x32_bf16 v[68:71], v[136:139], a[100:103], v[68:71]
    ds_read_b64_tr_b16 v[130:131], v18 offset:52992
    ds_read_b128 a[24:27], v10 offset:20480
    v_mfma_f32_16x16x32_bf16 v[72:75], v[140:143], a[20:23], v[72:75]
    ds_read_b64_tr_b16 v[132:133], v18 offset:51720
    ds_read_b128 a[104:107], v10 offset:22528
    v_mfma_f32_16x16x32_bf16 v[92:95], v[140:143], a[100:103], v[92:95]
    ds_read_b64_tr_b16 v[134:135], v18 offset:53000
    s_waitcnt lgkmcnt(10)
    v_mfma_f32_16x16x32_bf16 v[76:79], v[112:115], a[20:23], v[76:79]
    ds_read_b64_tr_b16 v[136:137], v18 offset:51728
    buffer_load_dwordx4 v15, s[56:59], s47 offen offset:3072 lds
    v_mfma_f32_16x16x32_bf16 v[96:99], v[112:115], a[100:103], v[96:99]
    ds_read_b64_tr_b16 v[138:139], v18 offset:53008
    ds_read_b128 a[28:31], v11 offset:20480
    v_mfma_f32_16x16x32_bf16 v[80:83], v[116:119], a[20:23], v[80:83]
    ds_read_b64_tr_b16 v[140:141], v18 offset:51736
    ds_read_b128 a[108:111], v11 offset:22528
    v_mfma_f32_16x16x32_bf16 v[100:103], v[116:119], a[100:103], v[100:103]
    ds_read_b64_tr_b16 v[142:143], v18 offset:53016
    s_waitcnt lgkmcnt(12)
    v_mfma_f32_16x16x32_bf16 v[84:87], v[120:123], a[20:23], v[84:87]
    ds_read_b64_tr_b16 v[112:113], v18 offset:51744
    s_add_u32 m0, s48, 141824
    v_mfma_f32_16x16x32_bf16 v[104:107], v[120:123], a[100:103], v[104:107]
    ds_read_b64_tr_b16 v[114:115], v18 offset:53024
    buffer_load_dwordx4 v16, s[56:59], s47 offen offset:0 lds
    v_mfma_f32_16x16x32_bf16 v[88:91], v[124:127], a[20:23], v[88:91]
    ds_read_b64_tr_b16 v[116:117], v18 offset:56832
    v_mfma_f32_16x16x32_bf16 v[108:111], v[124:127], a[100:103], v[108:111]
    ds_read_b64_tr_b16 v[118:119], v18 offset:58112
    s_waitcnt lgkmcnt(10)
    s_waitcnt lgkmcnt(5)
    v_mfma_f32_16x16x32_bf16 v[32:35], v[128:131], a[24:27], v[32:35]
    ds_read_b64_tr_b16 v[120:121], v18 offset:56840
    s_add_u32 m0, s78, 72192
    v_mfma_f32_16x16x32_bf16 v[52:55], v[128:131], a[104:107], v[52:55]
    ds_read_b64_tr_b16 v[122:123], v18 offset:58120
    v_mfma_f32_16x16x32_bf16 v[36:39], v[132:135], a[24:27], v[36:39]
    ds_read_b64_tr_b16 v[124:125], v18 offset:56848
    s_movk_i32 s74, 640
    v_mfma_f32_16x16x32_bf16 v[56:59], v[132:135], a[104:107], v[56:59]
    ds_read_b64_tr_b16 v[126:127], v18 offset:58128
    s_waitcnt lgkmcnt(8)
    v_mfma_f32_16x16x32_bf16 v[40:43], v[136:139], a[24:27], v[40:43]
    ds_read_b64_tr_b16 v[128:129], v18 offset:56856
    buffer_load_dwordx4 v232, s[52:55], s74 offen offset:0 lds
    v_mfma_f32_16x16x32_bf16 v[60:63], v[136:139], a[104:107], v[60:63]
    ds_read_b64_tr_b16 v[130:131], v18 offset:58136
    v_mfma_f32_16x16x32_bf16 v[44:47], v[140:143], a[24:27], v[44:47]
    ds_read_b64_tr_b16 v[132:133], v18 offset:56864
    buffer_load_dwordx4 v233, s[52:55], s74 offen offset:1024 lds
    v_mfma_f32_16x16x32_bf16 v[64:67], v[140:143], a[104:107], v[64:67]
    ds_read_b64_tr_b16 v[134:135], v18 offset:58144
    s_waitcnt lgkmcnt(8)
    v_mfma_f32_16x16x32_bf16 v[48:51], v[112:115], a[24:27], v[48:51]
    ds_read_b64_tr_b16 v[136:137], v18 offset:61952
    v_mfma_f32_16x16x32_bf16 v[68:71], v[112:115], a[104:107], v[68:71]
    ds_read_b64_tr_b16 v[138:139], v18 offset:63232
    v_mfma_f32_16x16x32_bf16 v[72:75], v[116:119], a[24:27], v[72:75]
    ds_read_b64_tr_b16 v[140:141], v18 offset:61960
    buffer_load_dwordx4 v234, s[52:55], s74 offen offset:2048 lds
    v_mfma_f32_16x16x32_bf16 v[92:95], v[116:119], a[104:107], v[92:95]
    ds_read_b64_tr_b16 v[142:143], v18 offset:63240
    s_waitcnt lgkmcnt(8)
    v_mfma_f32_16x16x32_bf16 v[76:79], v[120:123], a[24:27], v[76:79]
    ds_read_b64_tr_b16 v[112:113], v18 offset:61968
    buffer_load_dwordx4 v235, s[52:55], s74 offen offset:3072 lds
    v_mfma_f32_16x16x32_bf16 v[96:99], v[120:123], a[104:107], v[96:99]
    ds_read_b64_tr_b16 v[114:115], v18 offset:63248
    v_mfma_f32_16x16x32_bf16 v[80:83], v[124:127], a[24:27], v[80:83]
    ds_read_b64_tr_b16 v[116:117], v18 offset:61976
    s_add_u32 s47, s46, 1228800
    v_mfma_f32_16x16x32_bf16 v[100:103], v[124:127], a[104:107], v[100:103]
    ds_read_b64_tr_b16 v[118:119], v18 offset:63256
    s_waitcnt lgkmcnt(8)
    v_mfma_f32_16x16x32_bf16 v[84:87], v[128:131], a[24:27], v[84:87]
    ds_read_b64_tr_b16 v[120:121], v18 offset:61984
    v_mfma_f32_16x16x32_bf16 v[104:107], v[128:131], a[104:107], v[104:107]
    ds_read_b64_tr_b16 v[122:123], v18 offset:63264
    v_mfma_f32_16x16x32_bf16 v[88:91], v[132:135], a[24:27], v[88:91]
    ds_read_b64_tr_b16 v[124:125], v19 offset:1536
    s_add_u32 m0, s48, 10752
    v_mfma_f32_16x16x32_bf16 v[108:111], v[132:135], a[104:107], v[108:111]
    ds_read_b64_tr_b16 v[126:127], v19 offset:2816
    s_waitcnt lgkmcnt(8)
    v_mfma_f32_16x16x32_bf16 v[32:35], v[136:139], a[28:31], v[32:35]
    ds_read_b64_tr_b16 v[128:129], v19 offset:1544
    buffer_load_dwordx4 v12, s[56:59], s47 offen offset:0 lds
    v_mfma_f32_16x16x32_bf16 v[52:55], v[136:139], a[108:111], v[52:55]
    ds_read_b64_tr_b16 v[130:131], v19 offset:2824
    v_mfma_f32_16x16x32_bf16 v[36:39], v[140:143], a[28:31], v[36:39]
    ds_read_b64_tr_b16 v[132:133], v19 offset:1552
    buffer_load_dwordx4 v13, s[56:59], s47 offen offset:1024 lds
    v_mfma_f32_16x16x32_bf16 v[56:59], v[140:143], a[108:111], v[56:59]
    ds_read_b64_tr_b16 v[134:135], v19 offset:2832
    s_waitcnt lgkmcnt(8)
    v_mfma_f32_16x16x32_bf16 v[40:43], v[112:115], a[28:31], v[40:43]
    ds_read_b64_tr_b16 v[136:137], v19 offset:1560
    buffer_load_dwordx4 v14, s[56:59], s47 offen offset:2048 lds
    v_mfma_f32_16x16x32_bf16 v[60:63], v[112:115], a[108:111], v[60:63]
    ds_read_b64_tr_b16 v[138:139], v19 offset:2840
    v_mfma_f32_16x16x32_bf16 v[44:47], v[116:119], a[28:31], v[44:47]
    ds_read_b64_tr_b16 v[140:141], v19 offset:1568
    v_mfma_f32_16x16x32_bf16 v[64:67], v[116:119], a[108:111], v[64:67]
    ds_read_b64_tr_b16 v[142:143], v19 offset:2848
    s_waitcnt lgkmcnt(8)
    v_mfma_f32_16x16x32_bf16 v[48:51], v[120:123], a[28:31], v[48:51]
    s_waitcnt vmcnt(7)
    s_barrier
    ds_read_b64_tr_b16 v[112:113], v19 offset:6656
    v_mfma_f32_16x16x32_bf16 v[68:71], v[120:123], a[108:111], v[68:71]
    ds_read_b64_tr_b16 v[114:115], v19 offset:7936
    ds_read_b128 a[32:35], v10 offset:0
    v_mfma_f32_16x16x32_bf16 v[72:75], v[124:127], a[28:31], v[72:75]
    ds_read_b64_tr_b16 v[116:117], v19 offset:6664
    ds_read_b128 a[112:115], v10 offset:2048
    v_mfma_f32_16x16x32_bf16 v[92:95], v[124:127], a[108:111], v[92:95]
    ds_read_b64_tr_b16 v[118:119], v19 offset:7944
    s_waitcnt lgkmcnt(10)
    v_mfma_f32_16x16x32_bf16 v[76:79], v[128:131], a[28:31], v[76:79]
    ds_read_b64_tr_b16 v[120:121], v19 offset:6672
    buffer_load_dwordx4 v15, s[56:59], s47 offen offset:3072 lds
    v_mfma_f32_16x16x32_bf16 v[96:99], v[128:131], a[108:111], v[96:99]
    ds_read_b64_tr_b16 v[122:123], v19 offset:7952
    ds_read_b128 a[36:39], v11 offset:0
    v_mfma_f32_16x16x32_bf16 v[80:83], v[132:135], a[28:31], v[80:83]
    ds_read_b64_tr_b16 v[124:125], v19 offset:6680
    ds_read_b128 a[116:119], v11 offset:2048
    v_mfma_f32_16x16x32_bf16 v[100:103], v[132:135], a[108:111], v[100:103]
    ds_read_b64_tr_b16 v[126:127], v19 offset:7960
    s_waitcnt lgkmcnt(12)
    v_mfma_f32_16x16x32_bf16 v[84:87], v[136:139], a[28:31], v[84:87]
    ds_read_b64_tr_b16 v[128:129], v19 offset:6688
    s_add_u32 m0, s48, 14848
    v_mfma_f32_16x16x32_bf16 v[104:107], v[136:139], a[108:111], v[104:107]
    ds_read_b64_tr_b16 v[130:131], v19 offset:7968
    buffer_load_dwordx4 v16, s[56:59], s47 offen offset:0 lds
    v_mfma_f32_16x16x32_bf16 v[88:91], v[140:143], a[28:31], v[88:91]
    ds_read_b64_tr_b16 v[132:133], v19 offset:11776
    v_mfma_f32_16x16x32_bf16 v[108:111], v[140:143], a[108:111], v[108:111]
    ds_read_b64_tr_b16 v[134:135], v19 offset:13056
    s_waitcnt lgkmcnt(10)
    s_waitcnt lgkmcnt(5)
    v_mfma_f32_16x16x32_bf16 v[32:35], v[112:115], a[32:35], v[32:35]
    ds_read_b64_tr_b16 v[136:137], v19 offset:11784
    s_add_u32 m0, s78, 51712
    v_mfma_f32_16x16x32_bf16 v[52:55], v[112:115], a[112:115], v[52:55]
    ds_read_b64_tr_b16 v[138:139], v19 offset:13064
    v_mfma_f32_16x16x32_bf16 v[36:39], v[116:119], a[32:35], v[36:39]
    ds_read_b64_tr_b16 v[140:141], v19 offset:11792
    s_movk_i32 s74, 768
    v_mfma_f32_16x16x32_bf16 v[56:59], v[116:119], a[112:115], v[56:59]
    ds_read_b64_tr_b16 v[142:143], v19 offset:13072
    s_waitcnt lgkmcnt(8)
    v_mfma_f32_16x16x32_bf16 v[40:43], v[120:123], a[32:35], v[40:43]
    ds_read_b64_tr_b16 v[112:113], v19 offset:11800
    buffer_load_dwordx4 v232, s[52:55], s74 offen offset:0 lds
    v_mfma_f32_16x16x32_bf16 v[60:63], v[120:123], a[112:115], v[60:63]
    ds_read_b64_tr_b16 v[114:115], v19 offset:13080
    v_mfma_f32_16x16x32_bf16 v[44:47], v[124:127], a[32:35], v[44:47]
    ds_read_b64_tr_b16 v[116:117], v19 offset:11808
    buffer_load_dwordx4 v233, s[52:55], s74 offen offset:1024 lds
    v_mfma_f32_16x16x32_bf16 v[64:67], v[124:127], a[112:115], v[64:67]
    ds_read_b64_tr_b16 v[118:119], v19 offset:13088
    s_waitcnt lgkmcnt(8)
    v_mfma_f32_16x16x32_bf16 v[48:51], v[128:131], a[32:35], v[48:51]
    ds_read_b64_tr_b16 v[120:121], v19 offset:16896
    v_mfma_f32_16x16x32_bf16 v[68:71], v[128:131], a[112:115], v[68:71]
    ds_read_b64_tr_b16 v[122:123], v19 offset:18176
    v_mfma_f32_16x16x32_bf16 v[72:75], v[132:135], a[32:35], v[72:75]
    ds_read_b64_tr_b16 v[124:125], v19 offset:16904
    buffer_load_dwordx4 v234, s[52:55], s74 offen offset:2048 lds
    v_mfma_f32_16x16x32_bf16 v[92:95], v[132:135], a[112:115], v[92:95]
    ds_read_b64_tr_b16 v[126:127], v19 offset:18184
    s_waitcnt lgkmcnt(8)
    v_mfma_f32_16x16x32_bf16 v[76:79], v[136:139], a[32:35], v[76:79]
    ds_read_b64_tr_b16 v[128:129], v19 offset:16912
    buffer_load_dwordx4 v235, s[52:55], s74 offen offset:3072 lds
    v_mfma_f32_16x16x32_bf16 v[96:99], v[136:139], a[112:115], v[96:99]
    ds_read_b64_tr_b16 v[130:131], v19 offset:18192
    v_mfma_f32_16x16x32_bf16 v[80:83], v[140:143], a[32:35], v[80:83]
    ds_read_b64_tr_b16 v[132:133], v19 offset:16920
    s_add_u32 s47, s46, 1474560
    v_mfma_f32_16x16x32_bf16 v[100:103], v[140:143], a[112:115], v[100:103]
    ds_read_b64_tr_b16 v[134:135], v19 offset:18200
    s_waitcnt lgkmcnt(8)
    v_mfma_f32_16x16x32_bf16 v[84:87], v[112:115], a[32:35], v[84:87]
    ds_read_b64_tr_b16 v[136:137], v19 offset:16928
    v_mfma_f32_16x16x32_bf16 v[104:107], v[112:115], a[112:115], v[104:107]
    ds_read_b64_tr_b16 v[138:139], v19 offset:18208
    v_mfma_f32_16x16x32_bf16 v[88:91], v[116:119], a[32:35], v[88:91]
    ds_read_b64_tr_b16 v[140:141], v19 offset:22016
    s_add_u32 m0, s48, 31232
    v_mfma_f32_16x16x32_bf16 v[108:111], v[116:119], a[112:115], v[108:111]
    ds_read_b64_tr_b16 v[142:143], v19 offset:23296
    s_waitcnt lgkmcnt(8)
    v_mfma_f32_16x16x32_bf16 v[32:35], v[120:123], a[36:39], v[32:35]
    ds_read_b64_tr_b16 v[112:113], v19 offset:22024
    buffer_load_dwordx4 v12, s[56:59], s47 offen offset:0 lds
    v_mfma_f32_16x16x32_bf16 v[52:55], v[120:123], a[116:119], v[52:55]
    ds_read_b64_tr_b16 v[114:115], v19 offset:23304
    v_mfma_f32_16x16x32_bf16 v[36:39], v[124:127], a[36:39], v[36:39]
    ds_read_b64_tr_b16 v[116:117], v19 offset:22032
    buffer_load_dwordx4 v13, s[56:59], s47 offen offset:1024 lds
    v_mfma_f32_16x16x32_bf16 v[56:59], v[124:127], a[116:119], v[56:59]
    ds_read_b64_tr_b16 v[118:119], v19 offset:23312
    s_waitcnt lgkmcnt(8)
    v_mfma_f32_16x16x32_bf16 v[40:43], v[128:131], a[36:39], v[40:43]
    ds_read_b64_tr_b16 v[120:121], v19 offset:22040
    buffer_load_dwordx4 v14, s[56:59], s47 offen offset:2048 lds
    v_mfma_f32_16x16x32_bf16 v[60:63], v[128:131], a[116:119], v[60:63]
    ds_read_b64_tr_b16 v[122:123], v19 offset:23320
    v_mfma_f32_16x16x32_bf16 v[44:47], v[132:135], a[36:39], v[44:47]
    ds_read_b64_tr_b16 v[124:125], v19 offset:22048
    v_mfma_f32_16x16x32_bf16 v[64:67], v[132:135], a[116:119], v[64:67]
    ds_read_b64_tr_b16 v[126:127], v19 offset:23328
    s_waitcnt lgkmcnt(8)
    v_mfma_f32_16x16x32_bf16 v[48:51], v[136:139], a[36:39], v[48:51]
    ds_read_b64_tr_b16 a[160:161], v29 offset:0
    ds_read_b64_tr_b16 a[162:163], v29 offset:160
    ds_read_b64_tr_b16 a[164:165], v29 offset:320
    ds_read_b64_tr_b16 a[166:167], v29 offset:480
    ds_read_b64_tr_b16 a[168:169], v29 offset:640
    s_waitcnt vmcnt(7)
    s_barrier
    ds_read_b64_tr_b16 v[128:129], v17 offset:10752
    v_mfma_f32_16x16x32_bf16 v[68:71], v[136:139], a[116:119], v[68:71]
    ds_read_b64_tr_b16 v[130:131], v17 offset:12032
    ds_read_b128 a[40:43], v10 offset:20480
    v_mfma_f32_16x16x32_bf16 v[72:75], v[140:143], a[36:39], v[72:75]
    ds_read_b64_tr_b16 v[132:133], v17 offset:10760
    ds_read_b128 a[120:123], v10 offset:22528
    v_mfma_f32_16x16x32_bf16 v[92:95], v[140:143], a[116:119], v[92:95]
    ds_read_b64_tr_b16 v[134:135], v17 offset:12040
    s_waitcnt lgkmcnt(14)
    v_mfma_f32_16x16x32_bf16 v[76:79], v[112:115], a[36:39], v[76:79]
    ds_read_b64_tr_b16 v[136:137], v17 offset:10768
    buffer_load_dwordx4 v15, s[56:59], s47 offen offset:3072 lds
    v_mfma_f32_16x16x32_bf16 v[96:99], v[112:115], a[116:119], v[96:99]
    ds_read_b64_tr_b16 v[138:139], v17 offset:12048
    ds_read_b128 a[44:47], v11 offset:20480
    v_mfma_f32_16x16x32_bf16 v[80:83], v[116:119], a[36:39], v[80:83]
    ds_read_b64_tr_b16 v[140:141], v17 offset:10776
    ds_read_b128 a[124:127], v11 offset:22528
    v_mfma_f32_16x16x32_bf16 v[100:103], v[116:119], a[116:119], v[100:103]
    ds_read_b64_tr_b16 v[142:143], v17 offset:12056
    s_waitcnt lgkmcnt(14)
    v_mfma_f32_16x16x32_bf16 v[84:87], v[120:123], a[36:39], v[84:87]
    ds_read_b64_tr_b16 v[112:113], v17 offset:10784
    s_add_u32 m0, s48, 35328
    v_mfma_f32_16x16x32_bf16 v[104:107], v[120:123], a[116:119], v[104:107]
    ds_read_b64_tr_b16 v[114:115], v17 offset:12064
    buffer_load_dwordx4 v16, s[56:59], s47 offen offset:0 lds
    v_mfma_f32_16x16x32_bf16 v[88:91], v[124:127], a[36:39], v[88:91]
    ds_read_b64_tr_b16 v[116:117], v17 offset:15872
    v_mfma_f32_16x16x32_bf16 v[108:111], v[124:127], a[116:119], v[108:111]
    ds_read_b64_tr_b16 v[118:119], v17 offset:17152
    s_waitcnt lgkmcnt(10)
    s_waitcnt lgkmcnt(5)
    v_mfma_f32_16x16x32_bf16 v[32:35], v[128:131], a[40:43], v[32:35]
    ds_read_b64_tr_b16 v[120:121], v17 offset:15880
    s_add_u32 m0, s78, 72192
    v_mfma_f32_16x16x32_bf16 v[52:55], v[128:131], a[120:123], v[52:55]
    ds_read_b64_tr_b16 v[122:123], v17 offset:17160
    v_mfma_f32_16x16x32_bf16 v[36:39], v[132:135], a[40:43], v[36:39]
    ds_read_b64_tr_b16 v[124:125], v17 offset:15888
    s_movk_i32 s74, 896
    v_mfma_f32_16x16x32_bf16 v[56:59], v[132:135], a[120:123], v[56:59]
    ds_read_b64_tr_b16 v[126:127], v17 offset:17168
    s_waitcnt lgkmcnt(8)
    v_mfma_f32_16x16x32_bf16 v[40:43], v[136:139], a[40:43], v[40:43]
    ds_read_b64_tr_b16 v[128:129], v17 offset:15896
    buffer_load_dwordx4 v232, s[52:55], s74 offen offset:0 lds
    v_mfma_f32_16x16x32_bf16 v[60:63], v[136:139], a[120:123], v[60:63]
    ds_read_b64_tr_b16 v[130:131], v17 offset:17176
    v_mfma_f32_16x16x32_bf16 v[44:47], v[140:143], a[40:43], v[44:47]
    ds_read_b64_tr_b16 v[132:133], v17 offset:15904
    buffer_load_dwordx4 v233, s[52:55], s74 offen offset:1024 lds
    v_mfma_f32_16x16x32_bf16 v[64:67], v[140:143], a[120:123], v[64:67]
    ds_read_b64_tr_b16 v[134:135], v17 offset:17184
    s_waitcnt lgkmcnt(8)
    v_mfma_f32_16x16x32_bf16 v[48:51], v[112:115], a[40:43], v[48:51]
    ds_read_b64_tr_b16 v[136:137], v17 offset:20992
    v_mfma_f32_16x16x32_bf16 v[68:71], v[112:115], a[120:123], v[68:71]
    ds_read_b64_tr_b16 v[138:139], v17 offset:22272
    v_mfma_f32_16x16x32_bf16 v[72:75], v[116:119], a[40:43], v[72:75]
    ds_read_b64_tr_b16 v[140:141], v17 offset:21000
    buffer_load_dwordx4 v234, s[52:55], s74 offen offset:2048 lds
    v_mfma_f32_16x16x32_bf16 v[92:95], v[116:119], a[120:123], v[92:95]
    ds_read_b64_tr_b16 v[142:143], v17 offset:22280
    s_waitcnt lgkmcnt(8)
    v_mfma_f32_16x16x32_bf16 v[76:79], v[120:123], a[40:43], v[76:79]
    ds_read_b64_tr_b16 v[112:113], v17 offset:21008
    buffer_load_dwordx4 v235, s[52:55], s74 offen offset:3072 lds
    v_mfma_f32_16x16x32_bf16 v[96:99], v[120:123], a[120:123], v[96:99]
    ds_read_b64_tr_b16 v[114:115], v17 offset:22288
    v_mfma_f32_16x16x32_bf16 v[80:83], v[124:127], a[40:43], v[80:83]
    ds_read_b64_tr_b16 v[116:117], v17 offset:21016
    s_add_u32 s47, s46, 1720320
    v_mfma_f32_16x16x32_bf16 v[100:103], v[124:127], a[120:123], v[100:103]
    ds_read_b64_tr_b16 v[118:119], v17 offset:22296
    s_waitcnt lgkmcnt(8)
    v_mfma_f32_16x16x32_bf16 v[84:87], v[128:131], a[40:43], v[84:87]
    ds_read_b64_tr_b16 v[120:121], v17 offset:21024
    v_mfma_f32_16x16x32_bf16 v[104:107], v[128:131], a[120:123], v[104:107]
    ds_read_b64_tr_b16 v[122:123], v17 offset:22304
    v_mfma_f32_16x16x32_bf16 v[88:91], v[132:135], a[40:43], v[88:91]
    ds_read_b64_tr_b16 v[124:125], v17 offset:26112
    s_add_u32 m0, s48, 96768
    v_mfma_f32_16x16x32_bf16 v[108:111], v[132:135], a[120:123], v[108:111]
    ds_read_b64_tr_b16 v[126:127], v17 offset:27392
    s_waitcnt lgkmcnt(8)
    v_mfma_f32_16x16x32_bf16 v[32:35], v[136:139], a[44:47], v[32:35]
    ds_read_b64_tr_b16 v[128:129], v17 offset:26120
    buffer_load_dwordx4 v12, s[56:59], s47 offen offset:0 lds
    v_mfma_f32_16x16x32_bf16 v[52:55], v[136:139], a[124:127], v[52:55]
    ds_read_b64_tr_b16 v[130:131], v17 offset:27400
    v_mfma_f32_16x16x32_bf16 v[36:39], v[140:143], a[44:47], v[36:39]
    ds_read_b64_tr_b16 v[132:133], v17 offset:26128
    buffer_load_dwordx4 v13, s[56:59], s47 offen offset:1024 lds
    v_mfma_f32_16x16x32_bf16 v[56:59], v[140:143], a[124:127], v[56:59]
    ds_read_b64_tr_b16 v[134:135], v17 offset:27408
    s_waitcnt lgkmcnt(8)
    v_mfma_f32_16x16x32_bf16 v[40:43], v[112:115], a[44:47], v[40:43]
    ds_read_b64_tr_b16 v[136:137], v17 offset:26136
    buffer_load_dwordx4 v14, s[56:59], s47 offen offset:2048 lds
    v_mfma_f32_16x16x32_bf16 v[60:63], v[112:115], a[124:127], v[60:63]
    ds_read_b64_tr_b16 v[138:139], v17 offset:27416
    v_mfma_f32_16x16x32_bf16 v[44:47], v[116:119], a[44:47], v[44:47]
    ds_read_b64_tr_b16 v[140:141], v17 offset:26144
    v_mfma_f32_16x16x32_bf16 v[64:67], v[116:119], a[124:127], v[64:67]
    ds_read_b64_tr_b16 v[142:143], v17 offset:27424
    s_waitcnt lgkmcnt(8)
    v_mfma_f32_16x16x32_bf16 v[48:51], v[120:123], a[44:47], v[48:51]
    ds_read_b64_tr_b16 a[172:173], v29 offset:8
    ds_read_b64_tr_b16 a[174:175], v29 offset:168
    ds_read_b64_tr_b16 a[176:177], v29 offset:328
    ds_read_b64_tr_b16 a[178:179], v29 offset:488
    ds_read_b64_tr_b16 a[180:181], v29 offset:648
    s_waitcnt vmcnt(7)
    s_barrier
    ds_read_b64_tr_b16 v[112:113], v17 offset:31232
    v_mfma_f32_16x16x32_bf16 v[68:71], v[120:123], a[124:127], v[68:71]
    ds_read_b64_tr_b16 v[114:115], v17 offset:32512
    ds_read_b128 a[48:51], v10 offset:0
    v_mfma_f32_16x16x32_bf16 v[72:75], v[124:127], a[44:47], v[72:75]
    ds_read_b64_tr_b16 v[116:117], v17 offset:31240
    ds_read_b128 a[128:131], v10 offset:2048
    v_mfma_f32_16x16x32_bf16 v[92:95], v[124:127], a[124:127], v[92:95]
    ds_read_b64_tr_b16 v[118:119], v17 offset:32520
    s_waitcnt lgkmcnt(14)
    v_mfma_f32_16x16x32_bf16 v[76:79], v[128:131], a[44:47], v[76:79]
    ds_read_b64_tr_b16 v[120:121], v17 offset:31248
    buffer_load_dwordx4 v15, s[56:59], s47 offen offset:3072 lds
    v_mfma_f32_16x16x32_bf16 v[96:99], v[128:131], a[124:127], v[96:99]
    ds_read_b64_tr_b16 v[122:123], v17 offset:32528
    ds_read_b128 a[52:55], v11 offset:0
    v_mfma_f32_16x16x32_bf16 v[80:83], v[132:135], a[44:47], v[80:83]
    ds_read_b64_tr_b16 v[124:125], v17 offset:31256
    ds_read_b128 a[132:135], v11 offset:2048
    v_mfma_f32_16x16x32_bf16 v[100:103], v[132:135], a[124:127], v[100:103]
    ds_read_b64_tr_b16 v[126:127], v17 offset:32536
    s_waitcnt lgkmcnt(14)
    v_mfma_f32_16x16x32_bf16 v[84:87], v[136:139], a[44:47], v[84:87]
    ds_read_b64_tr_b16 v[128:129], v17 offset:31264
    s_add_u32 m0, s48, 100864
    v_mfma_f32_16x16x32_bf16 v[104:107], v[136:139], a[124:127], v[104:107]
    ds_read_b64_tr_b16 v[130:131], v17 offset:32544
    buffer_load_dwordx4 v16, s[56:59], s47 offen offset:0 lds
    v_mfma_f32_16x16x32_bf16 v[88:91], v[140:143], a[44:47], v[88:91]
    ds_read_b64_tr_b16 v[132:133], v17 offset:36352
    v_mfma_f32_16x16x32_bf16 v[108:111], v[140:143], a[124:127], v[108:111]
    ds_read_b64_tr_b16 v[134:135], v17 offset:37632
    s_waitcnt lgkmcnt(10)
    s_waitcnt lgkmcnt(5)
    v_mfma_f32_16x16x32_bf16 v[32:35], v[112:115], a[48:51], v[32:35]
    ds_read_b64_tr_b16 v[136:137], v17 offset:36360
    s_add_u32 m0, s78, 51712
    v_mfma_f32_16x16x32_bf16 v[52:55], v[112:115], a[128:131], v[52:55]
    ds_read_b64_tr_b16 v[138:139], v17 offset:37640
    v_mfma_f32_16x16x32_bf16 v[36:39], v[116:119], a[48:51], v[36:39]
    ds_read_b64_tr_b16 v[140:141], v17 offset:36368
    s_movk_i32 s74, 1024
    v_mfma_f32_16x16x32_bf16 v[56:59], v[116:119], a[128:131], v[56:59]
    ds_read_b64_tr_b16 v[142:143], v17 offset:37648
    s_waitcnt lgkmcnt(8)
    v_mfma_f32_16x16x32_bf16 v[40:43], v[120:123], a[48:51], v[40:43]
    ds_read_b64_tr_b16 v[112:113], v17 offset:36376
    buffer_load_dwordx4 v232, s[52:55], s74 offen offset:0 lds
    v_mfma_f32_16x16x32_bf16 v[60:63], v[120:123], a[128:131], v[60:63]
    ds_read_b64_tr_b16 v[114:115], v17 offset:37656
    v_mfma_f32_16x16x32_bf16 v[44:47], v[124:127], a[48:51], v[44:47]
    ds_read_b64_tr_b16 v[116:117], v17 offset:36384
    buffer_load_dwordx4 v233, s[52:55], s74 offen offset:1024 lds
    v_mfma_f32_16x16x32_bf16 v[64:67], v[124:127], a[128:131], v[64:67]
    ds_read_b64_tr_b16 v[118:119], v17 offset:37664
    s_waitcnt lgkmcnt(8)
    v_mfma_f32_16x16x32_bf16 v[48:51], v[128:131], a[48:51], v[48:51]
    ds_read_b64_tr_b16 v[120:121], v17 offset:41472
    v_mfma_f32_16x16x32_bf16 v[68:71], v[128:131], a[128:131], v[68:71]
    ds_read_b64_tr_b16 v[122:123], v17 offset:42752
    v_mfma_f32_16x16x32_bf16 v[72:75], v[132:135], a[48:51], v[72:75]
    ds_read_b64_tr_b16 v[124:125], v17 offset:41480
    buffer_load_dwordx4 v234, s[52:55], s74 offen offset:2048 lds
    v_mfma_f32_16x16x32_bf16 v[92:95], v[132:135], a[128:131], v[92:95]
    ds_read_b64_tr_b16 v[126:127], v17 offset:42760
    s_waitcnt lgkmcnt(8)
    v_mfma_f32_16x16x32_bf16 v[76:79], v[136:139], a[48:51], v[76:79]
    ds_read_b64_tr_b16 v[128:129], v17 offset:41488
WA_P1:
    s_cbranch_execz WA_P5
    s_nop 0
    buffer_load_dwordx4 v235, s[52:55], s74 offen offset:3072 lds
    v_mfma_f32_16x16x32_bf16 v[96:99], v[136:139], a[128:131], v[96:99]
    ds_read_b64_tr_b16 v[130:131], v17 offset:42768
    v_mfma_f32_16x16x32_bf16 v[80:83], v[140:143], a[48:51], v[80:83]
    ds_read_b64_tr_b16 v[132:133], v17 offset:41496
    s_add_u32 s47, s46, 1966080
    v_mfma_f32_16x16x32_bf16 v[100:103], v[140:143], a[128:131], v[100:103]
    ds_read_b64_tr_b16 v[134:135], v17 offset:42776
    s_waitcnt lgkmcnt(8)
    v_mfma_f32_16x16x32_bf16 v[84:87], v[112:115], a[48:51], v[84:87]
    ds_read_b64_tr_b16 v[136:137], v17 offset:41504
    v_mfma_f32_16x16x32_bf16 v[104:107], v[112:115], a[128:131], v[104:107]
    ds_read_b64_tr_b16 v[138:139], v17 offset:42784
    v_mfma_f32_16x16x32_bf16 v[88:91], v[116:119], a[48:51], v[88:91]
    ds_read_b64_tr_b16 v[140:141], v17 offset:46592
    s_add_u32 m0, s48, 117248
    v_mfma_f32_16x16x32_bf16 v[108:111], v[116:119], a[128:131], v[108:111]
    ds_read_b64_tr_b16 v[142:143], v17 offset:47872
    s_waitcnt lgkmcnt(8)
    v_mfma_f32_16x16x32_bf16 v[32:35], v[120:123], a[52:55], v[32:35]
    ds_read_b64_tr_b16 v[112:113], v17 offset:46600
    buffer_load_dwordx4 v12, s[56:59], s47 offen offset:0 lds
    v_mfma_f32_16x16x32_bf16 v[52:55], v[120:123], a[132:135], v[52:55]
    ds_read_b64_tr_b16 v[114:115], v17 offset:47880
    v_mfma_f32_16x16x32_bf16 v[36:39], v[124:127], a[52:55], v[36:39]
    ds_read_b64_tr_b16 v[116:117], v17 offset:46608
    buffer_load_dwordx4 v13, s[56:59], s47 offen offset:1024 lds
    v_mfma_f32_16x16x32_bf16 v[56:59], v[124:127], a[132:135], v[56:59]
    ds_read_b64_tr_b16 v[118:119], v17 offset:47888
    s_waitcnt lgkmcnt(8)
    v_mfma_f32_16x16x32_bf16 v[40:43], v[128:131], a[52:55], v[40:43]
    ds_read_b64_tr_b16 v[120:121], v17 offset:46616
    buffer_load_dwordx4 v14, s[56:59], s47 offen offset:2048 lds
    v_mfma_f32_16x16x32_bf16 v[60:63], v[128:131], a[132:135], v[60:63]
    ds_read_b64_tr_b16 v[122:123], v17 offset:47896
    v_mfma_f32_16x16x32_bf16 v[44:47], v[132:135], a[52:55], v[44:47]
    ds_read_b64_tr_b16 v[124:125], v17 offset:46624
    v_mfma_f32_16x16x32_bf16 v[64:67], v[132:135], a[132:135], v[64:67]
    ds_read_b64_tr_b16 v[126:127], v17 offset:47904
    s_waitcnt lgkmcnt(8)
    v_mfma_f32_16x16x32_bf16 v[48:51], v[136:139], a[52:55], v[48:51]
    ds_read_b64_tr_b16 a[184:185], v29 offset:16
    ds_read_b64_tr_b16 a[186:187], v29 offset:176
    ds_read_b64_tr_b16 a[188:189], v29 offset:336
    ds_read_b64_tr_b16 a[190:191], v29 offset:496
    ds_read_b64_tr_b16 a[192:193], v29 offset:656
    s_waitcnt vmcnt(7)
    s_barrier
    ds_read_b64_tr_b16 v[128:129], v18 offset:31232
    v_mfma_f32_16x16x32_bf16 v[68:71], v[136:139], a[132:135], v[68:71]
    ds_read_b64_tr_b16 v[130:131], v18 offset:32512
    ds_read_b128 a[56:59], v10 offset:20480
    v_mfma_f32_16x16x32_bf16 v[72:75], v[140:143], a[52:55], v[72:75]
    ds_read_b64_tr_b16 v[132:133], v18 offset:31240
    ds_read_b128 a[136:139], v10 offset:22528
    v_mfma_f32_16x16x32_bf16 v[92:95], v[140:143], a[132:135], v[92:95]
    ds_read_b64_tr_b16 v[134:135], v18 offset:32520
    s_waitcnt lgkmcnt(14)
    v_mfma_f32_16x16x32_bf16 v[76:79], v[112:115], a[52:55], v[76:79]
    ds_read_b64_tr_b16 v[136:137], v18 offset:31248
    buffer_load_dwordx4 v15, s[56:59], s47 offen offset:3072 lds
    v_mfma_f32_16x16x32_bf16 v[96:99], v[112:115], a[132:135], v[96:99]
    ds_read_b64_tr_b16 v[138:139], v18 offset:32528
    ds_read_b128 a[60:63], v11 offset:20480
    v_mfma_f32_16x16x32_bf16 v[80:83], v[116:119], a[52:55], v[80:83]
    ds_read_b64_tr_b16 v[140:141], v18 offset:31256
    ds_read_b128 a[140:143], v11 offset:22528
    v_mfma_f32_16x16x32_bf16 v[100:103], v[116:119], a[132:135], v[100:103]
    ds_read_b64_tr_b16 v[142:143], v18 offset:32536
    s_waitcnt lgkmcnt(14)
    v_mfma_f32_16x16x32_bf16 v[84:87], v[120:123], a[52:55], v[84:87]
    ds_read_b64_tr_b16 v[112:113], v18 offset:31264
    s_add_u32 m0, s48, 121344
    v_mfma_f32_16x16x32_bf16 v[104:107], v[120:123], a[132:135], v[104:107]
    ds_read_b64_tr_b16 v[114:115], v18 offset:32544
    buffer_load_dwordx4 v16, s[56:59], s47 offen offset:0 lds
    v_mfma_f32_16x16x32_bf16 v[88:91], v[124:127], a[52:55], v[88:91]
    ds_read_b64_tr_b16 v[116:117], v18 offset:36352
    v_mfma_f32_16x16x32_bf16 v[108:111], v[124:127], a[132:135], v[108:111]
    ds_read_b64_tr_b16 v[118:119], v18 offset:37632
    s_waitcnt lgkmcnt(10)
    s_waitcnt lgkmcnt(5)
    v_mfma_f32_16x16x32_bf16 v[32:35], v[128:131], a[56:59], v[32:35]
    ds_read_b64_tr_b16 v[120:121], v18 offset:36360
    s_add_u32 m0, s78, 72192
    v_mfma_f32_16x16x32_bf16 v[52:55], v[128:131], a[136:139], v[52:55]
    ds_read_b64_tr_b16 v[122:123], v18 offset:37640
    v_mfma_f32_16x16x32_bf16 v[36:39], v[132:135], a[56:59], v[36:39]
    ds_read_b64_tr_b16 v[124:125], v18 offset:36368
    s_movk_i32 s74, 1152
    v_mfma_f32_16x16x32_bf16 v[56:59], v[132:135], a[136:139], v[56:59]
    ds_read_b64_tr_b16 v[126:127], v18 offset:37648
    s_waitcnt lgkmcnt(8)
    v_mfma_f32_16x16x32_bf16 v[40:43], v[136:139], a[56:59], v[40:43]
    ds_read_b64_tr_b16 v[128:129], v18 offset:36376
    buffer_load_dwordx4 v232, s[52:55], s74 offen offset:0 lds
    v_mfma_f32_16x16x32_bf16 v[60:63], v[136:139], a[136:139], v[60:63]
    ds_read_b64_tr_b16 v[130:131], v18 offset:37656
    v_mfma_f32_16x16x32_bf16 v[44:47], v[140:143], a[56:59], v[44:47]
    ds_read_b64_tr_b16 v[132:133], v18 offset:36384
    buffer_load_dwordx4 v233, s[52:55], s74 offen offset:1024 lds
    v_mfma_f32_16x16x32_bf16 v[64:67], v[140:143], a[136:139], v[64:67]
    ds_read_b64_tr_b16 v[134:135], v18 offset:37664
    s_waitcnt lgkmcnt(8)
    v_mfma_f32_16x16x32_bf16 v[48:51], v[112:115], a[56:59], v[48:51]
    ds_read_b64_tr_b16 v[136:137], v18 offset:41472
    v_mfma_f32_16x16x32_bf16 v[68:71], v[112:115], a[136:139], v[68:71]
    ds_read_b64_tr_b16 v[138:139], v18 offset:42752
    v_mfma_f32_16x16x32_bf16 v[72:75], v[116:119], a[56:59], v[72:75]
    ds_read_b64_tr_b16 v[140:141], v18 offset:41480
    buffer_load_dwordx4 v234, s[52:55], s74 offen offset:2048 lds
    v_mfma_f32_16x16x32_bf16 v[92:95], v[116:119], a[136:139], v[92:95]
    ds_read_b64_tr_b16 v[142:143], v18 offset:42760
    s_waitcnt lgkmcnt(8)
    v_mfma_f32_16x16x32_bf16 v[76:79], v[120:123], a[56:59], v[76:79]
    ds_read_b64_tr_b16 v[112:113], v18 offset:41488
    buffer_load_dwordx4 v235, s[52:55], s74 offen offset:3072 lds
    v_mfma_f32_16x16x32_bf16 v[96:99], v[120:123], a[136:139], v[96:99]
    ds_read_b64_tr_b16 v[114:115], v18 offset:42768
    v_mfma_f32_16x16x32_bf16 v[80:83], v[124:127], a[56:59], v[80:83]
    ds_read_b64_tr_b16 v[116:117], v18 offset:41496
    s_add_u32 s47, s46, 2211840
    v_mfma_f32_16x16x32_bf16 v[100:103], v[124:127], a[136:139], v[100:103]
    ds_read_b64_tr_b16 v[118:119], v18 offset:42776
    s_waitcnt lgkmcnt(8)
    v_mfma_f32_16x16x32_bf16 v[84:87], v[128:131], a[56:59], v[84:87]
    ds_read_b64_tr_b16 v[120:121], v18 offset:41504
    v_mfma_f32_16x16x32_bf16 v[104:107], v[128:131], a[136:139], v[104:107]
    ds_read_b64_tr_b16 v[122:123], v18 offset:42784
    v_mfma_f32_16x16x32_bf16 v[88:91], v[132:135], a[56:59], v[88:91]
    ds_read_b64_tr_b16 v[124:125], v18 offset:46592
    s_add_u32 m0, s48, 137728
    v_mfma_f32_16x16x32_bf16 v[108:111], v[132:135], a[136:139], v[108:111]
    ds_read_b64_tr_b16 v[126:127], v18 offset:47872
    s_waitcnt lgkmcnt(8)
    v_mfma_f32_16x16x32_bf16 v[32:35], v[136:139], a[60:63], v[32:35]
    ds_read_b64_tr_b16 v[128:129], v18 offset:46600
    buffer_load_dwordx4 v12, s[56:59], s47 offen offset:0 lds
    v_mfma_f32_16x16x32_bf16 v[52:55], v[136:139], a[140:143], v[52:55]
    ds_read_b64_tr_b16 v[130:131], v18 offset:47880
    v_mfma_f32_16x16x32_bf16 v[36:39], v[140:143], a[60:63], v[36:39]
    ds_read_b64_tr_b16 v[132:133], v18 offset:46608
    buffer_load_dwordx4 v13, s[56:59], s47 offen offset:1024 lds
    v_mfma_f32_16x16x32_bf16 v[56:59], v[140:143], a[140:143], v[56:59]
    ds_read_b64_tr_b16 v[134:135], v18 offset:47888
    s_waitcnt lgkmcnt(8)
    v_mfma_f32_16x16x32_bf16 v[40:43], v[112:115], a[60:63], v[40:43]
    ds_read_b64_tr_b16 v[136:137], v18 offset:46616
    buffer_load_dwordx4 v14, s[56:59], s47 offen offset:2048 lds
    v_mfma_f32_16x16x32_bf16 v[60:63], v[112:115], a[140:143], v[60:63]
    ds_read_b64_tr_b16 v[138:139], v18 offset:47896
    v_mfma_f32_16x16x32_bf16 v[44:47], v[116:119], a[60:63], v[44:47]
    ds_read_b64_tr_b16 v[140:141], v18 offset:46624
    v_mfma_f32_16x16x32_bf16 v[64:67], v[116:119], a[140:143], v[64:67]
    ds_read_b64_tr_b16 v[142:143], v18 offset:47904
    s_waitcnt lgkmcnt(8)
    v_mfma_f32_16x16x32_bf16 v[48:51], v[120:123], a[60:63], v[48:51]
    ds_read_b64_tr_b16 a[196:197], v29 offset:24
    ds_read_b64_tr_b16 a[198:199], v29 offset:184
    ds_read_b64_tr_b16 a[200:201], v29 offset:344
    ds_read_b64_tr_b16 a[202:203], v29 offset:504
    ds_read_b64_tr_b16 a[204:205], v29 offset:664
    s_waitcnt vmcnt(7)
    s_barrier
    ds_read_b64_tr_b16 v[112:113], v18 offset:51712
    v_mfma_f32_16x16x32_bf16 v[68:71], v[120:123], a[140:143], v[68:71]
    ds_read_b64_tr_b16 v[114:115], v18 offset:52992
    ds_read_b128 a[64:67], v10 offset:0
    v_mfma_f32_16x16x32_bf16 v[72:75], v[124:127], a[60:63], v[72:75]
    ds_read_b64_tr_b16 v[116:117], v18 offset:51720
    ds_read_b128 a[144:147], v10 offset:2048
    v_mfma_f32_16x16x32_bf16 v[92:95], v[124:127], a[140:143], v[92:95]
    ds_read_b64_tr_b16 v[118:119], v18 offset:53000
    s_waitcnt lgkmcnt(14)
    v_mfma_f32_16x16x32_bf16 v[76:79], v[128:131], a[60:63], v[76:79]
    ds_read_b64_tr_b16 v[120:121], v18 offset:51728
    buffer_load_dwordx4 v15, s[56:59], s47 offen offset:3072 lds
    v_mfma_f32_16x16x32_bf16 v[96:99], v[128:131], a[140:143], v[96:99]
    ds_read_b64_tr_b16 v[122:123], v18 offset:53008
    ds_read_b128 a[68:71], v11 offset:0
    v_mfma_f32_16x16x32_bf16 v[80:83], v[132:135], a[60:63], v[80:83]
    ds_read_b64_tr_b16 v[124:125], v18 offset:51736
    ds_read_b128 a[148:151], v11 offset:2048
    v_mfma_f32_16x16x32_bf16 v[100:103], v[132:135], a[140:143], v[100:103]
    ds_read_b64_tr_b16 v[126:127], v18 offset:53016
    s_waitcnt lgkmcnt(14)
    v_mfma_f32_16x16x32_bf16 v[84:87], v[136:139], a[60:63], v[84:87]
    ds_read_b64_tr_b16 v[128:129], v18 offset:51744
    s_add_u32 m0, s48, 141824
    v_mfma_f32_16x16x32_bf16 v[104:107], v[136:139], a[140:143], v[104:107]
    ds_read_b64_tr_b16 v[130:131], v18 offset:53024
    buffer_load_dwordx4 v16, s[56:59], s47 offen offset:0 lds
    v_mfma_f32_16x16x32_bf16 v[88:91], v[140:143], a[60:63], v[88:91]
    ds_read_b64_tr_b16 v[132:133], v18 offset:56832
    v_mfma_f32_16x16x32_bf16 v[108:111], v[140:143], a[140:143], v[108:111]
    ds_read_b64_tr_b16 v[134:135], v18 offset:58112
    s_waitcnt lgkmcnt(10)
    s_waitcnt lgkmcnt(5)
    v_mfma_f32_16x16x32_bf16 v[32:35], v[112:115], a[64:67], v[32:35]
    ds_read_b64_tr_b16 v[136:137], v18 offset:56840
    s_add_u32 s47, s79, 0
    v_mfma_f32_16x16x32_bf16 v[52:55], v[112:115], a[144:147], v[52:55]
    ds_read_b64_tr_b16 v[138:139], v18 offset:58120
    v_mfma_f32_16x16x32_bf16 v[36:39], v[116:119], a[64:67], v[36:39]
    ds_read_b64_tr_b16 v[140:141], v18 offset:56848
    v_mfma_f32_16x16x32_bf16 v[56:59], v[116:119], a[144:147], v[56:59]
    ds_read_b64_tr_b16 v[142:143], v18 offset:58128
    s_waitcnt lgkmcnt(8)
    v_mfma_f32_16x16x32_bf16 v[40:43], v[120:123], a[64:67], v[40:43]
    ds_read_b64_tr_b16 v[112:113], v18 offset:56856
    s_add_u32 m0, s48, 10752
    v_mfma_f32_16x16x32_bf16 v[60:63], v[120:123], a[144:147], v[60:63]
    ds_read_b64_tr_b16 v[114:115], v18 offset:58136
    v_mfma_f32_16x16x32_bf16 v[44:47], v[124:127], a[64:67], v[44:47]
    ds_read_b64_tr_b16 v[116:117], v18 offset:56864
    v_mfma_f32_16x16x32_bf16 v[64:67], v[124:127], a[144:147], v[64:67]
    ds_read_b64_tr_b16 v[118:119], v18 offset:58144
    s_waitcnt lgkmcnt(8)
    v_mfma_f32_16x16x32_bf16 v[48:51], v[128:131], a[64:67], v[48:51]
    ds_read_b64_tr_b16 v[120:121], v18 offset:61952
    buffer_load_dwordx4 v12, s[56:59], s47 offen offset:0 lds
    v_mfma_f32_16x16x32_bf16 v[68:71], v[128:131], a[144:147], v[68:71]
    ds_read_b64_tr_b16 v[122:123], v18 offset:63232
    v_mfma_f32_16x16x32_bf16 v[72:75], v[132:135], a[64:67], v[72:75]
    ds_read_b64_tr_b16 v[124:125], v18 offset:61960
    v_mfma_f32_16x16x32_bf16 v[92:95], v[132:135], a[144:147], v[92:95]
    ds_read_b64_tr_b16 v[126:127], v18 offset:63240
    s_waitcnt lgkmcnt(8)
    v_mfma_f32_16x16x32_bf16 v[76:79], v[136:139], a[64:67], v[76:79]
    ds_read_b64_tr_b16 v[128:129], v18 offset:61968
    buffer_load_dwordx4 v13, s[56:59], s47 offen offset:1024 lds
    v_mfma_f32_16x16x32_bf16 v[96:99], v[136:139], a[144:147], v[96:99]
    ds_read_b64_tr_b16 v[130:131], v18 offset:63248
    v_mfma_f32_16x16x32_bf16 v[80:83], v[140:143], a[64:67], v[80:83]
    ds_read_b64_tr_b16 v[132:133], v18 offset:61976
    v_mfma_f32_16x16x32_bf16 v[100:103], v[140:143], a[144:147], v[100:103]
    ds_read_b64_tr_b16 v[134:135], v18 offset:63256
    s_waitcnt lgkmcnt(8)
    v_mfma_f32_16x16x32_bf16 v[84:87], v[112:115], a[64:67], v[84:87]
    ds_read_b64_tr_b16 v[136:137], v18 offset:61984
    v_mfma_f32_16x16x32_bf16 v[104:107], v[112:115], a[144:147], v[104:107]
    ds_read_b64_tr_b16 v[138:139], v18 offset:63264
    v_mfma_f32_16x16x32_bf16 v[88:91], v[116:119], a[64:67], v[88:91]
    ds_read_b64_tr_b16 v[140:141], v19 offset:1536
    buffer_load_dwordx4 v14, s[56:59], s47 offen offset:2048 lds
    v_mfma_f32_16x16x32_bf16 v[108:111], v[116:119], a[144:147], v[108:111]
    ds_read_b64_tr_b16 v[142:143], v19 offset:2816
    s_waitcnt lgkmcnt(8)
    v_mfma_f32_16x16x32_bf16 v[32:35], v[120:123], a[68:71], v[32:35]
    ds_read_b64_tr_b16 v[112:113], v19 offset:1544
    v_mfma_f32_16x16x32_bf16 v[52:55], v[120:123], a[148:151], v[52:55]
    ds_read_b64_tr_b16 v[114:115], v19 offset:2824
    v_mfma_f32_16x16x32_bf16 v[36:39], v[124:127], a[68:71], v[36:39]
    ds_read_b64_tr_b16 v[116:117], v19 offset:1552
    buffer_load_dwordx4 v15, s[56:59], s47 offen offset:3072 lds
    v_mfma_f32_16x16x32_bf16 v[56:59], v[124:127], a[148:151], v[56:59]
    ds_read_b64_tr_b16 v[118:119], v19 offset:2832
    s_waitcnt lgkmcnt(8)
    v_mfma_f32_16x16x32_bf16 v[40:43], v[128:131], a[68:71], v[40:43]
    ds_read_b64_tr_b16 v[120:121], v19 offset:1560
    v_mfma_f32_16x16x32_bf16 v[60:63], v[128:131], a[148:151], v[60:63]
    ds_read_b64_tr_b16 v[122:123], v19 offset:2840
    v_mfma_f32_16x16x32_bf16 v[44:47], v[132:135], a[68:71], v[44:47]
    ds_read_b64_tr_b16 v[124:125], v19 offset:1568
    s_add_u32 m0, s48, 14848
    v_mfma_f32_16x16x32_bf16 v[64:67], v[132:135], a[148:151], v[64:67]
    ds_read_b64_tr_b16 v[126:127], v19 offset:2848
    s_waitcnt lgkmcnt(8)
    v_mfma_f32_16x16x32_bf16 v[48:51], v[136:139], a[68:71], v[48:51]
    ds_read_b64_tr_b16 a[208:209], v29 offset:32
    ds_read_b64_tr_b16 a[210:211], v29 offset:192
    ds_read_b64_tr_b16 a[212:213], v29 offset:352
    ds_read_b64_tr_b16 a[214:215], v29 offset:512
    ds_read_b64_tr_b16 a[216:217], v29 offset:672
    s_waitcnt vmcnt(4)
    s_barrier
    ds_read_b64_tr_b16 v[128:129], v19 offset:6656
    v_mfma_f32_16x16x32_bf16 v[68:71], v[136:139], a[148:151], v[68:71]
    ds_read_b64_tr_b16 v[130:131], v19 offset:7936
    ds_read_b128 a[72:75], v10 offset:20480
    v_mfma_f32_16x16x32_bf16 v[72:75], v[140:143], a[68:71], v[72:75]
    ds_read_b64_tr_b16 v[132:133], v19 offset:6664
    ds_read_b128 a[152:155], v10 offset:22528
    v_mfma_f32_16x16x32_bf16 v[92:95], v[140:143], a[148:151], v[92:95]
    ds_read_b64_tr_b16 v[134:135], v19 offset:7944
    s_waitcnt lgkmcnt(14)
    v_mfma_f32_16x16x32_bf16 v[76:79], v[112:115], a[68:71], v[76:79]
    ds_read_b64_tr_b16 v[136:137], v19 offset:6672
    buffer_load_dwordx4 v16, s[56:59], s47 offen offset:0 lds
    v_mfma_f32_16x16x32_bf16 v[96:99], v[112:115], a[148:151], v[96:99]
    ds_read_b64_tr_b16 v[138:139], v19 offset:7952
    ds_read_b128 a[76:79], v11 offset:20480
    v_mfma_f32_16x16x32_bf16 v[80:83], v[116:119], a[68:71], v[80:83]
    ds_read_b64_tr_b16 v[140:141], v19 offset:6680
    ds_read_b128 a[156:159], v11 offset:22528
    v_mfma_f32_16x16x32_bf16 v[100:103], v[116:119], a[148:151], v[100:103]
    ds_read_b64_tr_b16 v[142:143], v19 offset:7960
    s_waitcnt lgkmcnt(14)
    v_mfma_f32_16x16x32_bf16 v[84:87], v[120:123], a[68:71], v[84:87]
    ds_read_b64_tr_b16 v[112:113], v19 offset:6688
    v_mfma_f32_16x16x32_bf16 v[104:107], v[120:123], a[148:151], v[104:107]
    ds_read_b64_tr_b16 v[114:115], v19 offset:7968
    v_mfma_f32_16x16x32_bf16 v[88:91], v[124:127], a[68:71], v[88:91]
    ds_read_b64_tr_b16 v[116:117], v19 offset:11776
    v_mfma_f32_16x16x32_bf16 v[108:111], v[124:127], a[148:151], v[108:111]
    ds_read_b64_tr_b16 v[118:119], v19 offset:13056
    s_waitcnt lgkmcnt(10)
    s_waitcnt lgkmcnt(5)
    v_mfma_f32_16x16x32_bf16 v[32:35], v[128:131], a[72:75], v[32:35]
    ds_read_b64_tr_b16 v[120:121], v19 offset:11784
    s_add_u32 s47, s79, 491520
    v_mfma_f32_16x16x32_bf16 v[52:55], v[128:131], a[152:155], v[52:55]
    ds_read_b64_tr_b16 v[122:123], v19 offset:13064
    v_mfma_f32_16x16x32_bf16 v[36:39], v[132:135], a[72:75], v[36:39]
    ds_read_b64_tr_b16 v[124:125], v19 offset:11792
    v_mfma_f32_16x16x32_bf16 v[56:59], v[132:135], a[152:155], v[56:59]
    ds_read_b64_tr_b16 v[126:127], v19 offset:13072
    s_waitcnt lgkmcnt(8)
    v_mfma_f32_16x16x32_bf16 v[40:43], v[136:139], a[72:75], v[40:43]
    ds_read_b64_tr_b16 v[128:129], v19 offset:11800
    s_add_u32 m0, s48, 31232
    v_mfma_f32_16x16x32_bf16 v[60:63], v[136:139], a[152:155], v[60:63]
    ds_read_b64_tr_b16 v[130:131], v19 offset:13080
    v_mfma_f32_16x16x32_bf16 v[44:47], v[140:143], a[72:75], v[44:47]
    ds_read_b64_tr_b16 v[132:133], v19 offset:11808
    v_mfma_f32_16x16x32_bf16 v[64:67], v[140:143], a[152:155], v[64:67]
    ds_read_b64_tr_b16 v[134:135], v19 offset:13088
    s_waitcnt lgkmcnt(8)
    v_mfma_f32_16x16x32_bf16 v[48:51], v[112:115], a[72:75], v[48:51]
    ds_read_b64_tr_b16 v[136:137], v19 offset:16896
    buffer_load_dwordx4 v12, s[56:59], s47 offen offset:0 lds
    v_mfma_f32_16x16x32_bf16 v[68:71], v[112:115], a[152:155], v[68:71]
    ds_read_b64_tr_b16 v[138:139], v19 offset:18176
    v_mfma_f32_16x16x32_bf16 v[72:75], v[116:119], a[72:75], v[72:75]
    ds_read_b64_tr_b16 v[140:141], v19 offset:16904
    v_mfma_f32_16x16x32_bf16 v[92:95], v[116:119], a[152:155], v[92:95]
    ds_read_b64_tr_b16 v[142:143], v19 offset:18184
    s_waitcnt lgkmcnt(8)
    v_mfma_f32_16x16x32_bf16 v[76:79], v[120:123], a[72:75], v[76:79]
    ds_read_b64_tr_b16 v[112:113], v19 offset:16912
    buffer_load_dwordx4 v13, s[56:59], s47 offen offset:1024 lds
    v_mfma_f32_16x16x32_bf16 v[96:99], v[120:123], a[152:155], v[96:99]
    ds_read_b64_tr_b16 v[114:115], v19 offset:18192
    v_mfma_f32_16x16x32_bf16 v[80:83], v[124:127], a[72:75], v[80:83]
    ds_read_b64_tr_b16 v[116:117], v19 offset:16920
    v_mfma_f32_16x16x32_bf16 v[100:103], v[124:127], a[152:155], v[100:103]
    ds_read_b64_tr_b16 v[118:119], v19 offset:18200
    s_waitcnt lgkmcnt(8)
    v_mfma_f32_16x16x32_bf16 v[84:87], v[128:131], a[72:75], v[84:87]
    ds_read_b64_tr_b16 v[120:121], v19 offset:16928
    v_mfma_f32_16x16x32_bf16 v[104:107], v[128:131], a[152:155], v[104:107]
    ds_read_b64_tr_b16 v[122:123], v19 offset:18208
    v_mfma_f32_16x16x32_bf16 v[88:91], v[132:135], a[72:75], v[88:91]
    ds_read_b64_tr_b16 v[124:125], v19 offset:22016
    buffer_load_dwordx4 v14, s[56:59], s47 offen offset:2048 lds
    v_mfma_f32_16x16x32_bf16 v[108:111], v[132:135], a[152:155], v[108:111]
    ds_read_b64_tr_b16 v[126:127], v19 offset:23296
    s_waitcnt lgkmcnt(8)
    v_mfma_f32_16x16x32_bf16 v[32:35], v[136:139], a[76:79], v[32:35]
    ds_read_b64_tr_b16 v[128:129], v19 offset:22024
    v_mfma_f32_16x16x32_bf16 v[52:55], v[136:139], a[156:159], v[52:55]
    ds_read_b64_tr_b16 v[130:131], v19 offset:23304
    v_mfma_f32_16x16x32_bf16 v[36:39], v[140:143], a[76:79], v[36:39]
    ds_read_b64_tr_b16 v[132:133], v19 offset:22032
    buffer_load_dwordx4 v15, s[56:59], s47 offen offset:3072 lds
    v_mfma_f32_16x16x32_bf16 v[56:59], v[140:143], a[156:159], v[56:59]
    ds_read_b64_tr_b16 v[134:135], v19 offset:23312
    s_waitcnt lgkmcnt(8)
    v_mfma_f32_16x16x32_bf16 v[40:43], v[112:115], a[76:79], v[40:43]
    ds_read_b64_tr_b16 v[136:137], v19 offset:22040
    v_mfma_f32_16x16x32_bf16 v[60:63], v[112:115], a[156:159], v[60:63]
    ds_read_b64_tr_b16 v[138:139], v19 offset:23320
    v_mfma_f32_16x16x32_bf16 v[44:47], v[116:119], a[76:79], v[44:47]
    ds_read_b64_tr_b16 v[140:141], v19 offset:22048
    s_add_u32 m0, s48, 35328
    v_mfma_f32_16x16x32_bf16 v[64:67], v[116:119], a[156:159], v[64:67]
    ds_read_b64_tr_b16 v[142:143], v19 offset:23328
    s_waitcnt lgkmcnt(8)
    v_mfma_f32_16x16x32_bf16 v[48:51], v[120:123], a[76:79], v[48:51]
    v_cvt_pk_bf16_f32 v144, v32, v33
    v_cvt_pk_bf16_f32 v156, v52, v53
    v_mfma_f32_16x16x32_bf16 v[68:71], v[120:123], a[156:159], v[68:71]
    v_cvt_pk_bf16_f32 v145, v34, v35
    v_cvt_pk_bf16_f32 v157, v54, v55
    v_mfma_f32_16x16x32_bf16 v[72:75], v[124:127], a[76:79], v[72:75]
    v_cvt_pk_bf16_f32 v146, v36, v37
    v_cvt_pk_bf16_f32 v158, v56, v57
    v_mfma_f32_16x16x32_bf16 v[92:95], v[124:127], a[156:159], v[92:95]
    v_cvt_pk_bf16_f32 v147, v38, v39
    s_waitcnt lgkmcnt(4)
    v_mfma_f32_16x16x32_bf16 v[76:79], v[128:131], a[76:79], v[76:79]
    v_cvt_pk_bf16_f32 v159, v58, v59
    buffer_load_dwordx4 v16, s[56:59], s47 offen offset:0 lds
    v_mfma_f32_16x16x32_bf16 v[96:99], v[128:131], a[156:159], v[96:99]
    v_cvt_pk_bf16_f32 v148, v40, v41
    v_cvt_pk_bf16_f32 v160, v60, v61
    v_mfma_f32_16x16x32_bf16 v[80:83], v[132:135], a[76:79], v[80:83]
    v_cvt_pk_bf16_f32 v149, v42, v43
    v_cvt_pk_bf16_f32 v161, v62, v63
    v_mfma_f32_16x16x32_bf16 v[100:103], v[132:135], a[156:159], v[100:103]
    v_cvt_pk_bf16_f32 v150, v44, v45
    s_waitcnt lgkmcnt(0)
    v_mfma_f32_16x16x32_bf16 v[84:87], v[136:139], a[76:79], v[84:87]
    v_cvt_pk_bf16_f32 v162, v64, v65
    v_cvt_pk_bf16_f32 v151, v46, v47
    v_mfma_f32_16x16x32_bf16 v[104:107], v[136:139], a[156:159], v[104:107]
    v_cvt_pk_bf16_f32 v163, v66, v67
    v_cvt_pk_bf16_f32 v152, v48, v49
    v_mfma_f32_16x16x32_bf16 v[88:91], v[140:143], a[76:79], v[88:91]
    v_cvt_pk_bf16_f32 v164, v68, v69
    v_cvt_pk_bf16_f32 v153, v50, v51
    v_mfma_f32_16x16x32_bf16 v[108:111], v[140:143], a[156:159], v[108:111]
    v_cvt_pk_bf16_f32 v165, v70, v71
    v_mfma_f32_16x16x32_bf16 v[168:171], a[160:163], v[144:147], 0
    v_mov_b32 v122, 0x3f803f80
    v_mov_b32 v123, 0x3f803f80
    v_mfma_f32_16x16x32_bf16 v[172:175], a[172:175], v[144:147], 0
    v_mov_b32 v134, 0x3f803f80
    v_mov_b32 v135, 0x3f803f80
    v_mfma_f32_16x16x32_bf16 v[176:179], a[184:187], v[144:147], 0
    v_cvt_pk_bf16_f32 v112, v72, v73
    v_cvt_pk_bf16_f32 v113, v74, v75
    v_mfma_f32_16x16x32_bf16 v[180:183], a[196:199], v[144:147], 0
    v_cvt_pk_bf16_f32 v114, v76, v77
    v_cvt_pk_bf16_f32 v115, v78, v79
    v_mfma_f32_16x16x32_bf16 v[184:187], a[208:211], v[144:147], 0
    v_cvt_pk_bf16_f32 v116, v80, v81
    v_cvt_pk_bf16_f32 v117, v82, v83
    v_mfma_f32_16x16x32_bf16 v[168:171], a[164:167], v[148:151], v[168:171]
    ds_write_b128 v21, v[112:115] offset:0
    v_mfma_f32_16x16x32_bf16 v[172:175], a[176:179], v[148:151], v[172:175]
    v_cvt_pk_bf16_f32 v118, v84, v85
    v_cvt_pk_bf16_f32 v119, v86, v87
    v_mfma_f32_16x16x32_bf16 v[176:179], a[188:191], v[148:151], v[176:179]
    v_cvt_pk_bf16_f32 v120, v88, v89
    v_cvt_pk_bf16_f32 v121, v90, v91
    v_mfma_f32_16x16x32_bf16 v[180:183], a[200:203], v[148:151], v[180:183]
    v_cvt_pk_bf16_f32 v124, v92, v93
    v_cvt_pk_bf16_f32 v125, v94, v95
    v_mfma_f32_16x16x32_bf16 v[184:187], a[212:215], v[148:151], v[184:187]
    ds_write_b128 v21, v[116:119] offset:16
    v_mfma_f32_16x16x32_bf16 v[168:171], a[168:171], v[152:155], v[168:171]
    v_cvt_pk_bf16_f32 v126, v96, v97
    v_cvt_pk_bf16_f32 v127, v98, v99
    v_mfma_f32_16x16x32_bf16 v[172:175], a[180:183], v[152:155], v[172:175]
    v_cvt_pk_bf16_f32 v128, v100, v101
    v_cvt_pk_bf16_f32 v129, v102, v103
    v_mfma_f32_16x16x32_bf16 v[176:179], a[192:195], v[152:155], v[176:179]
    v_cvt_pk_bf16_f32 v130, v104, v105
    v_cvt_pk_bf16_f32 v131, v106, v107
    v_mfma_f32_16x16x32_bf16 v[180:183], a[204:207], v[152:155], v[180:183]
    ds_write_b128 v21, v[120:123] offset:32
    v_mfma_f32_16x16x32_bf16 v[184:187], a[216:219], v[152:155], v[184:187]
    v_cvt_pk_bf16_f32 v132, v108, v109
    v_cvt_pk_bf16_f32 v133, v110, v111
    v_mfma_f32_16x16x32_bf16 v[188:191], a[160:163], v[156:159], 0
    v_mfma_f32_16x16x32_bf16 v[192:195], a[172:175], v[156:159], 0
    ds_write_b128 v21, v[124:127] offset:768
    v_mfma_f32_16x16x32_bf16 v[196:199], a[184:187], v[156:159], 0
    v_mfma_f32_16x16x32_bf16 v[200:203], a[196:199], v[156:159], 0
    v_max3_f32 v208, v168, v169, v170
    v_min3_f32 v209, v168, v169, v170
    v_mfma_f32_16x16x32_bf16 v[204:207], a[208:211], v[156:159], 0
    v_max3_f32 v208, v208, v171, v172
    v_min3_f32 v209, v209, v171, v172
    v_mfma_f32_16x16x32_bf16 v[188:191], a[164:167], v[160:163], v[188:191]
    ds_write_b128 v21, v[128:131] offset:784
    v_mfma_f32_16x16x32_bf16 v[192:195], a[176:179], v[160:163], v[192:195]
    v_max3_f32 v208, v208, v173, v174
    v_min3_f32 v209, v209, v173, v174
    v_mfma_f32_16x16x32_bf16 v[196:199], a[188:191], v[160:163], v[196:199]
    v_max3_f32 v208, v208, v175, v176
    v_min3_f32 v209, v209, v175, v176
    v_mfma_f32_16x16x32_bf16 v[200:203], a[200:203], v[160:163], v[200:203]
    v_max3_f32 v208, v208, v177, v178
    v_min3_f32 v209, v209, v177, v178
    v_mfma_f32_16x16x32_bf16 v[204:207], a[212:215], v[160:163], v[204:207]
    v_max3_f32 v208, v208, v179, v180
    v_min3_f32 v209, v209, v179, v180
    v_mfma_f32_16x16x32_bf16 v[188:191], a[168:171], v[164:167], v[188:191]
    ds_write_b128 v21, v[132:135] offset:800
    v_mfma_f32_16x16x32_bf16 v[192:195], a[180:183], v[164:167], v[192:195]
    v_max3_f32 v208, v208, v181, v182
    v_min3_f32 v209, v209, v181, v182
    v_mfma_f32_16x16x32_bf16 v[196:199], a[192:195], v[164:167], v[196:199]
    v_max3_f32 v208, v208, v183, v184
    v_min3_f32 v209, v209, v183, v184
    v_mfma_f32_16x16x32_bf16 v[200:203], a[204:207], v[164:167], v[200:203]
    v_max3_f32 v208, v208, v185, v186
    v_min3_f32 v209, v209, v185, v186
    v_mfma_f32_16x16x32_bf16 v[204:207], a[216:219], v[164:167], v[204:207]
    v_max_f32 v208, v208, v187
    v_min_f32 v209, v209, v187
    v_mul_f32 v208, s73, v208
    v_mul_f32 v209, s72, v209
    s_waitcnt vmcnt(5)
    s_barrier
    v_max3_f32 v210, v188, v189, v190
    v_min3_f32 v211, v188, v189, v190
    v_max3_f32 v210, v210, v191, v192
    v_min3_f32 v211, v211, v191, v192
    v_max3_f32 v210, v210, v193, v194
    v_min3_f32 v211, v211, v193, v194
    v_max3_f32 v210, v210, v195, v196
    v_min3_f32 v211, v211, v195, v196
    v_max3_f32 v210, v210, v197, v198
    v_min3_f32 v211, v211, v197, v198
    v_max3_f32 v210, v210, v199, v200
    v_min3_f32 v211, v211, v199, v200
    v_max3_f32 v210, v210, v201, v202
    v_min3_f32 v211, v211, v201, v202
    v_max3_f32 v210, v210, v203, v204
    v_min3_f32 v211, v211, v203, v204
    v_max3_f32 v210, v210, v205, v206
    v_min3_f32 v211, v211, v205, v206
    v_max_f32 v210, v210, v207
    v_min_f32 v211, v211, v207
    v_mul_f32 v210, s73, v210
    v_mul_f32 v211, s72, v211
    buffer_load_dword v31, v26, s[12:15], 0 offen sc1
    v_pk_fma_f32 v[32:33], v[168:169], s[72:73], v[208:209] op_sel:[0,0,0] op_sel_hi:[0,1,1]
    v_pk_fma_f32 v[34:35], v[168:169], s[72:73], v[208:209] op_sel:[1,0,0] op_sel_hi:[1,1,1]
    v_pk_fma_f32 v[36:37], v[170:171], s[72:73], v[208:209] op_sel:[0,0,0] op_sel_hi:[0,1,1]
    v_pk_fma_f32 v[38:39], v[170:171], s[72:73], v[208:209] op_sel:[1,0,0] op_sel_hi:[1,1,1]
    v_pk_fma_f32 v[40:41], v[172:173], s[72:73], v[208:209] op_sel:[0,0,0] op_sel_hi:[0,1,1]
    v_pk_fma_f32 v[42:43], v[172:173], s[72:73], v[208:209] op_sel:[1,0,0] op_sel_hi:[1,1,1]
    s_add_u32 s47, s79, 983040
    s_add_u32 m0, s48, 51712
    s_nop 0
    s_nop 0
    buffer_load_dwordx4 v12, s[56:59], s47 offen offset:0 lds
    v_pk_fma_f32 v[44:45], v[174:175], s[72:73], v[208:209] op_sel:[0,0,0] op_sel_hi:[0,1,1]
    v_pk_fma_f32 v[46:47], v[174:175], s[72:73], v[208:209] op_sel:[1,0,0] op_sel_hi:[1,1,1]
    v_pk_fma_f32 v[48:49], v[176:177], s[72:73], v[208:209] op_sel:[0,0,0] op_sel_hi:[0,1,1]
    v_pk_fma_f32 v[50:51], v[176:177], s[72:73], v[208:209] op_sel:[1,0,0] op_sel_hi:[1,1,1]
    v_pk_fma_f32 v[52:53], v[178:179], s[72:73], v[208:209] op_sel:[0,0,0] op_sel_hi:[0,1,1]
    v_pk_fma_f32 v[54:55], v[178:179], s[72:73], v[208:209] op_sel:[1,0,0] op_sel_hi:[1,1,1]
    v_pk_fma_f32 v[56:57], v[180:181], s[72:73], v[208:209] op_sel:[0,0,0] op_sel_hi:[0,1,1]
    v_pk_fma_f32 v[58:59], v[180:181], s[72:73], v[208:209] op_sel:[1,0,0] op_sel_hi:[1,1,1]
    v_pk_fma_f32 v[60:61], v[182:183], s[72:73], v[208:209] op_sel:[0,0,0] op_sel_hi:[0,1,1]
WA_P2:
    s_cbranch_execz WA_R
    s_nop 0
    v_pk_fma_f32 v[62:63], v[182:183], s[72:73], v[208:209] op_sel:[1,0,0] op_sel_hi:[1,1,1]
    v_pk_fma_f32 v[64:65], v[184:185], s[72:73], v[208:209] op_sel:[0,0,0] op_sel_hi:[0,1,1]
    v_pk_fma_f32 v[66:67], v[184:185], s[72:73], v[208:209] op_sel:[1,0,0] op_sel_hi:[1,1,1]
    v_pk_fma_f32 v[68:69], v[186:187], s[72:73], v[208:209] op_sel:[0,0,0] op_sel_hi:[0,1,1]
    v_pk_fma_f32 v[70:71], v[186:187], s[72:73], v[208:209] op_sel:[1,0,0] op_sel_hi:[1,1,1]
    v_exp_f32 v32, v32
    buffer_load_dwordx4 v13, s[56:59], s47 offen offset:1024 lds
    v_exp_f32 v33, v33
    v_exp_f32 v34, v34
    v_exp_f32 v35, v35
    v_exp_f32 v36, v36
    v_exp_f32 v37, v37
    v_pk_add_f32 v[208:209], v[32:33], v[34:35]
    v_exp_f32 v38, v38
    v_exp_f32 v39, v39
    v_pk_add_f32 v[208:209], v[208:209], v[36:37]
    v_exp_f32 v40, v40
    v_exp_f32 v41, v41
    v_pk_add_f32 v[208:209], v[208:209], v[38:39]
    v_exp_f32 v42, v42
    v_exp_f32 v43, v43
    v_pk_add_f32 v[208:209], v[208:209], v[40:41]
    buffer_load_dwordx4 v14, s[56:59], s47 offen offset:2048 lds
    v_exp_f32 v44, v44
    v_exp_f32 v45, v45
    v_pk_add_f32 v[208:209], v[208:209], v[42:43]
    v_exp_f32 v46, v46
    v_exp_f32 v47, v47
    v_pk_add_f32 v[208:209], v[208:209], v[44:45]
    v_exp_f32 v48, v48
    v_exp_f32 v49, v49
    v_pk_add_f32 v[208:209], v[208:209], v[46:47]
    v_exp_f32 v50, v50
    v_exp_f32 v51, v51
    v_pk_add_f32 v[208:209], v[208:209], v[48:49]
    v_exp_f32 v52, v52
    v_exp_f32 v53, v53
    v_pk_add_f32 v[208:209], v[208:209], v[50:51]
    buffer_load_dwordx4 v15, s[56:59], s47 offen offset:3072 lds
    v_exp_f32 v54, v54
    v_exp_f32 v55, v55
    v_pk_add_f32 v[208:209], v[208:209], v[52:53]
    v_exp_f32 v56, v56
    v_exp_f32 v57, v57
    v_pk_add_f32 v[208:209], v[208:209], v[54:55]
    v_exp_f32 v58, v58
    v_exp_f32 v59, v59
    v_pk_add_f32 v[208:209], v[208:209], v[56:57]
    v_exp_f32 v60, v60
    v_exp_f32 v61, v61
    v_pk_add_f32 v[208:209], v[208:209], v[58:59]
    v_exp_f32 v62, v62
    v_exp_f32 v63, v63
    v_pk_add_f32 v[208:209], v[208:209], v[60:61]
    s_add_u32 m0, s48, 55808
    s_nop 0
    s_nop 0
    buffer_load_dwordx4 v16, s[56:59], s47 offen offset:0 lds
    v_exp_f32 v64, v64
    v_exp_f32 v65, v65
    v_pk_add_f32 v[208:209], v[208:209], v[62:63]
    v_exp_f32 v66, v66
    v_exp_f32 v67, v67
    v_pk_add_f32 v[208:209], v[208:209], v[64:65]
    v_exp_f32 v68, v68
    v_exp_f32 v69, v69
    v_pk_add_f32 v[208:209], v[208:209], v[66:67]
    v_exp_f32 v70, v70
    v_exp_f32 v71, v71
    v_pk_add_f32 v[208:209], v[208:209], v[68:69]
    v_pk_add_f32 v[208:209], v[208:209], v[70:71]
    v_rcp_f32 v208, v208
    v_rcp_f32_e64 v209, v209
    s_nop 0
    v_pk_mul_f32 v[32:33], v[32:33], v[208:209]
    v_pk_mul_f32 v[34:35], v[34:35], v[208:209]
    v_cvt_pk_bf16_f32 v212, v32, v33
    v_pk_mul_f32 v[40:41], v[40:41], v[208:209]
    v_cvt_pk_bf16_f32 v213, v34, v35
    v_pk_mul_f32 v[42:43], v[42:43], v[208:209]
    v_cvt_pk_bf16_f32 v214, v40, v41
    v_pk_mul_f32 v[48:49], v[48:49], v[208:209]
    v_cvt_pk_bf16_f32 v215, v42, v43
    ds_write_b128 v22, v[212:215] offset:0
    v_pk_mul_f32 v[50:51], v[50:51], v[208:209]
    v_cvt_pk_bf16_f32 v216, v48, v49
    v_pk_mul_f32 v[56:57], v[56:57], v[208:209]
    v_cvt_pk_bf16_f32 v217, v50, v51
    v_pk_mul_f32 v[58:59], v[58:59], v[208:209]
    v_cvt_pk_bf16_f32 v218, v56, v57
    v_pk_mul_f32 v[36:37], v[36:37], v[208:209]
    v_cvt_pk_bf16_f32 v219, v58, v59
    ds_write_b128 v22, v[216:219] offset:16
    v_pk_mul_f32 v[38:39], v[38:39], v[208:209]
    v_cvt_pk_bf16_f32 v220, v36, v37
    v_pk_mul_f32 v[44:45], v[44:45], v[208:209]
    v_cvt_pk_bf16_f32 v221, v38, v39
    v_pk_mul_f32 v[46:47], v[46:47], v[208:209]
    v_cvt_pk_bf16_f32 v222, v44, v45
    v_pk_mul_f32 v[52:53], v[52:53], v[208:209]
    v_cvt_pk_bf16_f32 v223, v46, v47
    ds_write_b128 v22, v[220:223] offset:32
    v_pk_mul_f32 v[54:55], v[54:55], v[208:209]
    v_cvt_pk_bf16_f32 v224, v52, v53
    v_pk_mul_f32 v[60:61], v[60:61], v[208:209]
    v_cvt_pk_bf16_f32 v225, v54, v55
    v_pk_mul_f32 v[62:63], v[62:63], v[208:209]
    v_cvt_pk_bf16_f32 v226, v60, v61
    v_pk_mul_f32 v[64:65], v[64:65], v[208:209]
    v_cvt_pk_bf16_f32 v227, v62, v63
    ds_write_b128 v22, v[224:227] offset:48
    v_pk_mul_f32 v[66:67], v[66:67], v[208:209]
    v_cvt_pk_bf16_f32 v228, v64, v65
    v_pk_mul_f32 v[68:69], v[68:69], v[208:209]
    v_cvt_pk_bf16_f32 v229, v66, v67
    v_pk_mul_f32 v[70:71], v[70:71], v[208:209]
    v_cvt_pk_bf16_f32 v230, v68, v69
    v_cvt_pk_bf16_f32 v231, v70, v71
    ds_write_b128 v22, v[228:231] offset:64
    v_pk_fma_f32 v[32:33], v[188:189], s[72:73], v[210:211] op_sel:[0,0,0] op_sel_hi:[0,1,1]
    s_waitcnt vmcnt(5)
    v_cmp_eq_u32 vcc, 0, v31
    v_pk_fma_f32 v[34:35], v[188:189], s[72:73], v[210:211] op_sel:[1,0,0] op_sel_hi:[1,1,1]
    v_pk_fma_f32 v[36:37], v[190:191], s[72:73], v[210:211] op_sel:[0,0,0] op_sel_hi:[0,1,1]
    v_pk_fma_f32 v[38:39], v[190:191], s[72:73], v[210:211] op_sel:[1,0,0] op_sel_hi:[1,1,1]
    v_pk_fma_f32 v[40:41], v[192:193], s[72:73], v[210:211] op_sel:[0,0,0] op_sel_hi:[0,1,1]
    v_pk_fma_f32 v[42:43], v[192:193], s[72:73], v[210:211] op_sel:[1,0,0] op_sel_hi:[1,1,1]
    s_add_u32 s47, s79, 1474560
    s_add_u32 m0, s48, 72192
    s_nop 0
    buffer_load_dwordx4 v12, s[56:59], s47 offen offset:0 lds
    v_pk_fma_f32 v[44:45], v[194:195], s[72:73], v[210:211] op_sel:[0,0,0] op_sel_hi:[0,1,1]
    v_pk_fma_f32 v[46:47], v[194:195], s[72:73], v[210:211] op_sel:[1,0,0] op_sel_hi:[1,1,1]
    v_pk_fma_f32 v[48:49], v[196:197], s[72:73], v[210:211] op_sel:[0,0,0] op_sel_hi:[0,1,1]
    s_cbranch_vccnz A_cnt_slow
A_cnt_back:
    v_pk_fma_f32 v[50:51], v[196:197], s[72:73], v[210:211] op_sel:[1,0,0] op_sel_hi:[1,1,1]
    v_pk_fma_f32 v[52:53], v[198:199], s[72:73], v[210:211] op_sel:[0,0,0] op_sel_hi:[0,1,1]
    v_pk_fma_f32 v[54:55], v[198:199], s[72:73], v[210:211] op_sel:[1,0,0] op_sel_hi:[1,1,1]
    v_pk_fma_f32 v[56:57], v[200:201], s[72:73], v[210:211] op_sel:[0,0,0] op_sel_hi:[0,1,1]
    v_pk_fma_f32 v[58:59], v[200:201], s[72:73], v[210:211] op_sel:[1,0,0] op_sel_hi:[1,1,1]
    v_pk_fma_f32 v[60:61], v[202:203], s[72:73], v[210:211] op_sel:[0,0,0] op_sel_hi:[0,1,1]
    v_pk_fma_f32 v[62:63], v[202:203], s[72:73], v[210:211] op_sel:[1,0,0] op_sel_hi:[1,1,1]
    v_pk_fma_f32 v[64:65], v[204:205], s[72:73], v[210:211] op_sel:[0,0,0] op_sel_hi:[0,1,1]
    v_pk_fma_f32 v[66:67], v[204:205], s[72:73], v[210:211] op_sel:[1,0,0] op_sel_hi:[1,1,1]
    v_pk_fma_f32 v[68:69], v[206:207], s[72:73], v[210:211] op_sel:[0,0,0] op_sel_hi:[0,1,1]
    v_pk_fma_f32 v[70:71], v[206:207], s[72:73], v[210:211] op_sel:[1,0,0] op_sel_hi:[1,1,1]
    v_exp_f32 v32, v32
    buffer_load_dwordx4 v13, s[56:59], s47 offen offset:1024 lds
    v_exp_f32 v33, v33
    v_exp_f32 v34, v34
    v_exp_f32 v35, v35
    v_exp_f32 v36, v36
    v_exp_f32 v37, v37
    v_pk_add_f32 v[210:211], v[32:33], v[34:35]
    v_exp_f32 v38, v38
    v_exp_f32 v39, v39
    v_pk_add_f32 v[210:211], v[210:211], v[36:37]
    v_exp_f32 v40, v40
    v_exp_f32 v41, v41
    v_pk_add_f32 v[210:211], v[210:211], v[38:39]
    v_exp_f32 v42, v42
    v_exp_f32 v43, v43
    v_pk_add_f32 v[210:211], v[210:211], v[40:41]
    buffer_load_dwordx4 v14, s[56:59], s47 offen offset:2048 lds
    v_exp_f32 v44, v44
    v_exp_f32 v45, v45
    v_pk_add_f32 v[210:211], v[210:211], v[42:43]
    v_exp_f32 v46, v46
    v_exp_f32 v47, v47
    v_pk_add_f32 v[210:211], v[210:211], v[44:45]
    v_exp_f32 v48, v48
    v_exp_f32 v49, v49
    v_pk_add_f32 v[210:211], v[210:211], v[46:47]
    v_exp_f32 v50, v50
    v_exp_f32 v51, v51
    v_pk_add_f32 v[210:211], v[210:211], v[48:49]
    v_exp_f32 v52, v52
    v_exp_f32 v53, v53
    v_pk_add_f32 v[210:211], v[210:211], v[50:51]
    buffer_load_dwordx4 v15, s[56:59], s47 offen offset:3072 lds
    v_exp_f32 v54, v54
    v_exp_f32 v55, v55
    v_pk_add_f32 v[210:211], v[210:211], v[52:53]
    v_exp_f32 v56, v56
    v_exp_f32 v57, v57
    v_pk_add_f32 v[210:211], v[210:211], v[54:55]
    v_exp_f32 v58, v58
    v_exp_f32 v59, v59
    v_pk_add_f32 v[210:211], v[210:211], v[56:57]
    v_exp_f32 v60, v60
    v_exp_f32 v61, v61
    v_pk_add_f32 v[210:211], v[210:211], v[58:59]
    v_exp_f32 v62, v62
    v_exp_f32 v63, v63
    v_pk_add_f32 v[210:211], v[210:211], v[60:61]
    s_add_u32 m0, s48, 76288
    s_nop 0
    s_nop 0
    buffer_load_dwordx4 v16, s[56:59], s47 offen offset:0 lds
    v_exp_f32 v64, v64
    v_exp_f32 v65, v65
    v_pk_add_f32 v[210:211], v[210:211], v[62:63]
    v_exp_f32 v66, v66
    v_exp_f32 v67, v67
    v_pk_add_f32 v[210:211], v[210:211], v[64:65]
    v_exp_f32 v68, v68
    v_exp_f32 v69, v69
    v_pk_add_f32 v[210:211], v[210:211], v[66:67]
    v_exp_f32 v70, v70
    v_exp_f32 v71, v71
    v_pk_add_f32 v[210:211], v[210:211], v[68:69]
    v_pk_add_f32 v[210:211], v[210:211], v[70:71]
    v_rcp_f32 v210, v210
    v_rcp_f32 v211, v211
    ds_read_b64_tr_b16 v[112:113], v17 offset:10752
    ds_read_b64_tr_b16 v[114:115], v17 offset:12032
    ds_read_b64_tr_b16 v[116:117], v17 offset:10760
    ds_read_b64_tr_b16 v[118:119], v17 offset:12040
    ds_read_b64_tr_b16 v[120:121], v17 offset:10768
    ds_read_b64_tr_b16 v[122:123], v17 offset:12048
    ds_read_b64_tr_b16 v[124:125], v17 offset:10776
    ds_read_b64_tr_b16 v[126:127], v17 offset:12056
    ds_read_b64_tr_b16 v[128:129], v17 offset:10784
    ds_read_b64_tr_b16 v[130:131], v17 offset:12064
    ds_read_b64_tr_b16 v[132:133], v17 offset:15872
    ds_read_b64_tr_b16 v[134:135], v17 offset:17152
    v_pk_mul_f32 v[32:33], v[32:33], v[210:211]
    v_pk_mul_f32 v[34:35], v[34:35], v[210:211]
    v_cvt_pk_bf16_f32 v212, v32, v33
    v_pk_mul_f32 v[40:41], v[40:41], v[210:211]
    v_cvt_pk_bf16_f32 v213, v34, v35
    v_pk_mul_f32 v[42:43], v[42:43], v[210:211]
    v_cvt_pk_bf16_f32 v214, v40, v41
    v_pk_mul_f32 v[48:49], v[48:49], v[210:211]
    v_cvt_pk_bf16_f32 v215, v42, v43
    ds_write_b128 v22, v[212:215] offset:1280
    v_pk_mul_f32 v[50:51], v[50:51], v[210:211]
    v_cvt_pk_bf16_f32 v216, v48, v49
    v_pk_mul_f32 v[56:57], v[56:57], v[210:211]
    v_cvt_pk_bf16_f32 v217, v50, v51
    v_pk_mul_f32 v[58:59], v[58:59], v[210:211]
    v_cvt_pk_bf16_f32 v218, v56, v57
    v_pk_mul_f32 v[36:37], v[36:37], v[210:211]
    v_cvt_pk_bf16_f32 v219, v58, v59
    ds_write_b128 v22, v[216:219] offset:1296
    v_pk_mul_f32 v[38:39], v[38:39], v[210:211]
    v_cvt_pk_bf16_f32 v220, v36, v37
    v_pk_mul_f32 v[44:45], v[44:45], v[210:211]
    v_cvt_pk_bf16_f32 v221, v38, v39
    v_pk_mul_f32 v[46:47], v[46:47], v[210:211]
    v_cvt_pk_bf16_f32 v222, v44, v45
    v_pk_mul_f32 v[52:53], v[52:53], v[210:211]
    v_cvt_pk_bf16_f32 v223, v46, v47
    ds_write_b128 v22, v[220:223] offset:1312
    v_pk_mul_f32 v[54:55], v[54:55], v[210:211]
    v_cvt_pk_bf16_f32 v224, v52, v53
    v_pk_mul_f32 v[60:61], v[60:61], v[210:211]
    v_cvt_pk_bf16_f32 v225, v54, v55
    v_pk_mul_f32 v[62:63], v[62:63], v[210:211]
    v_cvt_pk_bf16_f32 v226, v60, v61
    v_pk_mul_f32 v[64:65], v[64:65], v[210:211]
    v_cvt_pk_bf16_f32 v227, v62, v63
    ds_write_b128 v22, v[224:227] offset:1328
    v_pk_mul_f32 v[66:67], v[66:67], v[210:211]
    v_cvt_pk_bf16_f32 v228, v64, v65
    v_pk_mul_f32 v[68:69], v[68:69], v[210:211]
    v_cvt_pk_bf16_f32 v229, v66, v67
    v_pk_mul_f32 v[70:71], v[70:71], v[210:211]
    v_cvt_pk_bf16_f32 v230, v68, v69
    v_cvt_pk_bf16_f32 v231, v70, v71
    ds_write_b128 v22, v[228:231] offset:1344
    s_waitcnt lgkmcnt(13)
    v_mfma_f32_16x16x32_bf16 v[72:75], v[112:115], a[0:3], 0
    ds_read_b64_tr_b16 v[136:137], v17 offset:15880
    v_mfma_f32_16x16x32_bf16 v[92:95], v[112:115], a[80:83], 0
    ds_read_b64_tr_b16 v[138:139], v17 offset:17160
    v_mfma_f32_16x16x32_bf16 v[76:79], v[116:119], a[0:3], 0
    ds_read_b64_tr_b16 v[140:141], v17 offset:15888
    v_mfma_f32_16x16x32_bf16 v[96:99], v[116:119], a[80:83], 0
    ds_read_b64_tr_b16 v[142:143], v17 offset:17168
    s_waitcnt lgkmcnt(13)
    buffer_store_dword v154, v154, s[60:63], s76 offen offset:2048 sc1
    s_waitcnt lgkmcnt(4)
    s_barrier
    ds_read_b64_tr_b16 v[32:33], v23 offset:0
    ds_read_b64_tr_b16 v[34:35], v23 offset:48
    ds_read_b64_tr_b16 v[40:41], v24 offset:0
    ds_read_b64_tr_b16 v[42:43], v24 offset:80
    ds_read_b64_tr_b16 v[44:45], v24 offset:32
    ds_read_b64_tr_b16 v[46:47], v24 offset:112
    ds_read_b64_tr_b16 v[48:49], v24 offset:64
    ds_read_b64_tr_b16 v[50:51], v24 offset:144
    ds_read_b64_tr_b16 v[36:37], v23 offset:32
    ds_read_b64_tr_b16 v[38:39], v23 offset:80
    ds_read_b64_tr_b16 v[52:53], v23 offset:1536
    ds_read_b64_tr_b16 v[54:55], v23 offset:1584
    ds_read_b64_tr_b16 v[60:61], v24 offset:2560
    ds_read_b64_tr_b16 v[62:63], v24 offset:2640
    ds_read_b64_tr_b16 v[64:65], v24 offset:2592
    ds_read_b64_tr_b16 v[66:67], v24 offset:2672
    ds_read_b64_tr_b16 v[68:69], v24 offset:2624
    ds_read_b64_tr_b16 v[70:71], v24 offset:2704
    ds_read_b64_tr_b16 v[56:57], v23 offset:1568
    ds_read_b64_tr_b16 v[58:59], v23 offset:1616
    s_waitcnt lgkmcnt(10)
    v_mfma_f32_16x16x32_bf16 v[208:211], v[40:43], v[32:35], 0
    ds_read_b64_tr_b16 v[168:169], v23 offset:3072
    ds_read_b64_tr_b16 v[170:171], v23 offset:3120
    v_mfma_f32_16x16x32_bf16 v[212:215], v[44:47], v[32:35], 0
    ds_read_b64_tr_b16 v[176:177], v24 offset:5120
    ds_read_b64_tr_b16 v[178:179], v24 offset:5200
    v_mfma_f32_16x16x32_bf16 v[216:219], v[48:51], v[32:35], 0
    ds_read_b64_tr_b16 v[180:181], v24 offset:5152
    ds_read_b64_tr_b16 v[182:183], v24 offset:5232
    v_mfma_f32_16x16x32_bf16 v[220:223], v[40:43], v[36:39], 0
    ds_read_b64_tr_b16 v[184:185], v24 offset:5184
    ds_read_b64_tr_b16 v[186:187], v24 offset:5264
    v_mfma_f32_16x16x32_bf16 v[224:227], v[44:47], v[36:39], 0
    ds_read_b64_tr_b16 v[172:173], v23 offset:3104
    ds_read_b64_tr_b16 v[174:175], v23 offset:3152
    v_mfma_f32_16x16x32_bf16 v[228:231], v[48:51], v[36:39], 0
    s_waitcnt lgkmcnt(10)
    v_mfma_f32_16x16x32_bf16 v[208:211], v[60:63], v[52:55], v[208:211]
    ds_read_b64_tr_b16 v[188:189], v23 offset:4608
    ds_read_b64_tr_b16 v[190:191], v23 offset:4656
    v_mfma_f32_16x16x32_bf16 v[212:215], v[64:67], v[52:55], v[212:215]
    ds_read_b64_tr_b16 v[196:197], v24 offset:7680
    ds_read_b64_tr_b16 v[198:199], v24 offset:7760
    v_mfma_f32_16x16x32_bf16 v[216:219], v[68:71], v[52:55], v[216:219]
    ds_read_b64_tr_b16 v[200:201], v24 offset:7712
    ds_read_b64_tr_b16 v[202:203], v24 offset:7792
    v_mfma_f32_16x16x32_bf16 v[220:223], v[60:63], v[56:59], v[220:223]
    ds_read_b64_tr_b16 v[204:205], v24 offset:7744
    ds_read_b64_tr_b16 v[206:207], v24 offset:7824
    v_mfma_f32_16x16x32_bf16 v[224:227], v[64:67], v[56:59], v[224:227]
    ds_read_b64_tr_b16 v[192:193], v23 offset:4640
    ds_read_b64_tr_b16 v[194:195], v23 offset:4688
    v_mfma_f32_16x16x32_bf16 v[228:231], v[68:71], v[56:59], v[228:231]
    s_waitcnt lgkmcnt(10)
    v_mfma_f32_16x16x32_bf16 v[208:211], v[176:179], v[168:171], v[208:211]
    v_mul_u32_u24 v237, 20, v3
    v_add_lshl_u32 v237, v237, v4, 7
    v_mfma_f32_16x16x32_bf16 v[212:215], v[180:183], v[168:171], v[212:215]
    v_lshl_add_u32 v237, v5, 3, v237
    v_bfe_u32 v238, v1, 3, 2
    v_mfma_f32_16x16x32_bf16 v[216:219], v[184:187], v[168:171], v[216:219]
    v_xor_b32 v239, 0, v238
    v_lshl_add_u32 v244, v239, 5, v237
    v_mfma_f32_16x16x32_bf16 v[220:223], v[176:179], v[172:175], v[220:223]
    v_add_u32 v248, 117248, v244
    v_xor_b32 v239, 1, v238
    v_mfma_f32_16x16x32_bf16 v[224:227], v[180:183], v[172:175], v[224:227]
    v_lshl_add_u32 v245, v239, 5, v237
    v_add_u32 v249, 117248, v245
    v_mfma_f32_16x16x32_bf16 v[228:231], v[184:187], v[172:175], v[228:231]
    v_xor_b32 v239, 2, v238
    v_lshl_add_u32 v246, v239, 5, v237
    s_waitcnt lgkmcnt(0)
    v_mfma_f32_16x16x32_bf16 v[208:211], v[196:199], v[188:191], v[208:211]
    v_add_u32 v250, 117248, v246
    v_xor_b32 v239, 3, v238
    v_mfma_f32_16x16x32_bf16 v[212:215], v[200:203], v[188:191], v[212:215]
    v_lshl_add_u32 v247, v239, 5, v237
    v_add_u32 v251, 117248, v247
    v_mfma_f32_16x16x32_bf16 v[216:219], v[204:207], v[188:191], v[216:219]
    v_lshlrev_b32 v252, 4, v1
    v_lshlrev_b32 v253, 3, v1
    v_mfma_f32_16x16x32_bf16 v[220:223], v[196:199], v[192:195], v[220:223]
    v_add_u32 v253, 4096, v253
    s_lshl2_add_u32 s45, s38, s32
    v_mfma_f32_16x16x32_bf16 v[224:227], v[200:203], v[192:195], v[224:227]
    s_mul_i32 s75, s45, 20992
    s_add_u32 s75, s75, 147456
    v_mfma_f32_16x16x32_bf16 v[228:231], v[204:207], v[192:195], v[228:231]
    s_lshl2_add_u32 s45, s40, s32
    s_mul_i32 s45, s45, 81920
    v_mfma_f32_16x16x32_bf16 v[80:83], v[120:123], a[0:3], 0
    ds_read_b64_tr_b16 v[112:113], v17 offset:15896
    v_mfma_f32_16x16x32_bf16 v[100:103], v[120:123], a[80:83], 0
    ds_read_b64_tr_b16 v[114:115], v17 offset:17176
    v_mfma_f32_16x16x32_bf16 v[84:87], v[124:127], a[0:3], 0
    ds_read_b64_tr_b16 v[116:117], v17 offset:15904
    v_mfma_f32_16x16x32_bf16 v[104:107], v[124:127], a[80:83], 0
    s_nop 0
    ds_read_b64_tr_b16 v[118:119], v17 offset:17184
    s_waitcnt vmcnt(1)
    s_barrier
    v_cvt_pk_bf16_f32 v32, v208, v209
    v_cvt_pk_bf16_f32 v33, v210, v211
    v_cvt_pk_bf16_f32 v34, v212, v213
    v_cvt_pk_bf16_f32 v35, v214, v215
    v_cvt_pk_bf16_f32 v40, v216, v217
    v_cvt_pk_bf16_f32 v41, v218, v219
    v_cvt_pk_bf16_f32 v36, v220, v221
    v_cvt_pk_bf16_f32 v37, v222, v223
    v_cvt_pk_bf16_f32 v38, v224, v225
    v_cvt_pk_bf16_f32 v39, v226, v227
    v_cvt_pk_bf16_f32 v42, v228, v229
    v_cvt_pk_bf16_f32 v43, v230, v231
    v_min_u32 v32, -2, v32
    v_min_u32 v36, -2, v36
    v_permlane16_swap_b32 v40, v42
    v_permlane16_swap_b32 v41, v43
    v_min_u32 v40, -2, v40
    buffer_store_dwordx4 v[32:35], v25, s[60:63], s76 offen offset:0 sc1
    buffer_store_dwordx4 v[36:39], v30, s[60:63], s76 offen offset:1024 sc1
    buffer_store_dwordx4 v[40:43], v28, s[60:63], s76 offen offset:1536 sc1
    v_mfma_f32_16x16x32_bf16 v[88:91], v[128:131], a[0:3], 0
    ds_read_b64_tr_b16 v[120:121], v17 offset:20992
    s_add_u32 s47, s79, 1966080
    v_mfma_f32_16x16x32_bf16 v[108:111], v[128:131], a[80:83], 0
    ds_read_b64_tr_b16 v[122:123], v17 offset:22272
    v_mfma_f32_16x16x32_bf16 v[72:75], v[132:135], a[4:7], v[72:75]
    ds_read_b64_tr_b16 v[124:125], v17 offset:21000
    v_mfma_f32_16x16x32_bf16 v[92:95], v[132:135], a[84:87], v[92:95]
    ds_read_b64_tr_b16 v[126:127], v17 offset:22280
    v_mfma_f32_16x16x32_bf16 v[76:79], v[136:139], a[4:7], v[76:79]
    ds_read_b64_tr_b16 v[128:129], v17 offset:21008
    s_add_u32 m0, s48, 96768
    v_mfma_f32_16x16x32_bf16 v[96:99], v[136:139], a[84:87], v[96:99]
    ds_read_b64_tr_b16 v[130:131], v17 offset:22288
    v_mfma_f32_16x16x32_bf16 v[80:83], v[140:143], a[4:7], v[80:83]
    ds_read_b64_tr_b16 v[132:133], v17 offset:21016
    v_mfma_f32_16x16x32_bf16 v[100:103], v[140:143], a[84:87], v[100:103]
    ds_read_b64_tr_b16 v[134:135], v17 offset:22296
    s_waitcnt lgkmcnt(8)
    v_mfma_f32_16x16x32_bf16 v[84:87], v[112:115], a[4:7], v[84:87]
    ds_read_b64_tr_b16 v[136:137], v17 offset:21024
    buffer_load_dwordx4 v12, s[56:59], s47 offen offset:0 lds
    v_mfma_f32_16x16x32_bf16 v[104:107], v[112:115], a[84:87], v[104:107]
    ds_read_b64_tr_b16 v[138:139], v17 offset:22304
    v_mfma_f32_16x16x32_bf16 v[88:91], v[116:119], a[4:7], v[88:91]
    ds_read_b64_tr_b16 v[140:141], v17 offset:26112
    v_mfma_f32_16x16x32_bf16 v[108:111], v[116:119], a[84:87], v[108:111]
    ds_read_b64_tr_b16 v[142:143], v17 offset:27392
    s_waitcnt lgkmcnt(8)
    v_mfma_f32_16x16x32_bf16 v[72:75], v[120:123], a[8:11], v[72:75]
    ds_read_b64_tr_b16 v[112:113], v17 offset:26120
    buffer_load_dwordx4 v13, s[56:59], s47 offen offset:1024 lds
    v_mfma_f32_16x16x32_bf16 v[92:95], v[120:123], a[88:91], v[92:95]
    ds_read_b64_tr_b16 v[114:115], v17 offset:27400
    v_mfma_f32_16x16x32_bf16 v[76:79], v[124:127], a[8:11], v[76:79]
    ds_read_b64_tr_b16 v[116:117], v17 offset:26128
    v_mfma_f32_16x16x32_bf16 v[96:99], v[124:127], a[88:91], v[96:99]
    ds_read_b64_tr_b16 v[118:119], v17 offset:27408
    s_waitcnt lgkmcnt(8)
    v_mfma_f32_16x16x32_bf16 v[80:83], v[128:131], a[8:11], v[80:83]
    ds_read_b64_tr_b16 v[120:121], v17 offset:26136
    buffer_load_dwordx4 v14, s[56:59], s47 offen offset:2048 lds
    v_mfma_f32_16x16x32_bf16 v[100:103], v[128:131], a[88:91], v[100:103]
    ds_read_b64_tr_b16 v[122:123], v17 offset:27416
    s_lshl_b32 s43, s49, 7
    v_mfma_f32_16x16x32_bf16 v[84:87], v[132:135], a[8:11], v[84:87]
    ds_read_b64_tr_b16 v[124:125], v17 offset:26144
    s_add_u32 s45, s45, s43
    v_mfma_f32_16x16x32_bf16 v[104:107], v[132:135], a[88:91], v[104:107]
    ds_read_b64_tr_b16 v[126:127], v17 offset:27424
    s_waitcnt lgkmcnt(8)
    v_mfma_f32_16x16x32_bf16 v[88:91], v[136:139], a[8:11], v[88:91]
    ds_read_b64_tr_b16 v[128:129], v17 offset:31232
    buffer_load_dwordx4 v15, s[56:59], s47 offen offset:3072 lds
    v_mfma_f32_16x16x32_bf16 v[108:111], v[136:139], a[88:91], v[108:111]
    ds_read_b64_tr_b16 v[130:131], v17 offset:32512
    v_mul_u32_u24 v255, 144, v2
    v_mfma_f32_16x16x32_bf16 v[72:75], v[140:143], a[12:15], v[72:75]
    ds_read_b64_tr_b16 v[132:133], v17 offset:31240
    v_and_b32 v238, 1, v3
    v_mfma_f32_16x16x32_bf16 v[92:95], v[140:143], a[92:95], v[92:95]
    ds_read_b64_tr_b16 v[134:135], v17 offset:32520
    s_waitcnt lgkmcnt(8)
    v_mfma_f32_16x16x32_bf16 v[76:79], v[112:115], a[12:15], v[76:79]
    ds_read_b64_tr_b16 v[136:137], v17 offset:31248
    s_add_u32 m0, s48, 100864
    v_mfma_f32_16x16x32_bf16 v[96:99], v[112:115], a[92:95], v[96:99]
    ds_read_b64_tr_b16 v[138:139], v17 offset:32528
    v_lshl_add_u32 v255, v238, 5, v255
    v_mfma_f32_16x16x32_bf16 v[80:83], v[116:119], a[12:15], v[80:83]
    ds_read_b64_tr_b16 v[140:141], v17 offset:31256
    v_lshrrev_b32 v238, 1, v3
    v_mfma_f32_16x16x32_bf16 v[100:103], v[116:119], a[92:95], v[100:103]
    ds_read_b64_tr_b16 v[142:143], v17 offset:32536
    s_waitcnt lgkmcnt(8)
    v_mfma_f32_16x16x32_bf16 v[84:87], v[120:123], a[12:15], v[84:87]
    ds_read_b64_tr_b16 v[112:113], v17 offset:31264
    buffer_load_dwordx4 v16, s[56:59], s47 offen offset:0 lds
    v_mfma_f32_16x16x32_bf16 v[104:107], v[120:123], a[92:95], v[104:107]
    ds_read_b64_tr_b16 v[114:115], v17 offset:32544
    v_lshlrev_b32 v238, 4, v238
    v_mfma_f32_16x16x32_bf16 v[88:91], v[124:127], a[12:15], v[88:91]
    ds_read_b64_tr_b16 v[116:117], v17 offset:36352
    v_add3_u32 v255, v255, v238, s48
    v_mfma_f32_16x16x32_bf16 v[108:111], v[124:127], a[92:95], v[108:111]
    ds_read_b64_tr_b16 v[118:119], v17 offset:37632
    s_waitcnt lgkmcnt(8)
    v_mfma_f32_16x16x32_bf16 v[72:75], v[128:131], a[16:19], v[72:75]
    ds_read_b64_tr_b16 v[120:121], v17 offset:36360
    s_xor_b32 s44, s35, 0
    v_mfma_f32_16x16x32_bf16 v[92:95], v[128:131], a[96:99], v[92:95]
    ds_read_b64_tr_b16 v[122:123], v17 offset:37640
    v_lshrrev_b32 v237, 3, v1
    v_mfma_f32_16x16x32_bf16 v[76:79], v[132:135], a[16:19], v[76:79]
    ds_read_b64_tr_b16 v[124:125], v17 offset:36368
    v_and_b32 v238, 7, v1
    v_mfma_f32_16x16x32_bf16 v[96:99], v[132:135], a[96:99], v[96:99]
    ds_read_b64_tr_b16 v[126:127], v17 offset:37648
    s_waitcnt lgkmcnt(8)
    v_mfma_f32_16x16x32_bf16 v[80:83], v[136:139], a[16:19], v[80:83]
    ds_read_b64_tr_b16 v[128:129], v17 offset:36376
    s_mul_i32 s47, s44, 51200
    v_mfma_f32_16x16x32_bf16 v[100:103], v[136:139], a[96:99], v[100:103]
    ds_read_b64_tr_b16 v[130:131], v17 offset:37656
    v_lshlrev_b32 v238, 4, v238
    v_mfma_f32_16x16x32_bf16 v[84:87], v[140:143], a[16:19], v[84:87]
    ds_read_b64_tr_b16 v[132:133], v17 offset:36384
    v_mul_u32_u24 v239, 144, v237
    v_mfma_f32_16x16x32_bf16 v[104:107], v[140:143], a[96:99], v[104:107]
    ds_read_b64_tr_b16 v[134:135], v17 offset:37664
    s_waitcnt lgkmcnt(8)
    v_mfma_f32_16x16x32_bf16 v[88:91], v[112:115], a[16:19], v[88:91]
    ds_read_b64_tr_b16 v[136:137], v17 offset:41472
    s_add_u32 m0, s48, 117248
    v_mfma_f32_16x16x32_bf16 v[108:111], v[112:115], a[96:99], v[108:111]
    ds_read_b64_tr_b16 v[138:139], v17 offset:42752
    v_add3_u32 v9, v239, v238, s48
    v_mfma_f32_16x16x32_bf16 v[72:75], v[116:119], a[20:23], v[72:75]
    ds_read_b64_tr_b16 v[140:141], v17 offset:41480
    v_mul_u32_u24 v254, 2560, v237
    v_mfma_f32_16x16x32_bf16 v[92:95], v[116:119], a[100:103], v[92:95]
    ds_read_b64_tr_b16 v[142:143], v17 offset:42760
    s_waitcnt lgkmcnt(8)
    v_mfma_f32_16x16x32_bf16 v[76:79], v[120:123], a[20:23], v[76:79]
    ds_read_b64_tr_b16 v[112:113], v17 offset:41488
    buffer_load_dwordx4 v20, s[64:67], s47 offen offset:0 lds
    v_mfma_f32_16x16x32_bf16 v[96:99], v[120:123], a[100:103], v[96:99]
    ds_read_b64_tr_b16 v[114:115], v17 offset:42768
    v_add3_u32 v254, v254, v238, s45
    v_mfma_f32_16x16x32_bf16 v[80:83], v[124:127], a[20:23], v[80:83]
    ds_read_b64_tr_b16 v[116:117], v17 offset:41496
    s_mul_i32 s45, s33, 524288
    v_mfma_f32_16x16x32_bf16 v[100:103], v[124:127], a[100:103], v[100:103]
    ds_read_b64_tr_b16 v[118:119], v17 offset:42776
    s_waitcnt lgkmcnt(8)
    v_mfma_f32_16x16x32_bf16 v[84:87], v[128:131], a[20:23], v[84:87]
    ds_read_b64_tr_b16 v[120:121], v17 offset:41504
    s_add_u32 s47, s47, 9216
    v_mfma_f32_16x16x32_bf16 v[104:107], v[128:131], a[100:103], v[104:107]
    ds_read_b64_tr_b16 v[122:123], v17 offset:42784
    s_add_u32 s75, s75, s45
    v_mfma_f32_16x16x32_bf16 v[88:91], v[132:135], a[20:23], v[88:91]
    ds_read_b64_tr_b16 v[124:125], v17 offset:46592
    s_and_b32 s43, s51, 3
    v_mfma_f32_16x16x32_bf16 v[108:111], v[132:135], a[100:103], v[108:111]
    ds_read_b64_tr_b16 v[126:127], v17 offset:47872
    s_waitcnt lgkmcnt(8)
    v_mfma_f32_16x16x32_bf16 v[72:75], v[136:139], a[24:27], v[72:75]
    ds_read_b64_tr_b16 v[128:129], v17 offset:46600
    buffer_load_dwordx4 v20, s[64:67], s47 offen offset:1024 lds
    v_mfma_f32_16x16x32_bf16 v[92:95], v[136:139], a[104:107], v[92:95]
    ds_read_b64_tr_b16 v[130:131], v17 offset:47880
    s_xor_b32 s45, s43, 0
    v_mfma_f32_16x16x32_bf16 v[76:79], v[140:143], a[24:27], v[76:79]
    ds_read_b64_tr_b16 v[132:133], v17 offset:46608
    s_mulk_i32 s45, 5248
    v_mfma_f32_16x16x32_bf16 v[96:99], v[140:143], a[104:107], v[96:99]
    ds_read_b64_tr_b16 v[134:135], v17 offset:47888
    s_waitcnt lgkmcnt(8)
    v_mfma_f32_16x16x32_bf16 v[80:83], v[112:115], a[24:27], v[80:83]
    ds_read_b64_tr_b16 v[136:137], v17 offset:46616
    s_add_u32 s47, s47, 9216
    v_mfma_f32_16x16x32_bf16 v[100:103], v[112:115], a[104:107], v[100:103]
    ds_read_b64_tr_b16 v[138:139], v17 offset:47896
    s_add_u32 s16, s75, s45
    v_mfma_f32_16x16x32_bf16 v[84:87], v[116:119], a[24:27], v[84:87]
    ds_read_b64_tr_b16 v[140:141], v17 offset:46624
    s_xor_b32 s20, s16, 524288
    v_mfma_f32_16x16x32_bf16 v[104:107], v[116:119], a[104:107], v[104:107]
    ds_read_b64_tr_b16 v[142:143], v17 offset:47904
    s_waitcnt lgkmcnt(8)
    v_mfma_f32_16x16x32_bf16 v[88:91], v[120:123], a[24:27], v[88:91]
    ds_read_b64_tr_b16 v[112:113], v17 offset:51712
    buffer_load_dwordx4 v20, s[64:67], s47 offen offset:2048 lds
    v_mfma_f32_16x16x32_bf16 v[108:111], v[120:123], a[104:107], v[108:111]
    ds_read_b64_tr_b16 v[114:115], v17 offset:52992
    s_xor_b32 s45, s43, 1
WA_P3:
    s_cbranch_execz WA_R
    s_nop 0
    v_mfma_f32_16x16x32_bf16 v[72:75], v[124:127], a[28:31], v[72:75]
    ds_read_b64_tr_b16 v[116:117], v17 offset:51720
    s_mulk_i32 s45, 5248
    v_mfma_f32_16x16x32_bf16 v[92:95], v[124:127], a[108:111], v[92:95]
    ds_read_b64_tr_b16 v[118:119], v17 offset:53000
    s_waitcnt lgkmcnt(8)
    v_mfma_f32_16x16x32_bf16 v[76:79], v[128:131], a[28:31], v[76:79]
    ds_read_b64_tr_b16 v[120:121], v17 offset:51728
    s_add_u32 s47, s47, 9216
    v_mfma_f32_16x16x32_bf16 v[96:99], v[128:131], a[108:111], v[96:99]
    ds_read_b64_tr_b16 v[122:123], v17 offset:53008
    s_add_u32 s17, s75, s45
    v_mfma_f32_16x16x32_bf16 v[80:83], v[132:135], a[28:31], v[80:83]
    ds_read_b64_tr_b16 v[124:125], v17 offset:51736
    s_xor_b32 s21, s17, 524288
    v_mfma_f32_16x16x32_bf16 v[100:103], v[132:135], a[108:111], v[100:103]
    ds_read_b64_tr_b16 v[126:127], v17 offset:53016
    s_waitcnt lgkmcnt(8)
    v_mfma_f32_16x16x32_bf16 v[84:87], v[136:139], a[28:31], v[84:87]
    ds_read_b64_tr_b16 v[128:129], v17 offset:51744
    buffer_load_dwordx4 v20, s[64:67], s47 offen offset:3072 lds
    v_mfma_f32_16x16x32_bf16 v[104:107], v[136:139], a[108:111], v[104:107]
    ds_read_b64_tr_b16 v[130:131], v17 offset:53024
    s_xor_b32 s45, s43, 2
    v_mfma_f32_16x16x32_bf16 v[88:91], v[140:143], a[28:31], v[88:91]
    ds_read_b64_tr_b16 v[132:133], v17 offset:56832
    s_mulk_i32 s45, 5248
    v_mfma_f32_16x16x32_bf16 v[108:111], v[140:143], a[108:111], v[108:111]
    ds_read_b64_tr_b16 v[134:135], v17 offset:58112
    s_waitcnt lgkmcnt(8)
    v_mfma_f32_16x16x32_bf16 v[72:75], v[112:115], a[32:35], v[72:75]
    ds_read_b64_tr_b16 v[136:137], v17 offset:56840
    s_add_u32 m0, s48, 121344
    v_mfma_f32_16x16x32_bf16 v[92:95], v[112:115], a[112:115], v[92:95]
    ds_read_b64_tr_b16 v[138:139], v17 offset:58120
    s_add_u32 s18, s75, s45
    v_mfma_f32_16x16x32_bf16 v[76:79], v[116:119], a[32:35], v[76:79]
    ds_read_b64_tr_b16 v[140:141], v17 offset:56848
    s_xor_b32 s22, s18, 524288
    v_mfma_f32_16x16x32_bf16 v[96:99], v[116:119], a[112:115], v[96:99]
    ds_read_b64_tr_b16 v[142:143], v17 offset:58128
    s_waitcnt lgkmcnt(8)
    v_mfma_f32_16x16x32_bf16 v[80:83], v[120:123], a[32:35], v[80:83]
    ds_read_b64_tr_b16 v[112:113], v17 offset:56856
    s_add_u32 s47, s47, 13312
    v_mfma_f32_16x16x32_bf16 v[100:103], v[120:123], a[112:115], v[100:103]
    ds_read_b64_tr_b16 v[114:115], v17 offset:58136
    s_xor_b32 s45, s43, 3
    v_mfma_f32_16x16x32_bf16 v[84:87], v[124:127], a[32:35], v[84:87]
    ds_read_b64_tr_b16 v[116:117], v17 offset:56864
    s_mulk_i32 s45, 5248
    v_mfma_f32_16x16x32_bf16 v[104:107], v[124:127], a[112:115], v[104:107]
    ds_read_b64_tr_b16 v[118:119], v17 offset:58144
    s_waitcnt lgkmcnt(8)
    v_mfma_f32_16x16x32_bf16 v[88:91], v[128:131], a[32:35], v[88:91]
    ds_read_b64_tr_b16 v[120:121], v17 offset:61952
    buffer_load_dwordx4 v20, s[64:67], s47 offen offset:0 lds
    v_mfma_f32_16x16x32_bf16 v[108:111], v[128:131], a[112:115], v[108:111]
    ds_read_b64_tr_b16 v[122:123], v17 offset:63232
    s_add_u32 s19, s75, s45
    v_mfma_f32_16x16x32_bf16 v[72:75], v[132:135], a[36:39], v[72:75]
    ds_read_b64_tr_b16 v[124:125], v17 offset:61960
    s_xor_b32 s23, s19, 524288
    v_mfma_f32_16x16x32_bf16 v[92:95], v[132:135], a[116:119], v[92:95]
    ds_read_b64_tr_b16 v[126:127], v17 offset:63240
    s_waitcnt lgkmcnt(8)
    v_mfma_f32_16x16x32_bf16 v[76:79], v[136:139], a[36:39], v[76:79]
    ds_read_b64_tr_b16 v[128:129], v17 offset:61968
    s_xor_b32 s44, s35, 4
    v_mfma_f32_16x16x32_bf16 v[96:99], v[136:139], a[116:119], v[96:99]
    ds_read_b64_tr_b16 v[130:131], v17 offset:63248
    s_mov_b32 s68, s26
    v_mfma_f32_16x16x32_bf16 v[80:83], v[140:143], a[36:39], v[80:83]
    ds_read_b64_tr_b16 v[132:133], v17 offset:61976
    s_and_b32 s69, s27, 0xffff
    v_mfma_f32_16x16x32_bf16 v[100:103], v[140:143], a[116:119], v[100:103]
    ds_read_b64_tr_b16 v[134:135], v17 offset:63256
    s_waitcnt lgkmcnt(8)
    v_mfma_f32_16x16x32_bf16 v[84:87], v[112:115], a[36:39], v[84:87]
    ds_read_b64_tr_b16 v[136:137], v17 offset:61984
    s_mul_i32 s47, s44, 51200
    v_mfma_f32_16x16x32_bf16 v[104:107], v[112:115], a[116:119], v[104:107]
    ds_read_b64_tr_b16 v[138:139], v17 offset:63264
    s_mov_b32 s70, 5242880
    v_mfma_f32_16x16x32_bf16 v[88:91], v[116:119], a[36:39], v[88:91]
    ds_read_b64_tr_b16 v[140:141], v18 offset:1536
    s_mov_b32 s71, 0x20000
    v_mfma_f32_16x16x32_bf16 v[108:111], v[116:119], a[116:119], v[108:111]
    ds_read_b64_tr_b16 v[142:143], v18 offset:2816
    s_waitcnt lgkmcnt(8)
    v_mfma_f32_16x16x32_bf16 v[72:75], v[120:123], a[40:43], v[72:75]
    ds_read_b64_tr_b16 v[112:113], v18 offset:1544
    s_add_u32 m0, s48, 137728
    v_mfma_f32_16x16x32_bf16 v[92:95], v[120:123], a[120:123], v[92:95]
    ds_read_b64_tr_b16 v[114:115], v18 offset:2824
    v_mfma_f32_16x16x32_bf16 v[76:79], v[124:127], a[40:43], v[76:79]
    ds_read_b64_tr_b16 v[116:117], v18 offset:1552
    v_mfma_f32_16x16x32_bf16 v[96:99], v[124:127], a[120:123], v[96:99]
    ds_read_b64_tr_b16 v[118:119], v18 offset:2832
    s_waitcnt lgkmcnt(8)
    v_mfma_f32_16x16x32_bf16 v[80:83], v[128:131], a[40:43], v[80:83]
    ds_read_b64_tr_b16 v[120:121], v18 offset:1560
    buffer_load_dwordx4 v20, s[64:67], s47 offen offset:0 lds
    v_mfma_f32_16x16x32_bf16 v[100:103], v[128:131], a[120:123], v[100:103]
    ds_read_b64_tr_b16 v[122:123], v18 offset:2840
    v_mfma_f32_16x16x32_bf16 v[84:87], v[132:135], a[40:43], v[84:87]
    ds_read_b64_tr_b16 v[124:125], v18 offset:1568
    v_mfma_f32_16x16x32_bf16 v[104:107], v[132:135], a[120:123], v[104:107]
    ds_read_b64_tr_b16 v[126:127], v18 offset:2848
    s_waitcnt lgkmcnt(8)
    v_mfma_f32_16x16x32_bf16 v[88:91], v[136:139], a[40:43], v[88:91]
    ds_read_b64_tr_b16 v[128:129], v18 offset:6656
    s_add_u32 s47, s47, 9216
    v_mfma_f32_16x16x32_bf16 v[108:111], v[136:139], a[120:123], v[108:111]
    ds_read_b64_tr_b16 v[130:131], v18 offset:7936
    v_mfma_f32_16x16x32_bf16 v[72:75], v[140:143], a[44:47], v[72:75]
    ds_read_b64_tr_b16 v[132:133], v18 offset:6664
    v_mfma_f32_16x16x32_bf16 v[92:95], v[140:143], a[124:127], v[92:95]
    ds_read_b64_tr_b16 v[134:135], v18 offset:7944
    s_waitcnt lgkmcnt(8)
    v_mfma_f32_16x16x32_bf16 v[76:79], v[112:115], a[44:47], v[76:79]
    ds_read_b64_tr_b16 v[136:137], v18 offset:6672
    buffer_load_dwordx4 v20, s[64:67], s47 offen offset:1024 lds
    v_mfma_f32_16x16x32_bf16 v[96:99], v[112:115], a[124:127], v[96:99]
    ds_read_b64_tr_b16 v[138:139], v18 offset:7952
    v_mfma_f32_16x16x32_bf16 v[80:83], v[116:119], a[44:47], v[80:83]
    ds_read_b64_tr_b16 v[140:141], v18 offset:6680
    v_mfma_f32_16x16x32_bf16 v[100:103], v[116:119], a[124:127], v[100:103]
    ds_read_b64_tr_b16 v[142:143], v18 offset:7960
    s_waitcnt lgkmcnt(8)
    v_mfma_f32_16x16x32_bf16 v[84:87], v[120:123], a[44:47], v[84:87]
    ds_read_b64_tr_b16 v[112:113], v18 offset:6688
    s_add_u32 s47, s47, 9216
    v_mfma_f32_16x16x32_bf16 v[104:107], v[120:123], a[124:127], v[104:107]
    ds_read_b64_tr_b16 v[114:115], v18 offset:7968
    v_mfma_f32_16x16x32_bf16 v[88:91], v[124:127], a[44:47], v[88:91]
    ds_read_b64_tr_b16 v[116:117], v18 offset:11776
    v_mfma_f32_16x16x32_bf16 v[108:111], v[124:127], a[124:127], v[108:111]
    ds_read_b64_tr_b16 v[118:119], v18 offset:13056
    s_waitcnt lgkmcnt(8)
    v_mfma_f32_16x16x32_bf16 v[72:75], v[128:131], a[48:51], v[72:75]
    ds_read_b64_tr_b16 v[120:121], v18 offset:11784
    buffer_load_dwordx4 v20, s[64:67], s47 offen offset:2048 lds
    v_mfma_f32_16x16x32_bf16 v[92:95], v[128:131], a[128:131], v[92:95]
    ds_read_b64_tr_b16 v[122:123], v18 offset:13064
    v_mfma_f32_16x16x32_bf16 v[76:79], v[132:135], a[48:51], v[76:79]
    ds_read_b64_tr_b16 v[124:125], v18 offset:11792
    v_mfma_f32_16x16x32_bf16 v[96:99], v[132:135], a[128:131], v[96:99]
    ds_read_b64_tr_b16 v[126:127], v18 offset:13072
    s_waitcnt lgkmcnt(8)
    v_mfma_f32_16x16x32_bf16 v[80:83], v[136:139], a[48:51], v[80:83]
    ds_read_b64_tr_b16 v[128:129], v18 offset:11800
    s_add_u32 s47, s47, 9216
    v_mfma_f32_16x16x32_bf16 v[100:103], v[136:139], a[128:131], v[100:103]
    ds_read_b64_tr_b16 v[130:131], v18 offset:13080
    v_mfma_f32_16x16x32_bf16 v[84:87], v[140:143], a[48:51], v[84:87]
    ds_read_b64_tr_b16 v[132:133], v18 offset:11808
    v_mfma_f32_16x16x32_bf16 v[104:107], v[140:143], a[128:131], v[104:107]
    ds_read_b64_tr_b16 v[134:135], v18 offset:13088
    s_waitcnt lgkmcnt(8)
    v_mfma_f32_16x16x32_bf16 v[88:91], v[112:115], a[48:51], v[88:91]
    ds_read_b64_tr_b16 v[136:137], v18 offset:16896
    buffer_load_dwordx4 v20, s[64:67], s47 offen offset:3072 lds
    v_mfma_f32_16x16x32_bf16 v[108:111], v[112:115], a[128:131], v[108:111]
    ds_read_b64_tr_b16 v[138:139], v18 offset:18176
    v_mfma_f32_16x16x32_bf16 v[72:75], v[116:119], a[52:55], v[72:75]
    ds_read_b64_tr_b16 v[140:141], v18 offset:16904
    v_mfma_f32_16x16x32_bf16 v[92:95], v[116:119], a[132:135], v[92:95]
    ds_read_b64_tr_b16 v[142:143], v18 offset:18184
    s_waitcnt lgkmcnt(8)
    v_mfma_f32_16x16x32_bf16 v[76:79], v[120:123], a[52:55], v[76:79]
    ds_read_b64_tr_b16 v[112:113], v18 offset:16912
    s_add_u32 m0, s48, 141824
    v_mfma_f32_16x16x32_bf16 v[96:99], v[120:123], a[132:135], v[96:99]
    ds_read_b64_tr_b16 v[114:115], v18 offset:18192
    v_mfma_f32_16x16x32_bf16 v[80:83], v[124:127], a[52:55], v[80:83]
    ds_read_b64_tr_b16 v[116:117], v18 offset:16920
    v_mfma_f32_16x16x32_bf16 v[100:103], v[124:127], a[132:135], v[100:103]
    ds_read_b64_tr_b16 v[118:119], v18 offset:18200
    s_waitcnt lgkmcnt(8)
    v_mfma_f32_16x16x32_bf16 v[84:87], v[128:131], a[52:55], v[84:87]
    ds_read_b64_tr_b16 v[120:121], v18 offset:16928
    s_add_u32 s47, s47, 13312
    v_mfma_f32_16x16x32_bf16 v[104:107], v[128:131], a[132:135], v[104:107]
    ds_read_b64_tr_b16 v[122:123], v18 offset:18208
    v_mfma_f32_16x16x32_bf16 v[88:91], v[132:135], a[52:55], v[88:91]
    ds_read_b64_tr_b16 v[124:125], v18 offset:22016
    v_mfma_f32_16x16x32_bf16 v[108:111], v[132:135], a[132:135], v[108:111]
    ds_read_b64_tr_b16 v[126:127], v18 offset:23296
    s_waitcnt lgkmcnt(8)
    v_mfma_f32_16x16x32_bf16 v[72:75], v[136:139], a[56:59], v[72:75]
    ds_read_b64_tr_b16 v[128:129], v18 offset:22024
    buffer_load_dwordx4 v20, s[64:67], s47 offen offset:0 lds
    v_mfma_f32_16x16x32_bf16 v[92:95], v[136:139], a[136:139], v[92:95]
    ds_read_b64_tr_b16 v[130:131], v18 offset:23304
    v_mfma_f32_16x16x32_bf16 v[76:79], v[140:143], a[56:59], v[76:79]
    ds_read_b64_tr_b16 v[132:133], v18 offset:22032
    v_mfma_f32_16x16x32_bf16 v[96:99], v[140:143], a[136:139], v[96:99]
    ds_read_b64_tr_b16 v[134:135], v18 offset:23312
    s_waitcnt lgkmcnt(8)
    v_mfma_f32_16x16x32_bf16 v[80:83], v[112:115], a[56:59], v[80:83]
    ds_read_b64_tr_b16 v[136:137], v18 offset:22040
    v_mfma_f32_16x16x32_bf16 v[100:103], v[112:115], a[136:139], v[100:103]
    ds_read_b64_tr_b16 v[138:139], v18 offset:23320
    v_mfma_f32_16x16x32_bf16 v[84:87], v[116:119], a[56:59], v[84:87]
    ds_read_b64_tr_b16 v[140:141], v18 offset:22048
    v_mfma_f32_16x16x32_bf16 v[104:107], v[116:119], a[136:139], v[104:107]
    ds_read_b64_tr_b16 v[142:143], v18 offset:23328
    s_waitcnt lgkmcnt(8)
    v_mfma_f32_16x16x32_bf16 v[88:91], v[120:123], a[56:59], v[88:91]
    s_waitcnt vmcnt(10)
    s_barrier
    ds_read_b64_tr_b16 v[112:113], v18 offset:31232
    v_mfma_f32_16x16x32_bf16 v[108:111], v[120:123], a[136:139], v[108:111]
    ds_read_b64_tr_b16 v[114:115], v18 offset:32512
    v_mfma_f32_16x16x32_bf16 v[72:75], v[124:127], a[60:63], v[72:75]
    ds_read_b64_tr_b16 v[116:117], v18 offset:31240
    v_mfma_f32_16x16x32_bf16 v[92:95], v[124:127], a[140:143], v[92:95]
    ds_read_b64_tr_b16 v[118:119], v18 offset:32520
    s_waitcnt lgkmcnt(8)
    v_mfma_f32_16x16x32_bf16 v[76:79], v[128:131], a[60:63], v[76:79]
    ds_read_b64_tr_b16 v[120:121], v18 offset:31248
    v_mfma_f32_16x16x32_bf16 v[96:99], v[128:131], a[140:143], v[96:99]
    ds_read_b64_tr_b16 v[122:123], v18 offset:32528
    v_mfma_f32_16x16x32_bf16 v[80:83], v[132:135], a[60:63], v[80:83]
    ds_read_b64_tr_b16 v[124:125], v18 offset:31256
    v_mfma_f32_16x16x32_bf16 v[100:103], v[132:135], a[140:143], v[100:103]
    ds_read_b64_tr_b16 v[126:127], v18 offset:32536
    s_waitcnt lgkmcnt(8)
    v_mfma_f32_16x16x32_bf16 v[84:87], v[136:139], a[60:63], v[84:87]
    ds_read_b64_tr_b16 v[128:129], v18 offset:31264
    s_xor_b32 s44, s35, 8
    v_mfma_f32_16x16x32_bf16 v[104:107], v[136:139], a[140:143], v[104:107]
    ds_read_b64_tr_b16 v[130:131], v18 offset:32544
    v_mfma_f32_16x16x32_bf16 v[88:91], v[140:143], a[60:63], v[88:91]
    ds_read_b64_tr_b16 v[132:133], v18 offset:36352
    s_mul_i32 s47, s44, 51200
    v_mfma_f32_16x16x32_bf16 v[108:111], v[140:143], a[140:143], v[108:111]
    ds_read_b64_tr_b16 v[134:135], v18 offset:37632
    s_waitcnt lgkmcnt(8)
    v_mfma_f32_16x16x32_bf16 v[72:75], v[112:115], a[64:67], v[72:75]
    ds_read_b64_tr_b16 v[136:137], v18 offset:36360
    s_add_u32 m0, s48, 10752
    v_mfma_f32_16x16x32_bf16 v[92:95], v[112:115], a[144:147], v[92:95]
    ds_read_b64_tr_b16 v[138:139], v18 offset:37640
    v_mfma_f32_16x16x32_bf16 v[76:79], v[116:119], a[64:67], v[76:79]
    ds_read_b64_tr_b16 v[140:141], v18 offset:36368
    buffer_load_dwordx4 v20, s[64:67], s47 offen offset:0 lds
    v_mfma_f32_16x16x32_bf16 v[96:99], v[116:119], a[144:147], v[96:99]
    ds_read_b64_tr_b16 v[142:143], v18 offset:37648
    s_waitcnt lgkmcnt(8)
    v_mfma_f32_16x16x32_bf16 v[80:83], v[120:123], a[64:67], v[80:83]
    ds_read_b64_tr_b16 v[112:113], v18 offset:36376
    s_add_u32 s47, s47, 9216
    v_mfma_f32_16x16x32_bf16 v[100:103], v[120:123], a[144:147], v[100:103]
    ds_read_b64_tr_b16 v[114:115], v18 offset:37656
    v_mfma_f32_16x16x32_bf16 v[84:87], v[124:127], a[64:67], v[84:87]
    ds_read_b64_tr_b16 v[116:117], v18 offset:36384
    buffer_load_dwordx4 v20, s[64:67], s47 offen offset:1024 lds
    v_mfma_f32_16x16x32_bf16 v[104:107], v[124:127], a[144:147], v[104:107]
    ds_read_b64_tr_b16 v[118:119], v18 offset:37664
    s_waitcnt lgkmcnt(8)
    v_mfma_f32_16x16x32_bf16 v[88:91], v[128:131], a[64:67], v[88:91]
    ds_read_b64_tr_b16 v[120:121], v18 offset:41472
    s_add_u32 s47, s47, 9216
    v_mfma_f32_16x16x32_bf16 v[108:111], v[128:131], a[144:147], v[108:111]
    ds_read_b64_tr_b16 v[122:123], v18 offset:42752
    v_mfma_f32_16x16x32_bf16 v[72:75], v[132:135], a[68:71], v[72:75]
    ds_read_b64_tr_b16 v[124:125], v18 offset:41480
    buffer_load_dwordx4 v20, s[64:67], s47 offen offset:2048 lds
    v_mfma_f32_16x16x32_bf16 v[92:95], v[132:135], a[148:151], v[92:95]
    ds_read_b64_tr_b16 v[126:127], v18 offset:42760
    s_waitcnt lgkmcnt(8)
    v_mfma_f32_16x16x32_bf16 v[76:79], v[136:139], a[68:71], v[76:79]
    ds_read_b64_tr_b16 v[128:129], v18 offset:41488
    s_add_u32 s47, s47, 9216
    v_mfma_f32_16x16x32_bf16 v[96:99], v[136:139], a[148:151], v[96:99]
    ds_read_b64_tr_b16 v[130:131], v18 offset:42768
    v_mfma_f32_16x16x32_bf16 v[80:83], v[140:143], a[68:71], v[80:83]
    ds_read_b64_tr_b16 v[132:133], v18 offset:41496
    buffer_load_dwordx4 v20, s[64:67], s47 offen offset:3072 lds
    v_mfma_f32_16x16x32_bf16 v[100:103], v[140:143], a[148:151], v[100:103]
    ds_read_b64_tr_b16 v[134:135], v18 offset:42776
    s_waitcnt lgkmcnt(8)
    v_mfma_f32_16x16x32_bf16 v[84:87], v[112:115], a[68:71], v[84:87]
    ds_read_b64_tr_b16 v[136:137], v18 offset:41504
    s_add_u32 m0, s48, 14848
    v_mfma_f32_16x16x32_bf16 v[104:107], v[112:115], a[148:151], v[104:107]
    ds_read_b64_tr_b16 v[138:139], v18 offset:42784
    v_mfma_f32_16x16x32_bf16 v[88:91], v[116:119], a[68:71], v[88:91]
    ds_read_b64_tr_b16 v[140:141], v18 offset:46592
    s_add_u32 s47, s47, 13312
    v_mfma_f32_16x16x32_bf16 v[108:111], v[116:119], a[148:151], v[108:111]
    ds_read_b64_tr_b16 v[142:143], v18 offset:47872
    s_waitcnt lgkmcnt(8)
    v_mfma_f32_16x16x32_bf16 v[72:75], v[120:123], a[72:75], v[72:75]
    ds_read_b64_tr_b16 v[112:113], v18 offset:46600
    buffer_load_dwordx4 v20, s[64:67], s47 offen offset:0 lds
    v_mfma_f32_16x16x32_bf16 v[92:95], v[120:123], a[152:155], v[92:95]
    ds_read_b64_tr_b16 v[114:115], v18 offset:47880
    v_mfma_f32_16x16x32_bf16 v[76:79], v[124:127], a[72:75], v[76:79]
    ds_read_b64_tr_b16 v[116:117], v18 offset:46608
    s_xor_b32 s44, s35, 12
    v_mfma_f32_16x16x32_bf16 v[96:99], v[124:127], a[152:155], v[96:99]
    ds_read_b64_tr_b16 v[118:119], v18 offset:47888
    s_waitcnt lgkmcnt(8)
    v_mfma_f32_16x16x32_bf16 v[80:83], v[128:131], a[72:75], v[80:83]
    ds_read_b64_tr_b16 v[120:121], v18 offset:46616
    s_mul_i32 s47, s44, 51200
    v_mfma_f32_16x16x32_bf16 v[100:103], v[128:131], a[152:155], v[100:103]
    ds_read_b64_tr_b16 v[122:123], v18 offset:47896
    v_mfma_f32_16x16x32_bf16 v[84:87], v[132:135], a[72:75], v[84:87]
    ds_read_b64_tr_b16 v[124:125], v18 offset:46624
    s_add_u32 m0, s48, 31232
    v_mfma_f32_16x16x32_bf16 v[104:107], v[132:135], a[152:155], v[104:107]
    ds_read_b64_tr_b16 v[126:127], v18 offset:47904
    s_waitcnt lgkmcnt(8)
    v_mfma_f32_16x16x32_bf16 v[88:91], v[136:139], a[72:75], v[88:91]
    buffer_load_dwordx4 v20, s[64:67], s47 offen offset:0 lds
    v_mfma_f32_16x16x32_bf16 v[108:111], v[136:139], a[152:155], v[108:111]
    v_mfma_f32_16x16x32_bf16 v[72:75], v[140:143], a[76:79], v[72:75]
    s_add_u32 s47, s47, 9216
    v_mfma_f32_16x16x32_bf16 v[92:95], v[140:143], a[156:159], v[92:95]
    s_waitcnt lgkmcnt(4)
    v_mfma_f32_16x16x32_bf16 v[76:79], v[112:115], a[76:79], v[76:79]
    buffer_load_dwordx4 v20, s[64:67], s47 offen offset:1024 lds
    v_mfma_f32_16x16x32_bf16 v[96:99], v[112:115], a[156:159], v[96:99]
    v_mfma_f32_16x16x32_bf16 v[80:83], v[116:119], a[76:79], v[80:83]
    s_add_u32 s47, s47, 9216
    v_mfma_f32_16x16x32_bf16 v[100:103], v[116:119], a[156:159], v[100:103]
    s_waitcnt lgkmcnt(0)
    v_cvt_pk_bf16_f32 v144, v72, v73
    v_cvt_pk_bf16_f32 v156, v92, v93
    v_mfma_f32_16x16x32_bf16 v[84:87], v[120:123], a[76:79], v[84:87]
    buffer_load_dwordx4 v20, s[64:67], s47 offen offset:2048 lds
    v_mfma_f32_16x16x32_bf16 v[104:107], v[120:123], a[156:159], v[104:107]
    v_cvt_pk_bf16_f32 v145, v74, v75
    v_cvt_pk_bf16_f32 v157, v94, v95
    v_cvt_pk_bf16_f32 v146, v76, v77
    v_cvt_pk_bf16_f32 v158, v96, v97
    v_mfma_f32_16x16x32_bf16 v[88:91], v[124:127], a[76:79], v[88:91]
    s_add_u32 s47, s47, 9216
    v_mfma_f32_16x16x32_bf16 v[108:111], v[124:127], a[156:159], v[108:111]
    v_cvt_pk_bf16_f32 v147, v78, v79
    v_cvt_pk_bf16_f32 v159, v98, v99
    v_cvt_pk_bf16_f32 v148, v80, v81
    v_cvt_pk_bf16_f32 v160, v100, v101
    v_cvt_pk_bf16_f32 v149, v82, v83
    v_cvt_pk_bf16_f32 v161, v102, v103
    v_cvt_pk_bf16_f32 v150, v84, v85
    v_cvt_pk_bf16_f32 v162, v104, v105
    v_cvt_pk_bf16_f32 v151, v86, v87
    v_cvt_pk_bf16_f32 v163, v106, v107
    v_cvt_pk_bf16_f32 v152, v88, v89
    v_cvt_pk_bf16_f32 v164, v108, v109
    v_cvt_pk_bf16_f32 v153, v90, v91
    v_cvt_pk_bf16_f32 v165, v110, v111
    v_mfma_f32_16x16x32_bf16 v[168:171], a[160:163], v[144:147], 0
    buffer_load_dwordx4 v20, s[64:67], s47 offen offset:3072 lds
    s_add_u32 m0, s48, 35328
    v_mfma_f32_16x16x32_bf16 v[172:175], a[172:175], v[144:147], 0
    s_add_u32 s47, s47, 13312
    buffer_load_dwordx4 v20, s[64:67], s47 offen offset:0 lds
    v_mfma_f32_16x16x32_bf16 v[176:179], a[184:187], v[144:147], 0
    s_lshl1_add_u32 s75, s39, s37
    s_mul_i32 s76, s75, 524288
    v_mfma_f32_16x16x32_bf16 v[180:183], a[196:199], v[144:147], 0
    s_lshl_b32 s75, s32, 11
    s_add_u32 s76, s76, s75
    v_mfma_f32_16x16x32_bf16 v[184:187], a[208:211], v[144:147], 0
    s_add_u32 s76, s76, 139264
    s_mul_i32 s75, s32, 2112
    v_mfma_f32_16x16x32_bf16 v[168:171], a[164:167], v[148:151], v[168:171]
    v_add_u32 v21, s75, v252
    s_movk_i32 s44, 5120
    v_mfma_f32_16x16x32_bf16 v[172:175], a[176:179], v[148:151], v[172:175]
    s_cmp_lt_u32 s32, 2
    s_cselect_b32 s44, s44, 1073741824
    v_mov_b32 v30, s44
    v_mfma_f32_16x16x32_bf16 v[176:179], a[188:191], v[148:151], v[176:179]
    buffer_load_dword v31, v26, s[12:15], 0 offen offset:4 sc1
    v_mfma_f32_16x16x32_bf16 v[180:183], a[200:203], v[148:151], v[180:183]
    v_mfma_f32_16x16x32_bf16 v[184:187], a[212:215], v[148:151], v[184:187]
    v_mfma_f32_16x16x32_bf16 v[168:171], a[168:171], v[152:155], v[168:171]
    v_mfma_f32_16x16x32_bf16 v[172:175], a[180:183], v[152:155], v[172:175]
    v_mfma_f32_16x16x32_bf16 v[176:179], a[192:195], v[152:155], v[176:179]
    v_mfma_f32_16x16x32_bf16 v[180:183], a[204:207], v[152:155], v[180:183]
    v_mfma_f32_16x16x32_bf16 v[184:187], a[216:219], v[152:155], v[184:187]
    v_mfma_f32_16x16x32_bf16 v[188:191], a[160:163], v[156:159], 0
    v_mfma_f32_16x16x32_bf16 v[192:195], a[172:175], v[156:159], 0
    v_mfma_f32_16x16x32_bf16 v[196:199], a[184:187], v[156:159], 0
    v_mfma_f32_16x16x32_bf16 v[200:203], a[196:199], v[156:159], 0
    v_max3_f32 v208, v168, v169, v170
    v_min3_f32 v209, v168, v169, v170
    v_mfma_f32_16x16x32_bf16 v[204:207], a[208:211], v[156:159], 0
    v_max3_f32 v208, v208, v171, v172
    v_min3_f32 v209, v209, v171, v172
    v_mfma_f32_16x16x32_bf16 v[188:191], a[164:167], v[160:163], v[188:191]
    v_max3_f32 v208, v208, v173, v174
    v_min3_f32 v209, v209, v173, v174
    v_mfma_f32_16x16x32_bf16 v[192:195], a[176:179], v[160:163], v[192:195]
    v_max3_f32 v208, v208, v175, v176
    v_min3_f32 v209, v209, v175, v176
    v_mfma_f32_16x16x32_bf16 v[196:199], a[188:191], v[160:163], v[196:199]
    v_max3_f32 v208, v208, v177, v178
    v_min3_f32 v209, v209, v177, v178
    v_mfma_f32_16x16x32_bf16 v[200:203], a[200:203], v[160:163], v[200:203]
    v_max3_f32 v208, v208, v179, v180
    v_min3_f32 v209, v209, v179, v180
    v_mfma_f32_16x16x32_bf16 v[204:207], a[212:215], v[160:163], v[204:207]
    v_max3_f32 v208, v208, v181, v182
    v_min3_f32 v209, v209, v181, v182
    v_mfma_f32_16x16x32_bf16 v[188:191], a[168:171], v[164:167], v[188:191]
    v_max3_f32 v208, v208, v183, v184
    v_min3_f32 v209, v209, v183, v184
    v_mfma_f32_16x16x32_bf16 v[192:195], a[180:183], v[164:167], v[192:195]
    v_max3_f32 v208, v208, v185, v186
    v_min3_f32 v209, v209, v185, v186
    v_mfma_f32_16x16x32_bf16 v[196:199], a[192:195], v[164:167], v[196:199]
    v_max_f32 v208, v208, v187
    v_min_f32 v209, v209, v187
    v_mfma_f32_16x16x32_bf16 v[200:203], a[204:207], v[164:167], v[200:203]
    v_mul_f32 v208, s73, v208
    v_mul_f32 v209, s72, v209
    v_mfma_f32_16x16x32_bf16 v[204:207], a[216:219], v[164:167], v[204:207]
    v_pk_fma_f32 v[96:97], v[168:169], s[72:73], v[208:209] op_sel:[0,0,0] op_sel_hi:[0,1,1]
    v_pk_fma_f32 v[98:99], v[168:169], s[72:73], v[208:209] op_sel:[1,0,0] op_sel_hi:[1,1,1]
    v_pk_fma_f32 v[100:101], v[170:171], s[72:73], v[208:209] op_sel:[0,0,0] op_sel_hi:[0,1,1]
    v_pk_fma_f32 v[102:103], v[170:171], s[72:73], v[208:209] op_sel:[1,0,0] op_sel_hi:[1,1,1]
    v_pk_fma_f32 v[104:105], v[172:173], s[72:73], v[208:209] op_sel:[0,0,0] op_sel_hi:[0,1,1]
    v_pk_fma_f32 v[106:107], v[172:173], s[72:73], v[208:209] op_sel:[1,0,0] op_sel_hi:[1,1,1]
    buffer_load_dwordx4 v[212:215], v252, s[60:63], s76 offen offset:0 sc1
    buffer_load_dwordx4 v[216:219], v252, s[60:63], s76 offen offset:1024 sc1
    v_pk_fma_f32 v[108:109], v[174:175], s[72:73], v[208:209] op_sel:[0,0,0] op_sel_hi:[0,1,1]
    v_pk_fma_f32 v[110:111], v[174:175], s[72:73], v[208:209] op_sel:[1,0,0] op_sel_hi:[1,1,1]
    v_pk_fma_f32 v[112:113], v[176:177], s[72:73], v[208:209] op_sel:[0,0,0] op_sel_hi:[0,1,1]
    v_pk_fma_f32 v[114:115], v[176:177], s[72:73], v[208:209] op_sel:[1,0,0] op_sel_hi:[1,1,1]
    v_pk_fma_f32 v[116:117], v[178:179], s[72:73], v[208:209] op_sel:[0,0,0] op_sel_hi:[0,1,1]
    v_pk_fma_f32 v[118:119], v[178:179], s[72:73], v[208:209] op_sel:[1,0,0] op_sel_hi:[1,1,1]
    v_pk_fma_f32 v[120:121], v[180:181], s[72:73], v[208:209] op_sel:[0,0,0] op_sel_hi:[0,1,1]
    v_pk_fma_f32 v[122:123], v[180:181], s[72:73], v[208:209] op_sel:[1,0,0] op_sel_hi:[1,1,1]
    v_pk_fma_f32 v[124:125], v[182:183], s[72:73], v[208:209] op_sel:[0,0,0] op_sel_hi:[0,1,1]
    v_pk_fma_f32 v[126:127], v[182:183], s[72:73], v[208:209] op_sel:[1,0,0] op_sel_hi:[1,1,1]
    v_pk_fma_f32 v[128:129], v[184:185], s[72:73], v[208:209] op_sel:[0,0,0] op_sel_hi:[0,1,1]
    v_pk_fma_f32 v[130:131], v[184:185], s[72:73], v[208:209] op_sel:[1,0,0] op_sel_hi:[1,1,1]
    v_pk_fma_f32 v[132:133], v[186:187], s[72:73], v[208:209] op_sel:[0,0,0] op_sel_hi:[0,1,1]
    v_pk_fma_f32 v[134:135], v[186:187], s[72:73], v[208:209] op_sel:[1,0,0] op_sel_hi:[1,1,1]
    v_exp_f32 v96, v96
    v_exp_f32 v97, v97
    v_exp_f32 v98, v98
    v_exp_f32 v99, v99
    v_exp_f32 v100, v100
    v_exp_f32 v101, v101
    v_pk_add_f32 v[208:209], v[96:97], v[98:99]
    v_exp_f32 v102, v102
    v_exp_f32 v103, v103
    v_pk_add_f32 v[208:209], v[208:209], v[100:101]
    v_exp_f32 v104, v104
    v_exp_f32 v105, v105
    v_pk_add_f32 v[208:209], v[208:209], v[102:103]
    v_exp_f32 v106, v106
    v_exp_f32 v107, v107
    v_pk_add_f32 v[208:209], v[208:209], v[104:105]
    v_exp_f32 v108, v108
    v_exp_f32 v109, v109
    v_pk_add_f32 v[208:209], v[208:209], v[106:107]
    v_exp_f32 v110, v110
    v_exp_f32 v111, v111
    v_pk_add_f32 v[208:209], v[208:209], v[108:109]
    v_exp_f32 v112, v112
    v_exp_f32 v113, v113
    v_pk_add_f32 v[208:209], v[208:209], v[110:111]
    v_exp_f32 v114, v114
    v_exp_f32 v115, v115
    v_pk_add_f32 v[208:209], v[208:209], v[112:113]
    v_exp_f32 v116, v116
    v_exp_f32 v117, v117
    v_pk_add_f32 v[208:209], v[208:209], v[114:115]
    v_exp_f32 v118, v118
    v_exp_f32 v119, v119
    v_pk_add_f32 v[208:209], v[208:209], v[116:117]
    v_exp_f32 v120, v120
    v_exp_f32 v121, v121
    v_pk_add_f32 v[208:209], v[208:209], v[118:119]
    v_exp_f32 v122, v122
    v_exp_f32 v123, v123
    v_pk_add_f32 v[208:209], v[208:209], v[120:121]
    v_exp_f32 v124, v124
    v_exp_f32 v125, v125
    v_pk_add_f32 v[208:209], v[208:209], v[122:123]
    v_exp_f32 v126, v126
    v_exp_f32 v127, v127
    v_pk_add_f32 v[208:209], v[208:209], v[124:125]
    v_exp_f32 v128, v128
    v_exp_f32 v129, v129
    v_pk_add_f32 v[208:209], v[208:209], v[126:127]
    v_exp_f32 v130, v130
    v_exp_f32 v131, v131
    v_pk_add_f32 v[208:209], v[208:209], v[128:129]
    v_exp_f32 v132, v132
    v_exp_f32 v133, v133
    v_pk_add_f32 v[208:209], v[208:209], v[130:131]
    v_exp_f32 v134, v134
    v_exp_f32 v135, v135
    v_pk_add_f32 v[208:209], v[208:209], v[132:133]
    v_pk_add_f32 v[208:209], v[208:209], v[134:135]
    v_rcp_f32 v208, v208
    v_rcp_f32_e64 v209, v209
    s_nop 0
    v_pk_mul_f32 v[96:97], v[96:97], v[208:209]
    v_pk_mul_f32 v[98:99], v[98:99], v[208:209]
    v_cvt_pk_bf16_f32 v32, v96, v97
    v_pk_mul_f32 v[100:101], v[100:101], v[208:209]
    v_cvt_pk_bf16_f32 v33, v98, v99
    v_pk_mul_f32 v[102:103], v[102:103], v[208:209]
    v_cvt_pk_bf16_f32 v34, v100, v101
    v_pk_mul_f32 v[104:105], v[104:105], v[208:209]
    v_cvt_pk_bf16_f32 v35, v102, v103
    v_pk_mul_f32 v[106:107], v[106:107], v[208:209]
    v_cvt_pk_bf16_f32 v36, v104, v105
    v_pk_mul_f32 v[108:109], v[108:109], v[208:209]
    s_waitcnt vmcnt(2)
    v_cmp_eq_u32 vcc, 0, v31
    v_cvt_pk_bf16_f32 v37, v106, v107
    v_pk_mul_f32 v[110:111], v[110:111], v[208:209]
    v_cvt_pk_bf16_f32 v38, v108, v109
    v_pk_mul_f32 v[112:113], v[112:113], v[208:209]
    v_cvt_pk_bf16_f32 v39, v110, v111
    v_pk_mul_f32 v[114:115], v[114:115], v[208:209]
    v_cvt_pk_bf16_f32 v40, v112, v113
    v_pk_mul_f32 v[116:117], v[116:117], v[208:209]
    s_cbranch_vccnz A_c2_slow
A_c2_back:
    s_waitcnt vmcnt(0)
    v_max3_u32 v6, v212, v214, v216
    v_max_u32 v6, v6, v218
    v_cmp_eq_u32 vcc, -1, v6
    v_cvt_pk_bf16_f32 v41, v114, v115
    v_pk_mul_f32 v[118:119], v[118:119], v[208:209]
    v_cvt_pk_bf16_f32 v42, v116, v117
    v_pk_mul_f32 v[120:121], v[120:121], v[208:209]
    v_cvt_pk_bf16_f32 v43, v118, v119
    v_pk_mul_f32 v[122:123], v[122:123], v[208:209]
    s_cbranch_vccnz A_red_slow
A_red_back:
    s_nop 0
    ds_write_b128 v21, v[212:215] offset:2304
    ds_write_b128 v21, v[216:219] offset:3328
    v_cvt_pk_bf16_f32 v44, v120, v121
    v_pk_mul_f32 v[124:125], v[124:125], v[208:209]
    v_cvt_pk_bf16_f32 v45, v122, v123
    v_pk_mul_f32 v[126:127], v[126:127], v[208:209]
    v_cvt_pk_bf16_f32 v46, v124, v125
    v_pk_mul_f32 v[128:129], v[128:129], v[208:209]
    v_cvt_pk_bf16_f32 v47, v126, v127
    v_pk_mul_f32 v[130:131], v[130:131], v[208:209]
    v_cvt_pk_bf16_f32 v48, v128, v129
    v_pk_mul_f32 v[132:133], v[132:133], v[208:209]
    v_cvt_pk_bf16_f32 v49, v130, v131
    v_pk_mul_f32 v[134:135], v[134:135], v[208:209]
    v_cvt_pk_bf16_f32 v50, v132, v133
    v_cvt_pk_bf16_f32 v51, v134, v135
    v_max3_f32 v210, v188, v189, v190
    v_min3_f32 v211, v188, v189, v190
    v_max3_f32 v210, v210, v191, v192
    v_min3_f32 v211, v211, v191, v192
    v_max3_f32 v210, v210, v193, v194
WA_P4:
    s_cbranch_execz WA_R
    s_nop 0
    v_min3_f32 v211, v211, v193, v194
    s_waitcnt lgkmcnt(0)
    s_barrier
    ds_read_b128 a[0:3], v27 offset:1088
    ds_read_b128 a[4:7], v27 offset:1216
    ds_read_b128 a[8:11], v27 offset:1344
    ds_read_b128 a[12:15], v27 offset:1472
    ds_read_b128 a[16:19], v27 offset:1856
    ds_read_b128 a[20:23], v27 offset:0
    ds_read_b128 a[24:27], v27 offset:256
    v_max3_f32 v210, v210, v195, v196
    v_min3_f32 v211, v211, v195, v196
    v_max3_f32 v210, v210, v197, v198
    v_min3_f32 v211, v211, v197, v198
    v_max3_f32 v210, v210, v199, v200
    v_min3_f32 v211, v211, v199, v200
    v_max3_f32 v210, v210, v201, v202
    v_min3_f32 v211, v211, v201, v202
    v_max3_f32 v210, v210, v203, v204
    v_min3_f32 v211, v211, v203, v204
    v_max3_f32 v210, v210, v205, v206
    v_min3_f32 v211, v211, v205, v206
    v_max_f32 v210, v210, v207
    v_min_f32 v211, v211, v207
    v_mul_f32 v210, s73, v210
    v_mul_f32 v211, s72, v211
    s_waitcnt lgkmcnt(4)
    v_mfma_f32_16x16x32_bf16 v[232:235], a[0:3], v[32:35], 0
    ds_read_b128 a[28:31], v27 offset:512
    v_mfma_f32_16x16x32_bf16 v[232:235], a[4:7], v[36:39], v[232:235]
    ds_read_b128 a[32:35], v27 offset:768
    v_mfma_f32_16x16x32_bf16 v[232:235], a[8:11], v[40:43], v[232:235]
    ds_read_b128 a[36:39], v27 offset:1536
    s_waitcnt lgkmcnt(4)
    v_mfma_f32_16x16x32_bf16 v[232:235], a[12:15], v[44:47], v[232:235]
    ds_read_b128 a[40:43], v27 offset:64
    v_mfma_f32_16x16x32_bf16 v[232:235], a[16:19], v[48:51], v[232:235]
    ds_read_b128 a[44:47], v27 offset:320
    v_mfma_f32_16x16x32_bf16 v[212:215], a[20:23], v[32:35], 0
    ds_read_b128 a[48:51], v27 offset:576
    s_waitcnt lgkmcnt(4)
    v_mfma_f32_16x16x32_bf16 v[212:215], a[24:27], v[36:39], v[212:215]
    ds_read_b128 a[52:55], v27 offset:832
    v_mfma_f32_16x16x32_bf16 v[212:215], a[28:31], v[40:43], v[212:215]
    ds_read_b128 a[56:59], v27 offset:1600
    v_mfma_f32_16x16x32_bf16 v[212:215], a[32:35], v[44:47], v[212:215]
    ds_read_b128 a[60:63], v27 offset:128
    s_waitcnt lgkmcnt(4)
    v_mfma_f32_16x16x32_bf16 v[212:215], a[36:39], v[48:51], v[212:215]
    ds_read_b128 a[64:67], v27 offset:384
    buffer_store_dword v30, v30, s[60:63], s16 offen sc1
    v_mfma_f32_16x16x32_bf16 v[216:219], a[40:43], v[32:35], 0
    ds_read_b128 a[68:71], v27 offset:640
    v_add_f32 v174, 0x358637bd, v232
    v_mfma_f32_16x16x32_bf16 v[216:219], a[44:47], v[36:39], v[216:219]
    ds_read_b128 a[72:75], v27 offset:896
    s_waitcnt lgkmcnt(4)
    v_mfma_f32_16x16x32_bf16 v[216:219], a[48:51], v[40:43], v[216:219]
    ds_read_b128 a[76:79], v27 offset:1664
    v_rcp_f32 v174, v174
    v_mfma_f32_16x16x32_bf16 v[216:219], a[52:55], v[44:47], v[216:219]
    ds_read_b128 a[80:83], v27 offset:192
    v_mul_f32 v212, v174, v212
    v_mfma_f32_16x16x32_bf16 v[216:219], a[56:59], v[48:51], v[216:219]
    ds_read_b128 a[84:87], v27 offset:448
    s_waitcnt lgkmcnt(4)
    v_mfma_f32_16x16x32_bf16 v[220:223], a[60:63], v[32:35], 0
    ds_read_b128 a[88:91], v27 offset:704
    v_mul_f32 v213, v174, v213
    v_mfma_f32_16x16x32_bf16 v[220:223], a[64:67], v[36:39], v[220:223]
    ds_read_b128 a[92:95], v27 offset:960
    v_mul_f32 v214, v174, v214
    v_mfma_f32_16x16x32_bf16 v[220:223], a[68:71], v[40:43], v[220:223]
    ds_read_b128 a[96:99], v27 offset:1728
    s_waitcnt lgkmcnt(4)
    v_mfma_f32_16x16x32_bf16 v[220:223], a[72:75], v[44:47], v[220:223]
    ds_read_b128 a[100:103], v27 offset:1024
    v_mul_f32 v215, v174, v215
    v_mfma_f32_16x16x32_bf16 v[220:223], a[76:79], v[48:51], v[220:223]
    ds_read_b128 a[104:107], v27 offset:1152
    v_cvt_pk_bf16_f32 v84, v212, v213
    v_mfma_f32_16x16x32_bf16 v[224:227], a[80:83], v[32:35], 0
    ds_read_b128 a[108:111], v27 offset:1280
    s_waitcnt lgkmcnt(4)
    v_mfma_f32_16x16x32_bf16 v[224:227], a[84:87], v[36:39], v[224:227]
    ds_read_b128 a[112:115], v27 offset:1408
    v_cvt_pk_bf16_f32 v85, v214, v215
    v_mfma_f32_16x16x32_bf16 v[224:227], a[88:91], v[40:43], v[224:227]
    ds_read_b128 a[116:119], v27 offset:1792
    v_min_u32 v84, -2, v84
    v_mfma_f32_16x16x32_bf16 v[224:227], a[92:95], v[44:47], v[224:227]
    v_mul_f32 v216, v174, v216
    s_waitcnt lgkmcnt(0)
    v_mfma_f32_16x16x32_bf16 v[224:227], a[96:99], v[48:51], v[224:227]
    v_mul_f32 v217, v174, v217
    v_mul_f32 v218, v174, v218
    v_mfma_f32_16x16x32_bf16 v[228:231], a[100:103], v[32:35], 0
    v_mul_f32 v219, v174, v219
    v_cvt_pk_bf16_f32 v86, v216, v217
    v_mfma_f32_16x16x32_bf16 v[228:231], a[104:107], v[36:39], v[228:231]
    v_cvt_pk_bf16_f32 v87, v218, v219
    v_mul_f32 v220, v174, v220
    v_mfma_f32_16x16x32_bf16 v[228:231], a[108:111], v[40:43], v[228:231]
    v_mul_f32 v221, v174, v221
    v_mul_f32 v222, v174, v222
    v_mfma_f32_16x16x32_bf16 v[228:231], a[112:115], v[44:47], v[228:231]
    v_mul_f32 v223, v174, v223
    v_cvt_pk_bf16_f32 v88, v220, v221
    v_mfma_f32_16x16x32_bf16 v[228:231], a[116:119], v[48:51], v[228:231]
    v_cvt_pk_bf16_f32 v89, v222, v223
    v_min_u32 v88, -2, v88
    buffer_store_dwordx4 v[84:87], v252, s[60:63], s16 offen offset:0 sc1
    v_pk_mul_f32 v[224:225], v[224:225], v[174:175] op_sel:[0,0] op_sel_hi:[1,0]
    v_pk_mul_f32 v[226:227], v[226:227], v[174:175] op_sel:[0,0] op_sel_hi:[1,0]
    v_cvt_pk_bf16_f32 v90, v224, v225
    v_cvt_pk_bf16_f32 v91, v226, v227
    s_nop 0
    v_pk_mul_f32 v[228:229], v[228:229], v[174:175] op_sel:[0,0] op_sel_hi:[1,0]
    v_pk_mul_f32 v[230:231], v[230:231], v[174:175] op_sel:[0,0] op_sel_hi:[1,0]
    v_cvt_pk_bf16_f32 v92, v228, v229
    v_cvt_pk_bf16_f32 v93, v230, v231
    v_min_u32 v92, -2, v92
    buffer_store_dwordx4 v[88:91], v252, s[60:63], s16 offen offset:1024 sc1
    buffer_store_dwordx2 v[92:93], v253, s[60:63], s16 offen offset:0 sc1
    v_pk_fma_f32 v[96:97], v[188:189], s[72:73], v[210:211] op_sel:[0,0,0] op_sel_hi:[0,1,1]
    v_pk_fma_f32 v[98:99], v[188:189], s[72:73], v[210:211] op_sel:[1,0,0] op_sel_hi:[1,1,1]
    v_pk_fma_f32 v[100:101], v[190:191], s[72:73], v[210:211] op_sel:[0,0,0] op_sel_hi:[0,1,1]
    v_pk_fma_f32 v[102:103], v[190:191], s[72:73], v[210:211] op_sel:[1,0,0] op_sel_hi:[1,1,1]
    v_pk_fma_f32 v[104:105], v[192:193], s[72:73], v[210:211] op_sel:[0,0,0] op_sel_hi:[0,1,1]
    v_pk_fma_f32 v[106:107], v[192:193], s[72:73], v[210:211] op_sel:[1,0,0] op_sel_hi:[1,1,1]
    v_pk_fma_f32 v[108:109], v[194:195], s[72:73], v[210:211] op_sel:[0,0,0] op_sel_hi:[0,1,1]
    v_pk_fma_f32 v[110:111], v[194:195], s[72:73], v[210:211] op_sel:[1,0,0] op_sel_hi:[1,1,1]
    v_pk_fma_f32 v[112:113], v[196:197], s[72:73], v[210:211] op_sel:[0,0,0] op_sel_hi:[0,1,1]
    v_pk_fma_f32 v[114:115], v[196:197], s[72:73], v[210:211] op_sel:[1,0,0] op_sel_hi:[1,1,1]
    v_pk_fma_f32 v[116:117], v[198:199], s[72:73], v[210:211] op_sel:[0,0,0] op_sel_hi:[0,1,1]
    v_pk_fma_f32 v[118:119], v[198:199], s[72:73], v[210:211] op_sel:[1,0,0] op_sel_hi:[1,1,1]
    v_pk_fma_f32 v[120:121], v[200:201], s[72:73], v[210:211] op_sel:[0,0,0] op_sel_hi:[0,1,1]
    v_pk_fma_f32 v[122:123], v[200:201], s[72:73], v[210:211] op_sel:[1,0,0] op_sel_hi:[1,1,1]
    v_pk_fma_f32 v[124:125], v[202:203], s[72:73], v[210:211] op_sel:[0,0,0] op_sel_hi:[0,1,1]
    v_pk_fma_f32 v[126:127], v[202:203], s[72:73], v[210:211] op_sel:[1,0,0] op_sel_hi:[1,1,1]
    v_pk_fma_f32 v[128:129], v[204:205], s[72:73], v[210:211] op_sel:[0,0,0] op_sel_hi:[0,1,1]
    v_pk_fma_f32 v[130:131], v[204:205], s[72:73], v[210:211] op_sel:[1,0,0] op_sel_hi:[1,1,1]
    v_pk_fma_f32 v[132:133], v[206:207], s[72:73], v[210:211] op_sel:[0,0,0] op_sel_hi:[0,1,1]
    v_pk_fma_f32 v[134:135], v[206:207], s[72:73], v[210:211] op_sel:[1,0,0] op_sel_hi:[1,1,1]
    v_exp_f32 v96, v96
    v_exp_f32 v97, v97
    v_exp_f32 v98, v98
    v_exp_f32 v99, v99
    v_exp_f32 v100, v100
    v_exp_f32 v101, v101
    v_pk_add_f32 v[210:211], v[96:97], v[98:99]
    v_exp_f32 v102, v102
    v_exp_f32 v103, v103
    v_pk_add_f32 v[210:211], v[210:211], v[100:101]
    v_exp_f32 v104, v104
    v_exp_f32 v105, v105
    v_pk_add_f32 v[210:211], v[210:211], v[102:103]
    v_exp_f32 v106, v106
    v_exp_f32 v107, v107
    v_pk_add_f32 v[210:211], v[210:211], v[104:105]
    v_exp_f32 v108, v108
    v_exp_f32 v109, v109
    v_pk_add_f32 v[210:211], v[210:211], v[106:107]
    v_exp_f32 v110, v110
    v_exp_f32 v111, v111
    v_pk_add_f32 v[210:211], v[210:211], v[108:109]
    v_exp_f32 v112, v112
    v_exp_f32 v113, v113
    v_pk_add_f32 v[210:211], v[210:211], v[110:111]
    v_exp_f32 v114, v114
    v_exp_f32 v115, v115
    v_pk_add_f32 v[210:211], v[210:211], v[112:113]
    v_exp_f32 v116, v116
    v_exp_f32 v117, v117
    v_pk_add_f32 v[210:211], v[210:211], v[114:115]
    v_exp_f32 v118, v118
    v_exp_f32 v119, v119
    v_pk_add_f32 v[210:211], v[210:211], v[116:117]
    v_exp_f32 v120, v120
    v_exp_f32 v121, v121
    v_pk_add_f32 v[210:211], v[210:211], v[118:119]
    v_exp_f32 v122, v122
    v_exp_f32 v123, v123
    v_pk_add_f32 v[210:211], v[210:211], v[120:121]
    v_exp_f32 v124, v124
    v_exp_f32 v125, v125
    v_pk_add_f32 v[210:211], v[210:211], v[122:123]
    v_exp_f32 v126, v126
    v_exp_f32 v127, v127
    v_pk_add_f32 v[210:211], v[210:211], v[124:125]
    v_exp_f32 v128, v128
    v_exp_f32 v129, v129
    v_pk_add_f32 v[210:211], v[210:211], v[126:127]
    v_exp_f32 v130, v130
    v_exp_f32 v131, v131
    v_pk_add_f32 v[210:211], v[210:211], v[128:129]
    v_exp_f32 v132, v132
    v_exp_f32 v133, v133
    v_pk_add_f32 v[210:211], v[210:211], v[130:131]
    v_exp_f32 v134, v134
    v_exp_f32 v135, v135
    v_pk_add_f32 v[210:211], v[210:211], v[132:133]
    v_pk_add_f32 v[210:211], v[210:211], v[134:135]
    v_rcp_f32 v210, v210
    v_rcp_f32_e64 v211, v211
    s_nop 0
    v_pk_mul_f32 v[96:97], v[96:97], v[210:211]
    v_pk_mul_f32 v[98:99], v[98:99], v[210:211]
    v_cvt_pk_bf16_f32 v52, v96, v97
    v_pk_mul_f32 v[100:101], v[100:101], v[210:211]
    v_cvt_pk_bf16_f32 v53, v98, v99
    v_pk_mul_f32 v[102:103], v[102:103], v[210:211]
    v_cvt_pk_bf16_f32 v54, v100, v101
    v_pk_mul_f32 v[104:105], v[104:105], v[210:211]
    v_cvt_pk_bf16_f32 v55, v102, v103
    v_pk_mul_f32 v[106:107], v[106:107], v[210:211]
    v_cvt_pk_bf16_f32 v56, v104, v105
    v_pk_mul_f32 v[108:109], v[108:109], v[210:211]
    v_cvt_pk_bf16_f32 v57, v106, v107
    v_pk_mul_f32 v[110:111], v[110:111], v[210:211]
    v_cvt_pk_bf16_f32 v58, v108, v109
    v_pk_mul_f32 v[112:113], v[112:113], v[210:211]
    v_cvt_pk_bf16_f32 v59, v110, v111
    v_pk_mul_f32 v[114:115], v[114:115], v[210:211]
    v_cvt_pk_bf16_f32 v60, v112, v113
    v_pk_mul_f32 v[116:117], v[116:117], v[210:211]
    v_cvt_pk_bf16_f32 v61, v114, v115
    v_pk_mul_f32 v[118:119], v[118:119], v[210:211]
    v_cvt_pk_bf16_f32 v62, v116, v117
    v_pk_mul_f32 v[120:121], v[120:121], v[210:211]
    v_cvt_pk_bf16_f32 v63, v118, v119
    v_pk_mul_f32 v[122:123], v[122:123], v[210:211]
    v_cvt_pk_bf16_f32 v64, v120, v121
    v_pk_mul_f32 v[124:125], v[124:125], v[210:211]
    v_cvt_pk_bf16_f32 v65, v122, v123
    v_pk_mul_f32 v[126:127], v[126:127], v[210:211]
    v_cvt_pk_bf16_f32 v66, v124, v125
    v_pk_mul_f32 v[128:129], v[128:129], v[210:211]
    v_cvt_pk_bf16_f32 v67, v126, v127
    v_pk_mul_f32 v[130:131], v[130:131], v[210:211]
    v_cvt_pk_bf16_f32 v68, v128, v129
    v_pk_mul_f32 v[132:133], v[132:133], v[210:211]
    v_cvt_pk_bf16_f32 v69, v130, v131
    v_pk_mul_f32 v[134:135], v[134:135], v[210:211]
    v_cvt_pk_bf16_f32 v70, v132, v133
    v_cvt_pk_bf16_f32 v71, v134, v135
    v_mfma_f32_16x16x32_bf16 v[196:199], a[0:3], v[52:55], 0
    ds_read_b64_tr_b16 a[120:121], v248 offset:0
    v_mfma_f32_16x16x32_bf16 v[196:199], a[4:7], v[56:59], v[196:199]
    ds_read_b64_tr_b16 a[122:123], v250 offset:512
    v_mfma_f32_16x16x32_bf16 v[196:199], a[8:11], v[60:63], v[196:199]
    ds_read_b64_tr_b16 a[124:125], v249 offset:0
    v_mfma_f32_16x16x32_bf16 v[196:199], a[12:15], v[64:67], v[196:199]
    ds_read_b64_tr_b16 a[126:127], v251 offset:512
    v_mfma_f32_16x16x32_bf16 v[196:199], a[16:19], v[68:71], v[196:199]
    ds_read_b64_tr_b16 a[128:129], v250 offset:0
    v_mfma_f32_16x16x32_bf16 v[176:179], a[20:23], v[52:55], 0
    ds_read_b64_tr_b16 a[130:131], v248 offset:512
    v_mfma_f32_16x16x32_bf16 v[176:179], a[24:27], v[56:59], v[176:179]
    ds_read_b64_tr_b16 a[132:133], v251 offset:0
    v_mfma_f32_16x16x32_bf16 v[176:179], a[28:31], v[60:63], v[176:179]
    ds_read_b64_tr_b16 a[134:135], v249 offset:512
    v_mfma_f32_16x16x32_bf16 v[176:179], a[32:35], v[64:67], v[176:179]
    ds_read_b64_tr_b16 a[136:137], v248 offset:1024
    v_add_f32 v175, 0x358637bd, v196
    v_mfma_f32_16x16x32_bf16 v[176:179], a[36:39], v[68:71], v[176:179]
    ds_read_b64_tr_b16 a[138:139], v250 offset:1536
    v_rcp_f32 v175, v175
    v_mfma_f32_16x16x32_bf16 v[180:183], a[40:43], v[52:55], 0
    ds_read_b64_tr_b16 a[140:141], v249 offset:1024
    v_mfma_f32_16x16x32_bf16 v[180:183], a[44:47], v[56:59], v[180:183]
    ds_read_b64_tr_b16 a[142:143], v251 offset:1536
    buffer_load_dwordx4 v[94:97], v252, s[60:63], s17 offen offset:0 sc1
    v_mfma_f32_16x16x32_bf16 v[180:183], a[48:51], v[60:63], v[180:183]
    ds_read_b64_tr_b16 a[144:145], v250 offset:1024
    v_mfma_f32_16x16x32_bf16 v[180:183], a[52:55], v[64:67], v[180:183]
    ds_read_b64_tr_b16 a[146:147], v248 offset:1536
    buffer_load_dwordx4 v[98:101], v252, s[60:63], s17 offen offset:1024 sc1
    v_mfma_f32_16x16x32_bf16 v[180:183], a[56:59], v[68:71], v[180:183]
    ds_read_b64_tr_b16 a[148:149], v251 offset:1024
    v_mfma_f32_16x16x32_bf16 v[184:187], a[60:63], v[52:55], 0
    ds_read_b64_tr_b16 a[150:151], v249 offset:1536
    buffer_load_dwordx2 v[102:103], v253, s[60:63], s17 offen offset:0 sc1
    v_mfma_f32_16x16x32_bf16 v[184:187], a[64:67], v[56:59], v[184:187]
    ds_read_b64_tr_b16 a[152:153], v248 offset:2048
    v_mfma_f32_16x16x32_bf16 v[184:187], a[68:71], v[60:63], v[184:187]
    ds_read_b64_tr_b16 a[154:155], v248 offset:10240
    buffer_load_dwordx4 v[104:107], v252, s[60:63], s18 offen offset:0 sc1
    v_mfma_f32_16x16x32_bf16 v[184:187], a[72:75], v[64:67], v[184:187]
    ds_read_b64_tr_b16 a[156:157], v249 offset:2048
    v_mul_f32 v176, v175, v176
    v_mfma_f32_16x16x32_bf16 v[184:187], a[76:79], v[68:71], v[184:187]
    ds_read_b64_tr_b16 a[158:159], v249 offset:10240
    v_mul_f32 v177, v175, v177
    v_mfma_f32_16x16x32_bf16 v[188:191], a[80:83], v[52:55], 0
    ds_read_b64_tr_b16 a[160:161], v250 offset:2048
    v_mul_f32 v178, v175, v178
    v_mfma_f32_16x16x32_bf16 v[188:191], a[84:87], v[56:59], v[188:191]
    ds_read_b64_tr_b16 a[162:163], v250 offset:10240
    v_mul_f32 v179, v175, v179
    v_mfma_f32_16x16x32_bf16 v[188:191], a[88:91], v[60:63], v[188:191]
    ds_read_b64_tr_b16 a[164:165], v251 offset:2048
    v_cvt_pk_bf16_f32 v164, v176, v177
    v_mfma_f32_16x16x32_bf16 v[188:191], a[92:95], v[64:67], v[188:191]
    v_cvt_pk_bf16_f32 v165, v178, v179
    v_min_u32 v164, -2, v164
    v_mfma_f32_16x16x32_bf16 v[188:191], a[96:99], v[68:71], v[188:191]
    v_mul_f32 v180, v175, v180
    v_mul_f32 v181, v175, v181
    v_mfma_f32_16x16x32_bf16 v[192:195], a[100:103], v[52:55], 0
    v_mul_f32 v182, v175, v182
    v_mul_f32 v183, v175, v183
    v_mfma_f32_16x16x32_bf16 v[192:195], a[104:107], v[56:59], v[192:195]
    v_cvt_pk_bf16_f32 v166, v180, v181
    v_cvt_pk_bf16_f32 v167, v182, v183
    v_mfma_f32_16x16x32_bf16 v[192:195], a[108:111], v[60:63], v[192:195]
    buffer_load_dwordx4 v[108:111], v252, s[60:63], s18 offen offset:1024 sc1
    buffer_load_dwordx2 v[112:113], v253, s[60:63], s18 offen offset:0 sc1
    v_mfma_f32_16x16x32_bf16 v[192:195], a[112:115], v[64:67], v[192:195]
    buffer_load_dwordx4 v[114:117], v252, s[60:63], s19 offen offset:0 sc1
    buffer_load_dwordx4 v[118:121], v252, s[60:63], s19 offen offset:1024 sc1
    v_mfma_f32_16x16x32_bf16 v[192:195], a[116:119], v[68:71], v[192:195]
    buffer_load_dwordx2 v[122:123], v253, s[60:63], s19 offen offset:0 sc1
    ds_read_b64_tr_b16 a[166:167], v251 offset:10240
    buffer_store_dwordx4 v[164:167], v252, s[60:63], s16 offen offset:2048 sc1
    v_pk_mul_f32 v[184:185], v[184:185], v[174:175] op_sel:[0,1] op_sel_hi:[1,1]
    v_pk_mul_f32 v[186:187], v[186:187], v[174:175] op_sel:[0,1] op_sel_hi:[1,1]
    v_cvt_pk_bf16_f32 v168, v184, v185
    v_cvt_pk_bf16_f32 v169, v186, v187
    v_min_u32_e64 v168, -2, v168
    v_pk_mul_f32 v[188:189], v[188:189], v[174:175] op_sel:[0,1] op_sel_hi:[1,1]
    v_pk_mul_f32 v[190:191], v[190:191], v[174:175] op_sel:[0,1] op_sel_hi:[1,1]
    v_cvt_pk_bf16_f32 v170, v188, v189
    v_cvt_pk_bf16_f32 v171, v190, v191
    v_pk_mul_f32 v[192:193], v[192:193], v[174:175] op_sel:[0,1] op_sel_hi:[1,1]
    v_pk_mul_f32 v[194:195], v[194:195], v[174:175] op_sel:[0,1] op_sel_hi:[1,1]
    v_cvt_pk_bf16_f32 v172, v192, v193
    v_cvt_pk_bf16_f32 v173, v194, v195
    v_min_u32_e64 v172, -2, v172
    buffer_store_dwordx4 v[168:171], v252, s[60:63], s16 offen offset:3072 sc1
    buffer_store_dwordx2 v[172:173], v253, s[60:63], s16 offen offset:512 sc1
G2_begin:
    s_waitcnt lgkmcnt(14)
    v_mfma_f32_16x16x32_bf16 v[32:35], a[120:123], v[84:87], 0
    ds_read_b64_tr_b16 a[168:169], v250 offset:10752
    ds_read_b64_tr_b16 a[170:171], v248 offset:11264
    v_mfma_f32_16x16x32_bf16 v[36:39], a[124:127], v[84:87], 0
    ds_read_b64_tr_b16 a[172:173], v251 offset:10752
    ds_read_b64_tr_b16 a[174:175], v249 offset:11264
    v_mfma_f32_16x16x32_bf16 v[40:43], a[128:131], v[84:87], 0
    ds_read_b64_tr_b16 a[176:177], v248 offset:10752
    ds_read_b64_tr_b16 a[178:179], v250 offset:11264
    v_mfma_f32_16x16x32_bf16 v[44:47], a[132:135], v[84:87], 0
    ds_read_b64_tr_b16 a[180:181], v249 offset:10752
    ds_read_b64_tr_b16 a[182:183], v251 offset:11264
    v_mfma_f32_16x16x32_bf16 v[32:35], a[136:139], v[88:91], v[32:35]
    ds_read_b64_tr_b16 a[184:185], v250 offset:11776
    ds_read_b64_tr_b16 a[186:187], v248 offset:12288
    s_waitcnt lgkmcnt(14)
    v_mfma_f32_16x16x32_bf16 v[36:39], a[140:143], v[88:91], v[36:39]
    ds_read_b64_tr_b16 a[188:189], v251 offset:11776
    ds_read_b64_tr_b16 a[190:191], v249 offset:12288
    v_mfma_f32_16x16x32_bf16 v[40:43], a[144:147], v[88:91], v[40:43]
    ds_read_b64_tr_b16 a[192:193], v248 offset:11776
    ds_read_b64_tr_b16 a[194:195], v250 offset:12288
    v_mfma_f32_16x16x32_bf16 v[44:47], a[148:151], v[88:91], v[44:47]
    ds_read_b64_tr_b16 a[196:197], v249 offset:11776
    ds_read_b64_tr_b16 a[198:199], v251 offset:12288
    v_mfma_f32_16x16x32_bf16 v[48:51], a[120:123], v[164:167], 0
    ds_read_b64_tr_b16 a[200:201], v248 offset:20480
    ds_read_b64_tr_b16 a[202:203], v250 offset:20992
    v_mfma_f32_16x16x32_bf16 v[52:55], a[124:127], v[164:167], 0
    ds_read_b64_tr_b16 a[204:205], v249 offset:20480
    ds_read_b64_tr_b16 a[206:207], v251 offset:20992
    v_mfma_f32_16x16x32_bf16 v[56:59], a[128:131], v[164:167], 0
    ds_read_b64_tr_b16 a[208:209], v250 offset:20480
    ds_read_b64_tr_b16 a[210:211], v248 offset:20992
    v_mfma_f32_16x16x32_bf16 v[60:63], a[132:135], v[164:167], 0
    ds_read_b64_tr_b16 a[212:213], v251 offset:20480
    ds_read_b64_tr_b16 a[214:215], v249 offset:20992
    v_mfma_f32_16x16x32_bf16 v[48:51], a[136:139], v[168:171], v[48:51]
    ds_read_b64_tr_b16 a[216:217], v248 offset:21504
    ds_read_b64_tr_b16 a[218:219], v250 offset:22016
    v_mfma_f32_16x16x32_bf16 v[52:55], a[140:143], v[168:171], v[52:55]
    ds_read_b64_tr_b16 a[220:221], v249 offset:21504
    ds_read_b64_tr_b16 a[222:223], v251 offset:22016
    buffer_load_dwordx4 v[124:127], v252, s[60:63], s20 offen offset:0 sc1
    v_mfma_f32_16x16x32_bf16 v[56:59], a[144:147], v[168:171], v[56:59]
    ds_read_b64_tr_b16 a[224:225], v250 offset:21504
    ds_read_b64_tr_b16 a[226:227], v248 offset:22016
    v_mfma_f32_16x16x32_bf16 v[60:63], a[148:151], v[168:171], v[60:63]
    ds_read_b64_tr_b16 a[228:229], v251 offset:21504
    ds_read_b64_tr_b16 a[230:231], v249 offset:22016
    buffer_load_dwordx4 v[128:131], v252, s[60:63], s20 offen offset:1024 sc1
    s_waitcnt vmcnt(11)
    v_max3_u32 v6, v94, v98, v102
    v_cmp_eq_u32 vcc, -1, v6
    s_nop 4
    s_cbranch_vccnz G2_10_slow
G2_10_back:
    v_mfma_f32_16x16x32_bf16 v[32:35], a[152:155], v[92:95], v[32:35]
    ds_read_b64_tr_b16 a[232:233], v248 offset:22528
    ds_read_b64_tr_b16 a[234:235], v248 offset:30720
    v_mfma_f32_16x16x32_bf16 v[36:39], a[156:159], v[92:95], v[36:39]
    ds_read_b64_tr_b16 a[236:237], v249 offset:22528
    ds_read_b64_tr_b16 a[238:239], v249 offset:30720
    buffer_load_dwordx2 v[132:133], v253, s[60:63], s20 offen offset:0 sc1
    s_waitcnt lgkmcnt(14)
    v_mfma_f32_16x16x32_bf16 v[40:43], a[160:163], v[92:95], v[40:43]
    ds_read_b64_tr_b16 a[240:241], v250 offset:22528
    ds_read_b64_tr_b16 a[242:243], v250 offset:30720
    v_mfma_f32_16x16x32_bf16 v[44:47], a[164:167], v[92:95], v[44:47]
    ds_read_b64_tr_b16 a[244:245], v251 offset:22528
    ds_read_b64_tr_b16 a[246:247], v251 offset:30720
    buffer_load_dwordx4 v[134:137], v252, s[60:63], s21 offen offset:0 sc1
    v_mfma_f32_16x16x32_bf16 v[32:35], a[168:171], v[96:99], v[32:35]
    ds_read_b64_tr_b16 a[248:249], v250 offset:31232
    ds_read_b64_tr_b16 a[250:251], v248 offset:31744
    v_mfma_f32_16x16x32_bf16 v[36:39], a[172:175], v[96:99], v[36:39]
    ds_read_b64_tr_b16 a[252:253], v251 offset:31232
    ds_read_b64_tr_b16 a[254:255], v249 offset:31744
    buffer_load_dwordx4 v[138:141], v252, s[60:63], s21 offen offset:1024 sc1
    v_mfma_f32_16x16x32_bf16 v[40:43], a[176:179], v[96:99], v[40:43]
    ds_read_b64_tr_b16 a[0:1], v248 offset:31232
    ds_read_b64_tr_b16 a[2:3], v250 offset:31744
    v_mfma_f32_16x16x32_bf16 v[44:47], a[180:183], v[96:99], v[44:47]
    ds_read_b64_tr_b16 a[4:5], v249 offset:31232
    ds_read_b64_tr_b16 a[6:7], v251 offset:31744
    buffer_load_dwordx2 v[142:143], v253, s[60:63], s21 offen offset:0 sc1
    s_waitcnt vmcnt(12)
    v_mfma_f32_16x16x32_bf16 v[32:35], a[184:187], v[100:103], v[32:35]
    ds_read_b64_tr_b16 a[8:9], v250 offset:32256
    ds_read_b64_tr_b16 a[10:11], v248 offset:32768
    v_max3_u32 v6, v104, v108, v112
    v_mfma_f32_16x16x32_bf16 v[36:39], a[188:191], v[100:103], v[36:39]
    ds_read_b64_tr_b16 a[12:13], v251 offset:32256
    ds_read_b64_tr_b16 a[14:15], v249 offset:32768
    buffer_load_dwordx4 v[144:147], v252, s[60:63], s22 offen offset:0 sc1
    v_cmp_eq_u32 vcc, -1, v6
    v_mfma_f32_16x16x32_bf16 v[40:43], a[192:195], v[100:103], v[40:43]
    ds_read_b64_tr_b16 a[16:17], v248 offset:32256
    ds_read_b64_tr_b16 a[18:19], v250 offset:32768
    v_mfma_f32_16x16x32_bf16 v[44:47], a[196:199], v[100:103], v[44:47]
    ds_read_b64_tr_b16 a[20:21], v249 offset:32256
    ds_read_b64_tr_b16 a[22:23], v251 offset:32768
    buffer_load_dwordx4 v[148:151], v252, s[60:63], s22 offen offset:1024 sc1
    s_cbranch_vccnz G2_20_slow
G2_20_back:
    v_mfma_f32_16x16x32_bf16 v[32:35], a[200:203], v[104:107], v[32:35]
    ds_read_b64_tr_b16 a[24:25], v244 offset:10752
    ds_read_b64_tr_b16 a[26:27], v246 offset:11264
    v_mfma_f32_16x16x32_bf16 v[36:39], a[204:207], v[104:107], v[36:39]
    ds_read_b64_tr_b16 a[28:29], v245 offset:10752
    ds_read_b64_tr_b16 a[30:31], v247 offset:11264
    buffer_load_dwordx2 v[152:153], v253, s[60:63], s22 offen offset:0 sc1
    v_mfma_f32_16x16x32_bf16 v[40:43], a[208:211], v[104:107], v[40:43]
    ds_read_b64_tr_b16 a[32:33], v246 offset:10752
    ds_read_b64_tr_b16 a[34:35], v244 offset:11264
    s_waitcnt lgkmcnt(14)
    v_mfma_f32_16x16x32_bf16 v[44:47], a[212:215], v[104:107], v[44:47]
    ds_read_b64_tr_b16 a[36:37], v247 offset:10752
    ds_read_b64_tr_b16 a[38:39], v245 offset:11264
    buffer_load_dwordx4 v[154:157], v252, s[60:63], s23 offen offset:0 sc1
    s_waitcnt vmcnt(13)
    v_mfma_f32_16x16x32_bf16 v[32:35], a[216:219], v[108:111], v[32:35]
    ds_read_b64_tr_b16 a[40:41], v244 offset:11776
    ds_read_b64_tr_b16 a[42:43], v246 offset:12288
    v_max3_u32 v6, v114, v118, v122
    v_mfma_f32_16x16x32_bf16 v[36:39], a[220:223], v[108:111], v[36:39]
    ds_read_b64_tr_b16 a[44:45], v245 offset:11776
    ds_read_b64_tr_b16 a[46:47], v247 offset:12288
    buffer_load_dwordx4 v[158:161], v252, s[60:63], s23 offen offset:1024 sc1
    v_cmp_eq_u32 vcc, -1, v6
    v_mfma_f32_16x16x32_bf16 v[40:43], a[224:227], v[108:111], v[40:43]
    ds_read_b64_tr_b16 a[48:49], v246 offset:11776
    ds_read_b64_tr_b16 a[50:51], v244 offset:12288
    v_mfma_f32_16x16x32_bf16 v[44:47], a[228:231], v[108:111], v[44:47]
    ds_read_b64_tr_b16 a[52:53], v247 offset:11776
    ds_read_b64_tr_b16 a[54:55], v245 offset:12288
    buffer_load_dwordx2 v[162:163], v253, s[60:63], s23 offen offset:0 sc1
    s_cbranch_vccnz G2_30_slow
G2_30_back:
    v_mfma_f32_16x16x32_bf16 v[32:35], a[232:235], v[112:115], v[32:35]
    ds_read_b64_tr_b16 a[56:57], v244 offset:12800
    ds_read_b64_tr_b16 a[58:59], v244 offset:20992
    v_mfma_f32_16x16x32_bf16 v[36:39], a[236:239], v[112:115], v[36:39]
    ds_read_b64_tr_b16 a[60:61], v245 offset:12800
    ds_read_b64_tr_b16 a[62:63], v245 offset:20992
    v_mfma_f32_16x16x32_bf16 v[40:43], a[240:243], v[112:115], v[40:43]
    ds_read_b64_tr_b16 a[64:65], v246 offset:12800
    ds_read_b64_tr_b16 a[66:67], v246 offset:20992
    v_mfma_f32_16x16x32_bf16 v[44:47], a[244:247], v[112:115], v[44:47]
    ds_read_b64_tr_b16 a[68:69], v247 offset:12800
    ds_read_b64_tr_b16 a[70:71], v247 offset:20992
    v_mfma_f32_16x16x32_bf16 v[32:35], a[248:251], v[116:119], v[32:35]
    ds_read_b64_tr_b16 a[72:73], v246 offset:21504
    ds_read_b64_tr_b16 a[74:75], v244 offset:22016
    v_mfma_f32_16x16x32_bf16 v[36:39], a[252:255], v[116:119], v[36:39]
    ds_read_b64_tr_b16 a[76:77], v247 offset:21504
    ds_read_b64_tr_b16 a[78:79], v245 offset:22016
    v_mfma_f32_16x16x32_bf16 v[40:43], a[0:3], v[116:119], v[40:43]
    ds_read_b64_tr_b16 a[80:81], v244 offset:21504
    ds_read_b64_tr_b16 a[82:83], v246 offset:22016
    v_mfma_f32_16x16x32_bf16 v[44:47], a[4:7], v[116:119], v[44:47]
    ds_read_b64_tr_b16 a[84:85], v245 offset:21504
    ds_read_b64_tr_b16 a[86:87], v247 offset:22016
    s_waitcnt lgkmcnt(14)
    s_waitcnt vmcnt(9)
    v_mfma_f32_16x16x32_bf16 v[32:35], a[8:11], v[120:123], v[32:35]
    ds_read_b64_tr_b16 a[88:89], v246 offset:22528
    ds_read_b64_tr_b16 a[90:91], v244 offset:23040
    v_max3_u32 v6, v124, v128, v132
    v_mfma_f32_16x16x32_bf16 v[36:39], a[12:15], v[120:123], v[36:39]
    ds_read_b64_tr_b16 a[92:93], v247 offset:22528
    ds_read_b64_tr_b16 a[94:95], v245 offset:23040
    v_cmp_eq_u32 vcc, -1, v6
    v_mfma_f32_16x16x32_bf16 v[40:43], a[16:19], v[120:123], v[40:43]
    ds_read_b64_tr_b16 a[96:97], v244 offset:22528
    ds_read_b64_tr_b16 a[98:99], v246 offset:23040
    v_mfma_f32_16x16x32_bf16 v[44:47], a[20:23], v[120:123], v[44:47]
    ds_read_b64_tr_b16 a[100:101], v245 offset:22528
    ds_read_b64_tr_b16 a[102:103], v247 offset:23040
    s_cbranch_vccnz G2_40_slow
G2_40_back:
    v_mfma_f32_16x16x32_bf16 v[32:35], a[24:27], v[124:127], v[32:35]
    ds_read_b64_tr_b16 a[104:105], v244 offset:31232
    ds_read_b64_tr_b16 a[106:107], v246 offset:31744
    v_mfma_f32_16x16x32_bf16 v[36:39], a[28:31], v[124:127], v[36:39]
    ds_read_b64_tr_b16 a[108:109], v245 offset:31232
    ds_read_b64_tr_b16 a[110:111], v247 offset:31744
    v_mfma_f32_16x16x32_bf16 v[40:43], a[32:35], v[124:127], v[40:43]
    ds_read_b64_tr_b16 a[112:113], v246 offset:31232
    v_mfma_f32_16x16x32_bf16 v[44:47], a[36:39], v[124:127], v[44:47]
    ds_read_b64_tr_b16 a[114:115], v244 offset:31744
    s_waitcnt vmcnt(6)
    v_mfma_f32_16x16x32_bf16 v[32:35], a[40:43], v[128:131], v[32:35]
    ds_read_b64_tr_b16 a[116:117], v247 offset:31232
    ds_read_b64_tr_b16 a[118:119], v245 offset:31744
    v_max3_u32 v6, v134, v138, v142
    v_mfma_f32_16x16x32_bf16 v[36:39], a[44:47], v[128:131], v[36:39]
    ds_read_b64_tr_b16 a[120:121], v244 offset:32256
    v_cmp_eq_u32 vcc, -1, v6
    v_mfma_f32_16x16x32_bf16 v[40:43], a[48:51], v[128:131], v[40:43]
    ds_read_b64_tr_b16 a[122:123], v246 offset:32768
    buffer_load_dwordx4 v[174:177], v252, s[60:63], s17 offen offset:2048 sc1
    v_mfma_f32_16x16x32_bf16 v[44:47], a[52:55], v[128:131], v[44:47]
    ds_read_b64_tr_b16 a[124:125], v245 offset:32256
    s_cbranch_vccnz G2_50_slow
G2_50_back:
    v_mfma_f32_16x16x32_bf16 v[32:35], a[56:59], v[132:135], v[32:35]
    ds_read_b64_tr_b16 a[126:127], v247 offset:32768
    buffer_load_dwordx4 v[178:181], v252, s[60:63], s17 offen offset:3072 sc1
    s_waitcnt lgkmcnt(14)
    v_mfma_f32_16x16x32_bf16 v[36:39], a[60:63], v[132:135], v[36:39]
    ds_read_b64_tr_b16 a[128:129], v246 offset:32256
    ds_read_b64_tr_b16 a[130:131], v244 offset:32768
    v_mfma_f32_16x16x32_bf16 v[40:43], a[64:67], v[132:135], v[40:43]
    ds_read_b64_tr_b16 a[132:133], v247 offset:32256
    buffer_load_dwordx2 v[182:183], v253, s[60:63], s17 offen offset:512 sc1
    v_mfma_f32_16x16x32_bf16 v[44:47], a[68:71], v[132:135], v[44:47]
    ds_read_b64_tr_b16 a[134:135], v245 offset:32768
    buffer_load_dwordx4 v[184:187], v252, s[60:63], s18 offen offset:2048 sc1
    v_mfma_f32_16x16x32_bf16 v[32:35], a[72:75], v[136:139], v[32:35]
    ds_read_b64_tr_b16 a[136:137], v244 offset:33280
    buffer_load_dwordx4 v[188:191], v252, s[60:63], s18 offen offset:3072 sc1
    v_mfma_f32_16x16x32_bf16 v[36:39], a[76:79], v[136:139], v[36:39]
    ds_read_b64_tr_b16 a[138:139], v244 offset:41472
    v_mfma_f32_16x16x32_bf16 v[40:43], a[80:83], v[136:139], v[40:43]
    ds_read_b64_tr_b16 a[140:141], v245 offset:33280
    ds_read_b64_tr_b16 a[142:143], v245 offset:41472
WA_P5:
    s_cbranch_execz WA_R
    s_nop 0
    v_mfma_f32_16x16x32_bf16 v[44:47], a[84:87], v[136:139], v[44:47]
    ds_read_b64_tr_b16 a[144:145], v246 offset:33280
    s_waitcnt vmcnt(8)
    v_mfma_f32_16x16x32_bf16 v[32:35], a[88:91], v[140:143], v[32:35]
    ds_read_b64_tr_b16 a[146:147], v246 offset:41472
    v_max3_u32 v6, v144, v148, v152
    v_mfma_f32_16x16x32_bf16 v[36:39], a[92:95], v[140:143], v[36:39]
    ds_read_b64_tr_b16 a[148:149], v247 offset:33280
    buffer_load_dwordx2 v[192:193], v253, s[60:63], s18 offen offset:512 sc1
    v_cmp_eq_u32 vcc, -1, v6
    v_mfma_f32_16x16x32_bf16 v[40:43], a[96:99], v[140:143], v[40:43]
    ds_read_b64_tr_b16 a[150:151], v247 offset:41472
    buffer_load_dwordx4 v[194:197], v252, s[60:63], s19 offen offset:2048 sc1
    s_waitcnt lgkmcnt(14)
    v_mfma_f32_16x16x32_bf16 v[44:47], a[100:103], v[140:143], v[44:47]
    ds_read_b64_tr_b16 a[56:57], v246 offset:41984
    ds_read_b64_tr_b16 a[58:59], v244 offset:42496
    s_cbranch_vccnz G2_60_slow
G2_60_back:
    v_mfma_f32_16x16x32_bf16 v[32:35], a[104:107], v[144:147], v[32:35]
    ds_read_b64_tr_b16 a[60:61], v247 offset:41984
    buffer_load_dwordx4 v[198:201], v252, s[60:63], s19 offen offset:3072 sc1
    v_mfma_f32_16x16x32_bf16 v[36:39], a[108:111], v[144:147], v[36:39]
    ds_read_b64_tr_b16 a[62:63], v245 offset:42496
    buffer_load_dwordx2 v[202:203], v253, s[60:63], s19 offen offset:512 sc1
    v_mfma_f32_16x16x32_bf16 v[40:43], a[112:115], v[144:147], v[40:43]
    ds_read_b64_tr_b16 a[64:65], v244 offset:41984
    v_mfma_f32_16x16x32_bf16 v[44:47], a[116:119], v[144:147], v[44:47]
    ds_read_b64_tr_b16 a[66:67], v246 offset:42496
    s_waitcnt vmcnt(9)
    v_mfma_f32_16x16x32_bf16 v[32:35], a[120:123], v[148:151], v[32:35]
    ds_read_b64_tr_b16 a[68:69], v245 offset:41984
    ds_read_b64_tr_b16 a[70:71], v247 offset:42496
    s_waitcnt lgkmcnt(14)
    v_max3_u32 v6, v154, v158, v162
    v_mfma_f32_16x16x32_bf16 v[36:39], a[124:127], v[148:151], v[36:39]
    ds_read_b64_tr_b16 a[72:73], v246 offset:43008
    v_cmp_eq_u32 vcc, -1, v6
    v_mfma_f32_16x16x32_bf16 v[40:43], a[128:131], v[148:151], v[40:43]
    ds_read_b64_tr_b16 a[74:75], v244 offset:43520
    buffer_load_dwordx4 v[204:207], v252, s[60:63], s20 offen offset:2048 sc1
    v_mfma_f32_16x16x32_bf16 v[44:47], a[132:135], v[148:151], v[44:47]
    ds_read_b64_tr_b16 a[76:77], v247 offset:43008
    s_cbranch_vccnz G2_70_slow
G2_70_back:
    v_mfma_f32_16x16x32_bf16 v[32:35], a[136:139], v[152:155], v[32:35]
    ds_read_b64_tr_b16 a[78:79], v245 offset:43520
    buffer_load_dwordx4 v[208:211], v252, s[60:63], s20 offen offset:3072 sc1
    s_waitcnt lgkmcnt(10)
    v_mfma_f32_16x16x32_bf16 v[36:39], a[140:143], v[152:155], v[36:39]
    ds_read_b64_tr_b16 a[80:81], v244 offset:43008
    ds_read_b64_tr_b16 a[82:83], v246 offset:43520
    v_mfma_f32_16x16x32_bf16 v[40:43], a[144:147], v[152:155], v[40:43]
    ds_read_b64_tr_b16 a[84:85], v245 offset:43008
    buffer_load_dwordx2 v[212:213], v253, s[60:63], s20 offen offset:512 sc1
    v_mfma_f32_16x16x32_bf16 v[44:47], a[148:151], v[152:155], v[44:47]
    ds_read_b64_tr_b16 a[86:87], v247 offset:43520
    v_mfma_f32_16x16x32_bf16 v[32:35], a[56:59], v[156:159], v[32:35]
    buffer_load_dwordx4 v[214:217], v252, s[60:63], s21 offen offset:2048 sc1
    s_waitcnt lgkmcnt(6)
    v_mfma_f32_16x16x32_bf16 v[36:39], a[60:63], v[156:159], v[36:39]
    v_mfma_f32_16x16x32_bf16 v[40:43], a[64:67], v[156:159], v[40:43]
    buffer_load_dwordx4 v[218:221], v252, s[60:63], s21 offen offset:3072 sc1
    v_mfma_f32_16x16x32_bf16 v[44:47], a[68:71], v[156:159], v[44:47]
    v_mfma_f32_16x16x32_bf16 v[32:35], a[72:75], v[160:163], v[32:35]
    buffer_load_dwordx2 v[222:223], v253, s[60:63], s21 offen offset:512 sc1
    s_waitcnt lgkmcnt(4)
    v_mfma_f32_16x16x32_bf16 v[36:39], a[76:79], v[160:163], v[36:39]
    s_waitcnt lgkmcnt(2)
    v_mfma_f32_16x16x32_bf16 v[40:43], a[80:83], v[160:163], v[40:43]
    buffer_load_dwordx4 v[224:227], v252, s[60:63], s22 offen offset:2048 sc1
    s_waitcnt lgkmcnt(0)
    v_mfma_f32_16x16x32_bf16 v[44:47], a[84:87], v[160:163], v[44:47]
    s_waitcnt vmcnt(13)
    v_max3_u32 v6, v174, v178, v182
    v_cmp_eq_u32 vcc, -1, v6
    s_nop 4
    s_cbranch_vccnz G2_11_slow
G2_11_back:
    v_mfma_f32_16x16x32_bf16 v[48:51], a[152:155], v[172:175], v[48:51]
    ds_read_b64_tr_b16 a[152:153], v244 offset:12800
    buffer_load_dwordx4 v[228:231], v252, s[60:63], s22 offen offset:3072 sc1
    v_mfma_f32_16x16x32_bf16 v[52:55], a[156:159], v[172:175], v[52:55]
    ds_read_b64_tr_b16 a[154:155], v244 offset:20992
    v_mfma_f32_16x16x32_bf16 v[56:59], a[160:163], v[172:175], v[56:59]
    ds_read_b64_tr_b16 a[156:157], v245 offset:12800
    buffer_load_dwordx2 v[232:233], v253, s[60:63], s22 offen offset:512 sc1
    v_mfma_f32_16x16x32_bf16 v[60:63], a[164:167], v[172:175], v[60:63]
    ds_read_b64_tr_b16 a[158:159], v245 offset:20992
    v_mfma_f32_16x16x32_bf16 v[48:51], a[168:171], v[176:179], v[48:51]
    ds_read_b64_tr_b16 a[160:161], v246 offset:12800
    buffer_load_dwordx4 v[234:237], v252, s[60:63], s23 offen offset:2048 sc1
    v_mfma_f32_16x16x32_bf16 v[52:55], a[172:175], v[176:179], v[52:55]
    ds_read_b64_tr_b16 a[162:163], v246 offset:20992
    v_cvt_pk_bf16_f32 v64, v32, v33
    v_mfma_f32_16x16x32_bf16 v[56:59], a[176:179], v[176:179], v[56:59]
    ds_read_b64_tr_b16 a[164:165], v247 offset:12800
    v_cvt_pk_bf16_f32 v65, v34, v35
    v_mfma_f32_16x16x32_bf16 v[60:63], a[180:183], v[176:179], v[60:63]
    ds_read_b64_tr_b16 a[166:167], v247 offset:20992
    v_cvt_pk_bf16_f32 v66, v36, v37
    s_waitcnt vmcnt(13)
    v_mfma_f32_16x16x32_bf16 v[48:51], a[184:187], v[180:183], v[48:51]
    ds_read_b64_tr_b16 a[168:169], v246 offset:21504
    v_cvt_pk_bf16_f32 v67, v38, v39
    v_max3_u32 v6, v184, v188, v192
    v_mfma_f32_16x16x32_bf16 v[52:55], a[188:191], v[180:183], v[52:55]
    ds_read_b64_tr_b16 a[170:171], v244 offset:22016
    v_cvt_pk_bf16_f32 v68, v40, v41
    v_cmp_eq_u32 vcc, -1, v6
    v_mfma_f32_16x16x32_bf16 v[56:59], a[192:195], v[180:183], v[56:59]
    ds_read_b64_tr_b16 a[172:173], v247 offset:21504
    v_cvt_pk_bf16_f32 v69, v42, v43
    v_cvt_pk_bf16_f32 v70, v44, v45
    v_mfma_f32_16x16x32_bf16 v[60:63], a[196:199], v[180:183], v[60:63]
    ds_read_b64_tr_b16 a[174:175], v245 offset:22016
    v_cvt_pk_bf16_f32 v71, v46, v47
    s_cbranch_vccnz G2_21_slow
G2_21_back:
    v_mfma_f32_16x16x32_bf16 v[48:51], a[200:203], v[184:187], v[48:51]
    ds_read_b64_tr_b16 a[176:177], v244 offset:21504
    v_permlane16_swap_b32 v64, v66
    v_permlane16_swap_b32 v65, v67
    v_mfma_f32_16x16x32_bf16 v[52:55], a[204:207], v[184:187], v[52:55]
    ds_read_b64_tr_b16 a[178:179], v246 offset:22016
    v_permlane16_swap_b32 v68, v70
    v_permlane16_swap_b32 v69, v71
    v_mfma_f32_16x16x32_bf16 v[56:59], a[208:211], v[184:187], v[56:59]
    ds_read_b64_tr_b16 a[180:181], v245 offset:21504
    buffer_load_dwordx4 v[238:241], v252, s[60:63], s23 offen offset:3072 sc1
    buffer_load_dwordx2 v[242:243], v253, s[60:63], s23 offen offset:512 sc1
    v_mfma_f32_16x16x32_bf16 v[60:63], a[212:215], v[184:187], v[60:63]
    ds_read_b64_tr_b16 a[182:183], v247 offset:22016
    s_waitcnt vmcnt(12)
    v_mfma_f32_16x16x32_bf16 v[48:51], a[216:219], v[188:191], v[48:51]
    v_max3_u32 v6, v194, v198, v202
    v_mfma_f32_16x16x32_bf16 v[52:55], a[220:223], v[188:191], v[52:55]
    v_cmp_eq_u32 vcc, -1, v6
    v_mfma_f32_16x16x32_bf16 v[56:59], a[224:227], v[188:191], v[56:59]
    v_mfma_f32_16x16x32_bf16 v[60:63], a[228:231], v[188:191], v[60:63]
    s_nop 2
    s_cbranch_vccnz G2_31_slow
G2_31_back:
    v_mfma_f32_16x16x32_bf16 v[48:51], a[232:235], v[192:195], v[48:51]
    v_mfma_f32_16x16x32_bf16 v[52:55], a[236:239], v[192:195], v[52:55]
    v_mfma_f32_16x16x32_bf16 v[56:59], a[240:243], v[192:195], v[56:59]
    v_mfma_f32_16x16x32_bf16 v[60:63], a[244:247], v[192:195], v[60:63]
    v_mfma_f32_16x16x32_bf16 v[48:51], a[248:251], v[196:199], v[48:51]
    ds_write_b128 v255, v[64:67] offset:51712
    v_mfma_f32_16x16x32_bf16 v[52:55], a[252:255], v[196:199], v[52:55]
    ds_write_b128 v255, v[68:71] offset:51776
    v_mfma_f32_16x16x32_bf16 v[56:59], a[0:3], v[196:199], v[56:59]
    v_mfma_f32_16x16x32_bf16 v[60:63], a[4:7], v[196:199], v[60:63]
    s_waitcnt vmcnt(9)
    v_mfma_f32_16x16x32_bf16 v[48:51], a[8:11], v[200:203], v[48:51]
    v_max3_u32 v6, v204, v208, v212
    v_mfma_f32_16x16x32_bf16 v[52:55], a[12:15], v[200:203], v[52:55]
    v_cmp_eq_u32 vcc, -1, v6
    v_mfma_f32_16x16x32_bf16 v[56:59], a[16:19], v[200:203], v[56:59]
    ds_read_b128 v[32:35], v9 offset:51712
    v_mfma_f32_16x16x32_bf16 v[60:63], a[20:23], v[200:203], v[60:63]
    ds_read_b128 v[36:39], v9 offset:52864
    s_nop 0
    s_cbranch_vccnz G2_41_slow
G2_41_back:
    v_mfma_f32_16x16x32_bf16 v[48:51], a[24:27], v[204:207], v[48:51]
    v_mfma_f32_16x16x32_bf16 v[52:55], a[28:31], v[204:207], v[52:55]
    v_mfma_f32_16x16x32_bf16 v[56:59], a[32:35], v[204:207], v[56:59]
    v_mfma_f32_16x16x32_bf16 v[60:63], a[36:39], v[204:207], v[60:63]
    s_waitcnt vmcnt(6)
    v_mfma_f32_16x16x32_bf16 v[48:51], a[40:43], v[208:211], v[48:51]
    v_max3_u32 v6, v214, v218, v222
    v_mfma_f32_16x16x32_bf16 v[52:55], a[44:47], v[208:211], v[52:55]
    v_cmp_eq_u32 vcc, -1, v6
    v_mfma_f32_16x16x32_bf16 v[56:59], a[48:51], v[208:211], v[56:59]
    s_mov_b32 s44, 0
    s_waitcnt lgkmcnt(1)
    v_mfma_f32_16x16x32_bf16 v[60:63], a[52:55], v[208:211], v[60:63]
    buffer_store_dwordx4 v[32:35], v254, s[68:71], s44 offen sc1
    s_cbranch_vccnz G2_51_slow
G2_51_back:
    v_mfma_f32_16x16x32_bf16 v[48:51], a[152:155], v[212:215], v[48:51]
    s_mov_b32 s44, 20480
    s_waitcnt lgkmcnt(0)
    v_mfma_f32_16x16x32_bf16 v[52:55], a[156:159], v[212:215], v[52:55]
    buffer_store_dwordx4 v[36:39], v254, s[68:71], s44 offen sc1
    v_mfma_f32_16x16x32_bf16 v[56:59], a[160:163], v[212:215], v[56:59]
    v_mfma_f32_16x16x32_bf16 v[60:63], a[164:167], v[212:215], v[60:63]
    v_mfma_f32_16x16x32_bf16 v[48:51], a[168:171], v[216:219], v[48:51]
    v_mfma_f32_16x16x32_bf16 v[52:55], a[172:175], v[216:219], v[52:55]
    v_mfma_f32_16x16x32_bf16 v[56:59], a[176:179], v[216:219], v[56:59]
    v_mfma_f32_16x16x32_bf16 v[60:63], a[180:183], v[216:219], v[60:63]
    s_waitcnt vmcnt(5)
    v_mfma_f32_16x16x32_bf16 v[48:51], a[88:91], v[220:223], v[48:51]
    v_max3_u32 v6, v224, v228, v232
    v_mfma_f32_16x16x32_bf16 v[52:55], a[92:95], v[220:223], v[52:55]
    v_cmp_eq_u32 vcc, -1, v6
    v_mfma_f32_16x16x32_bf16 v[56:59], a[96:99], v[220:223], v[56:59]
    v_mfma_f32_16x16x32_bf16 v[60:63], a[100:103], v[220:223], v[60:63]
    s_nop 2
    s_cbranch_vccnz G2_61_slow
G2_61_back:
    v_mfma_f32_16x16x32_bf16 v[48:51], a[104:107], v[224:227], v[48:51]
    v_mfma_f32_16x16x32_bf16 v[52:55], a[108:111], v[224:227], v[52:55]
    v_mfma_f32_16x16x32_bf16 v[56:59], a[112:115], v[224:227], v[56:59]
    v_mfma_f32_16x16x32_bf16 v[60:63], a[116:119], v[224:227], v[60:63]
    s_waitcnt vmcnt(2)
    v_mfma_f32_16x16x32_bf16 v[48:51], a[120:123], v[228:231], v[48:51]
    v_max3_u32 v6, v234, v238, v242
    v_mfma_f32_16x16x32_bf16 v[52:55], a[124:127], v[228:231], v[52:55]
    v_cmp_eq_u32 vcc, -1, v6
    v_mfma_f32_16x16x32_bf16 v[56:59], a[128:131], v[228:231], v[56:59]
    v_mfma_f32_16x16x32_bf16 v[60:63], a[132:135], v[228:231], v[60:63]
    s_nop 2
    s_cbranch_vccnz G2_71_slow
G2_71_back:
    v_mfma_f32_16x16x32_bf16 v[48:51], a[136:139], v[232:235], v[48:51]
    v_mfma_f32_16x16x32_bf16 v[52:55], a[140:143], v[232:235], v[52:55]
    v_mfma_f32_16x16x32_bf16 v[48:51], a[56:59], v[236:239], v[48:51]
    v_mfma_f32_16x16x32_bf16 v[52:55], a[60:63], v[236:239], v[52:55]
    v_mfma_f32_16x16x32_bf16 v[48:51], a[72:75], v[240:243], v[48:51]
    v_mfma_f32_16x16x32_bf16 v[52:55], a[76:79], v[240:243], v[52:55]
    v_mfma_f32_16x16x32_bf16 v[56:59], a[144:147], v[232:235], v[56:59]
    v_mfma_f32_16x16x32_bf16 v[60:63], a[148:151], v[232:235], v[60:63]
    v_mfma_f32_16x16x32_bf16 v[56:59], a[64:67], v[236:239], v[56:59]
    s_nop 3
    v_cvt_pk_bf16_f32 v72, v48, v49
    v_cvt_pk_bf16_f32 v73, v50, v51
    v_mfma_f32_16x16x32_bf16 v[60:63], a[68:71], v[236:239], v[60:63]
    v_cvt_pk_bf16_f32 v74, v52, v53
    v_cvt_pk_bf16_f32 v75, v54, v55
    v_mfma_f32_16x16x32_bf16 v[56:59], a[80:83], v[240:243], v[56:59]
    v_permlane16_swap_b32 v72, v74
    v_permlane16_swap_b32 v73, v75
    v_mfma_f32_16x16x32_bf16 v[60:63], a[84:87], v[240:243], v[60:63]
    ds_write_b128 v255, v[72:75] offset:54016
    s_nop 3
    v_cvt_pk_bf16_f32 v76, v56, v57
    v_cvt_pk_bf16_f32 v77, v58, v59
    s_nop 0
    v_cvt_pk_bf16_f32 v78, v60, v61
    v_cvt_pk_bf16_f32 v79, v62, v63
    s_nop 0
    v_permlane16_swap_b32 v76, v78
    v_permlane16_swap_b32 v77, v79
    ds_write_b128 v255, v[76:79] offset:54080
    ds_read_b128 v[48:51], v9 offset:54016
    ds_read_b128 v[52:55], v9 offset:55168
    s_mov_b32 s44, 40960
    s_waitcnt lgkmcnt(1)
    buffer_store_dwordx4 v[48:51], v254, s[68:71], s44 offen
    s_mov_b32 s44, 61440
    s_waitcnt lgkmcnt(0)
    buffer_store_dwordx4 v[52:55], v254, s[68:71], s44 offen
L_done:
L_exit:
    s_endpgm
    .p2align 3
    .p2align 12,,768
L_H:
    s_cmp_lt_u32 s34, 28
    s_cbranch_scc1 L_P
    s_cmp_lg_u32 s34, 31
    s_cbranch_scc1 L_H2
    s_cmp_ge_u32 s32, 2
    s_cbranch_scc1 L_H2
    s_and_b32 s44, s33, 1
    s_lshl1_add_u32 s44, s44, s32
    s_mulk_i32 s44, 50
    v_min_u32 v17, 49, v1
    v_add_lshl_u32 v17, v17, s44, 7
    global_load_dword v63, v17, s[8:9]
L_H2:
    s_sub_u32 s34, s34, 28
    s_lshr_b32 s36, s33, 1
    s_and_b32 s37, s33, 1
    v_and_b32 v1, 63, v0
    v_and_b32_e64 v2, 15, v0
    v_bfe_u32 v3, v0, 4, 2
    v_bfe_u32 v4, v0, 2, 2
    v_and_b32 v5, 3, v0
    s_lshl_b32 s43, s34, 2
    s_add_u32 s43, s43, s32
    s_mov_b32 s60, s30
    s_and_b32 s61, s31, 0xffff
    s_mov_b32 s62, 4194304
    s_mov_b32 s63, 0x20000
    s_mov_b32 s68, s28
    s_and_b32 s69, s29, 0xffff
    s_mov_b32 s70, 256
    s_mov_b32 s71, 0x20000
    s_mov_b32 s64, s10
    s_and_b32 s65, s11, 0xffff
    s_mov_b32 s66, 819200
    s_mov_b32 s67, 0x20000
    s_mov_b32 s56, s6
    s_and_b32 s57, s7, 0xffff
    s_mov_b32 s58, 2457600
    s_mov_b32 s59, 0x20000
    s_waitcnt vmcnt(0)
    s_mov_b32 s38, s34
    s_lshl2_add_u32 s40, s36, s38
    s_mul_i32 s49, s37, 5
    s_add_u32 s49, s49, 4
    s_lshl_b32 s51, s37, 2
    s_xor_b32 s51, s51, 0
    v_lshrrev_b32 v6, 3, v1
    v_mul_u32_u24 v6, 1280, v6
    v_and_b32 v7, 7, v1
    v_lshlrev_b32 v8, 1, v3
    v_xor_b32 v7, v7, v8
    v_lshl_add_u32 v20, v7, 4, v6
    s_lshl_b32 s44, s49, 7
    v_add_u32 v20, s44, v20
    s_lshl_b32 s35, s51, 1
    s_xor_b32 s35, s35, s32
    s_mul_i32 s48, s32, 5120
    s_mul_i32 s76, s33, 524288
    s_lshl_b32 s44, s34, 11
    s_add_u32 s76, s76, s44
    s_add_u32 s76, s76, 139264
    s_lshl4_add_u32 s44, s33, s43
    s_mul_i32 s47, s44, 19200
    s_mul_i32 s46, s44, 6400
    v_min_u32 v18, 49, v1
    v_mul_u32_u24 v17, 6554, v18
    v_lshrrev_b32_e64 v17, 16, v17
    v_mad_u32_u24 v17, v17, 20, v18
    v_lshlrev_b32 v17, 7, v17
    v_lshlrev_b32 v18, 7, v18
    buffer_load_dword v63, v17, s[56:59], s47 offen
    buffer_load_dword v63, v18, s[64:67], s46 offen
    s_waitcnt vmcnt(0)
    s_xor_b32 s44, s35, 0
    s_mul_i32 s47, s44, 51200
    s_add_u32 m0, s48, 117248
    s_nop 0
    s_nop 0
    buffer_load_dwordx4 v20, s[64:67], s47 offen offset:0 lds
    s_add_u32 s47, s47, 9216
    buffer_load_dwordx4 v20, s[64:67], s47 offen offset:1024 lds
    s_add_u32 s47, s47, 9216
    buffer_load_dwordx4 v20, s[64:67], s47 offen offset:2048 lds
    s_add_u32 s47, s47, 9216
    buffer_load_dwordx4 v20, s[64:67], s47 offen offset:3072 lds
    s_add_u32 m0, s48, 121344
    s_add_u32 s47, s47, 13312
    buffer_load_dwordx4 v20, s[64:67], s47 offen offset:0 lds
    s_xor_b32 s44, s35, 4
    s_mul_i32 s47, s44, 51200
    s_add_u32 m0, s48, 137728
    s_nop 0
    buffer_load_dwordx4 v20, s[64:67], s47 offen offset:0 lds
    s_add_u32 s47, s47, 9216
    buffer_load_dwordx4 v20, s[64:67], s47 offen offset:1024 lds
    s_add_u32 s47, s47, 9216
    buffer_load_dwordx4 v20, s[64:67], s47 offen offset:2048 lds
    s_add_u32 s47, s47, 9216
    buffer_load_dwordx4 v20, s[64:67], s47 offen offset:3072 lds
    s_add_u32 m0, s48, 141824
    s_add_u32 s47, s47, 13312
    buffer_load_dwordx4 v20, s[64:67], s47 offen offset:0 lds
    s_xor_b32 s44, s35, 8
    s_mul_i32 s47, s44, 51200
    s_add_u32 m0, s48, 10752
    s_nop 0
    buffer_load_dwordx4 v20, s[64:67], s47 offen offset:0 lds
    s_add_u32 s47, s47, 9216
    buffer_load_dwordx4 v20, s[64:67], s47 offen offset:1024 lds
    s_add_u32 s47, s47, 9216
    buffer_load_dwordx4 v20, s[64:67], s47 offen offset:2048 lds
    s_add_u32 s47, s47, 9216
    buffer_load_dwordx4 v20, s[64:67], s47 offen offset:3072 lds
    s_add_u32 m0, s48, 14848
    s_add_u32 s47, s47, 13312
    buffer_load_dwordx4 v20, s[64:67], s47 offen offset:0 lds
    s_xor_b32 s44, s35, 12
    s_mul_i32 s47, s44, 51200
    s_add_u32 m0, s48, 31232
    s_nop 0
    buffer_load_dwordx4 v20, s[64:67], s47 offen offset:0 lds
    s_add_u32 s47, s47, 9216
    buffer_load_dwordx4 v20, s[64:67], s47 offen offset:1024 lds
    s_add_u32 s47, s47, 9216
    buffer_load_dwordx4 v20, s[64:67], s47 offen offset:2048 lds
    s_add_u32 s47, s47, 9216
    buffer_load_dwordx4 v20, s[64:67], s47 offen offset:3072 lds
    s_add_u32 m0, s48, 35328
    s_add_u32 s47, s47, 13312
    buffer_load_dwordx4 v20, s[64:67], s47 offen offset:0 lds
    s_waitcnt vmcnt(0)
    s_mul_i32 s45, s43, 52
    s_lshr_b32 s45, s45, 8
    s_sub_u32 s44, s37, s45
    s_mul_i32 s44, s44, 5
    s_add_u32 s44, s44, s43
    s_lshl_b32 s44, s44, 7
    s_mul_i32 s47, s45, 245760
    s_add_u32 s47, s47, s44
    s_mul_i32 s46, s45, 81920
    s_add_u32 s46, s46, s44
    s_nop 0
    v_mul_u32_u24 v17, 3840, v1
    v_mul_u32_u24 v18, 1280, v1
    s_add_u32 s47, s47, 983040
    buffer_load_dword v63, v17, s[56:59], s47 offen
    s_add_u32 s47, s47, 737280
    buffer_load_dword v63, v17, s[56:59], s47 offen
    s_add_u32 s47, s47, 737280
    s_waitcnt vmcnt(0)
    s_mul_i32 s45, s37, 524288
    s_mul_i32 s77, s40, 2176
    s_add_u32 s77, s77, s45
    s_mul_i32 s44, s32, 1048576
    v_mul_u32_u24 v9, 34816, v5
    v_add_u32 v9, s44, v9
    v_mov_b32_e64 v7, 0
    s_lshl_b32 s44, s32, 9
    v_lshl_add_u32 v11, v2, 4, s44
    v_mul_u32_u24 v10, 34816, v3
    v_add_u32 v10, v10, v11
    v_lshrrev_b32 v6, 1, v3
    v_lshl_add_u32 v11, v6, 8, v11
    v_and_b32 v6, 1, v3
    v_lshl_add_u32 v11, v6, 3, v11
    s_add_u32 s16, s77, 0
    s_add_u32 s17, s77, 1048576
    s_add_u32 s18, s77, 2097152
    s_add_u32 s19, s77, 3145728
    v_and_b32 v6, 1, v2
    v_lshlrev_b32 v6, 4, v6
    v_mov_b32 v8, 0x3f80
    v_lshlrev_b32 v6, v6, v8
    v_lshrrev_b32 v8, 1, v2
    v_cmp_eq_u32 vcc, 0, v8
    s_nop 1
    v_cndmask_b32 v64, 0, v6, vcc
    v_cmp_eq_u32 vcc, 1, v8
    s_nop 1
    v_cndmask_b32 v65, 0, v6, vcc
    v_cmp_eq_u32 vcc, 2, v8
    s_nop 1
    v_cndmask_b32 v66, 0, v6, vcc
    v_cmp_eq_u32 vcc, 3, v8
    s_nop 1
    v_cndmask_b32 v67, 0, v6, vcc
    v_cmp_eq_u32 vcc, 4, v8
    s_nop 1
    v_cndmask_b32 v68, 0, v6, vcc
    v_cmp_eq_u32 vcc, 5, v8
    s_nop 1
    v_cndmask_b32 v69, 0, v6, vcc
    v_cmp_eq_u32 vcc, 6, v8
    s_nop 1
    v_cndmask_b32 v70, 0, v6, vcc
    v_cmp_eq_u32 vcc, 7, v8
    s_nop 1
    v_cndmask_b32 v71, 0, v6, vcc
    s_mov_b64 exec, 0
    s_cmp_eq_u32 s32, 0
    s_cbranch_scc1 WH_P0
    s_cmp_eq_u32 s32, 1
    s_cbranch_scc1 WH_P1
    s_cmp_eq_u32 s32, 2
    s_cbranch_scc1 WH_P2
    s_branch WH_P3
WH_P1:
WH_P2:
WH_P3:
WH_R:
    s_mov_b64 exec, -1
    s_waitcnt vmcnt(0)
    s_mov_b32 s50, 60000
H_cnt:
    buffer_load_dword v31, v7, s[68:71], 0 offen sc1
    s_waitcnt vmcnt(0)
    v_cmp_eq_u32 vcc, 0, v31
    s_nop 4
    s_cbranch_vccz H_cnt_ok
    s_sleep 8
    s_sub_u32 s50, s50, 1
    s_cmp_lg_u32 s50, 0
    s_cbranch_scc1 H_cnt
H_cnt_ok:
    s_mov_b32 s50, 60000
H_part:
    buffer_load_dword v6, v9, s[60:63], s77 offen offset:2048 sc1
    s_waitcnt vmcnt(0)
    v_cmp_eq_u32_e64 vcc, -1, v6
    s_nop 4
    s_cbranch_vccz H_part_ok
    s_sleep 2
    s_sub_u32 s50, s50, 1
    s_cmp_lg_u32 s50, 0
    s_cbranch_scc1 H_part
H_part_ok:
    s_barrier
    s_mov_b32 s50, 60000
H_load:
    buffer_load_dwordx4 v[32:35], v10, s[60:63], s16 offen offset:0 sc1
    buffer_load_dwordx4 v[36:39], v10, s[60:63], s16 offen offset:256 sc1
    buffer_load_dwordx4 v[40:43], v10, s[60:63], s17 offen offset:0 sc1
    buffer_load_dwordx4 v[44:47], v10, s[60:63], s17 offen offset:256 sc1
    buffer_load_dwordx4 v[48:51], v10, s[60:63], s18 offen offset:0 sc1
    buffer_load_dwordx4 v[52:55], v10, s[60:63], s18 offen offset:256 sc1
    buffer_load_dwordx4 v[56:59], v10, s[60:63], s19 offen offset:0 sc1
    buffer_load_dwordx4 v[60:63], v10, s[60:63], s19 offen offset:256 sc1
    s_waitcnt vmcnt(6)
    v_mfma_f32_16x16x32_bf16 v[80:83], v[64:67], v[32:35], 0
    v_mfma_f32_16x16x32_bf16 v[80:83], v[68:71], v[36:39], v[80:83]
    v_max_u32 v6, v32, v36
    s_waitcnt vmcnt(4)
    v_mfma_f32_16x16x32_bf16 v[80:83], v[64:67], v[40:43], v[80:83]
    v_mfma_f32_16x16x32_bf16 v[80:83], v[68:71], v[44:47], v[80:83]
    v_max3_u32 v6, v6, v40, v44
    s_waitcnt vmcnt(2)
    v_mfma_f32_16x16x32_bf16 v[80:83], v[64:67], v[48:51], v[80:83]
    v_mfma_f32_16x16x32_bf16 v[80:83], v[68:71], v[52:55], v[80:83]
    v_max3_u32 v6, v6, v48, v52
    s_waitcnt vmcnt(0)
    v_mfma_f32_16x16x32_bf16 v[80:83], v[64:67], v[56:59], v[80:83]
    v_mfma_f32_16x16x32_bf16 v[80:83], v[68:71], v[60:63], v[80:83]
    v_max3_u32 v6, v6, v56, v60
    v_cmp_eq_u32 vcc, -1, v6
    s_nop 4
    s_cbranch_vccnz H_retry
H_store:
    v_cvt_pk_bf16_f32 v80, v80, v81
    v_cvt_pk_bf16_f32 v81, v82, v83
    v_min_u32 v80, -2, v80
    buffer_store_dwordx2 v[80:81], v11, s[60:63], s76 offen sc1
    v_mov_b32 v7, 0
    s_mov_b32 s50, 60000
GH_c2:
    buffer_load_dword v31, v7, s[68:71], 0 offen offset:4 sc1
    s_waitcnt vmcnt(0)
    v_cmp_eq_u32 vcc, 0, v31
    s_nop 4
    s_cbranch_vccz GH_c2_ok
    s_sleep 8
    s_sub_u32 s50, s50, 1
    s_cmp_lg_u32 s50, 0
    s_cbranch_scc1 GH_c2
GH_c2_ok:
    v_mul_u32_u24_e64 v237, 20, v3
    v_add_lshl_u32 v237, v237, v4, 7
    v_lshl_add_u32 v237, v5, 3, v237
    v_bfe_u32 v238, v1, 3, 2
    v_xor_b32_e64 v239, 0, v238
    v_lshl_add_u32 v244, v239, 5, v237
    v_add_u32 v248, 117248, v244
    v_xor_b32_e64 v239, 1, v238
    v_lshl_add_u32 v245, v239, 5, v237
    v_add_u32 v249, 117248, v245
    v_xor_b32_e64 v239, 2, v238
    v_lshl_add_u32 v246, v239, 5, v237
    v_add_u32 v250, 117248, v246
    v_xor_b32_e64 v239, 3, v238
    v_lshl_add_u32 v247, v239, 5, v237
    v_add_u32 v251, 117248, v247
    v_lshlrev_b32 v252, 4, v1
    v_lshlrev_b32 v253, 3, v1
    v_add_u32 v253, 4096, v253
    s_lshl2_add_u32 s45, s38, s32
    s_mul_i32 s75, s45, 20992
    s_add_u32 s75, s75, 147456
    s_lshl2_add_u32 s45, s40, s32
    s_mul_i32 s45, s45, 81920
    s_lshl_b32 s43, s49, 7
    s_add_u32 s45, s45, s43
    v_mul_u32_u24 v255, 144, v2
    v_and_b32_e64 v238, 1, v3
    v_lshl_add_u32 v255, v238, 5, v255
    v_lshrrev_b32 v238, 1, v3
    v_lshlrev_b32 v238, 4, v238
    v_add3_u32 v255, v255, v238, s48
    v_lshrrev_b32 v237, 3, v1
    v_and_b32 v238, 7, v1
    v_lshlrev_b32_e64 v238, 4, v238
    v_mul_u32_u24 v239, 144, v237
    v_add3_u32 v9, v239, v238, s48
    v_mul_u32_u24 v254, 2560, v237
    v_add3_u32 v254, v254, v238, s45
    s_mul_i32 s45, s33, 524288
    s_add_u32 s75, s75, s45
    s_and_b32 s43, s51, 3
    s_xor_b32 s45, s43, 0
    s_mulk_i32 s45, 5248
    s_add_u32 s16, s75, s45
    s_xor_b32 s20, s16, 524288
    s_xor_b32 s45, s43, 1
    s_mulk_i32 s45, 5248
    s_add_u32 s17, s75, s45
    s_xor_b32 s21, s17, 524288
    s_xor_b32 s45, s43, 2
    s_mulk_i32 s45, 5248
    s_add_u32 s18, s75, s45
    s_xor_b32 s22, s18, 524288
    s_xor_b32 s45, s43, 3
    s_mulk_i32 s45, 5248
    s_add_u32 s19, s75, s45
    s_xor_b32 s23, s19, 524288
    s_mov_b32 s68, s26
    s_nop 0
    s_and_b32 s69, s27, 0xffff
    s_mov_b32 s70, 5242880
    s_mov_b32 s71, 0x20000
    ds_read_b64_tr_b16 a[120:121], v248 offset:0
    ds_read_b64_tr_b16 a[122:123], v250 offset:512
    ds_read_b64_tr_b16 a[124:125], v249 offset:0
    ds_read_b64_tr_b16 a[126:127], v251 offset:512
    ds_read_b64_tr_b16 a[128:129], v250 offset:0
    ds_read_b64_tr_b16 a[130:131], v248 offset:512
    ds_read_b64_tr_b16 a[132:133], v251 offset:0
    ds_read_b64_tr_b16 a[134:135], v249 offset:512
    ds_read_b64_tr_b16 a[136:137], v248 offset:1024
    ds_read_b64_tr_b16 a[138:139], v250 offset:1536
    ds_read_b64_tr_b16 a[140:141], v249 offset:1024
    ds_read_b64_tr_b16 a[142:143], v251 offset:1536
    ds_read_b64_tr_b16 a[144:145], v250 offset:1024
    ds_read_b64_tr_b16 a[146:147], v248 offset:1536
    ds_read_b64_tr_b16 a[148:149], v251 offset:1024
    ds_read_b64_tr_b16 a[150:151], v249 offset:1536
    ds_read_b64_tr_b16 a[152:153], v248 offset:2048
    ds_read_b64_tr_b16 a[154:155], v248 offset:10240
    ds_read_b64_tr_b16 a[156:157], v249 offset:2048
    ds_read_b64_tr_b16 a[158:159], v249 offset:10240
    ds_read_b64_tr_b16 a[160:161], v250 offset:2048
    ds_read_b64_tr_b16 a[162:163], v250 offset:10240
    ds_read_b64_tr_b16 a[164:165], v251 offset:2048
    ds_read_b64_tr_b16 a[166:167], v251 offset:10240
    ds_read_b64_tr_b16 a[168:169], v250 offset:10752
    ds_read_b64_tr_b16 a[170:171], v248 offset:11264
    ds_read_b64_tr_b16 a[172:173], v251 offset:10752
    ds_read_b64_tr_b16 a[174:175], v249 offset:11264
    ds_read_b64_tr_b16 a[176:177], v248 offset:10752
    ds_read_b64_tr_b16 a[178:179], v250 offset:11264
    ds_read_b64_tr_b16 a[180:181], v249 offset:10752
    ds_read_b64_tr_b16 a[182:183], v251 offset:11264
    ds_read_b64_tr_b16 a[184:185], v250 offset:11776
    ds_read_b64_tr_b16 a[186:187], v248 offset:12288
    ds_read_b64_tr_b16 a[188:189], v251 offset:11776
    ds_read_b64_tr_b16 a[190:191], v249 offset:12288
    ds_read_b64_tr_b16 a[192:193], v248 offset:11776
    ds_read_b64_tr_b16 a[194:195], v250 offset:12288
    ds_read_b64_tr_b16 a[196:197], v249 offset:11776
    ds_read_b64_tr_b16 a[198:199], v251 offset:12288
    ds_read_b64_tr_b16 a[200:201], v248 offset:20480
    ds_read_b64_tr_b16 a[202:203], v250 offset:20992
    ds_read_b64_tr_b16 a[204:205], v249 offset:20480
WH_P0:
    s_cbranch_execz WH_R
    s_nop 0
    ds_read_b64_tr_b16 a[206:207], v251 offset:20992
    ds_read_b64_tr_b16 a[208:209], v250 offset:20480
    ds_read_b64_tr_b16 a[210:211], v248 offset:20992
    ds_read_b64_tr_b16 a[212:213], v251 offset:20480
    ds_read_b64_tr_b16 a[214:215], v249 offset:20992
    ds_read_b64_tr_b16 a[216:217], v248 offset:21504
    ds_read_b64_tr_b16 a[218:219], v250 offset:22016
    ds_read_b64_tr_b16 a[220:221], v249 offset:21504
    ds_read_b64_tr_b16 a[222:223], v251 offset:22016
    ds_read_b64_tr_b16 a[224:225], v250 offset:21504
    ds_read_b64_tr_b16 a[226:227], v248 offset:22016
    ds_read_b64_tr_b16 a[228:229], v251 offset:21504
    ds_read_b64_tr_b16 a[230:231], v249 offset:22016
    ds_read_b64_tr_b16 a[232:233], v248 offset:22528
    ds_read_b64_tr_b16 a[234:235], v248 offset:30720
    ds_read_b64_tr_b16 a[236:237], v249 offset:22528
    ds_read_b64_tr_b16 a[238:239], v249 offset:30720
    ds_read_b64_tr_b16 a[240:241], v250 offset:22528
    ds_read_b64_tr_b16 a[242:243], v250 offset:30720
    ds_read_b64_tr_b16 a[244:245], v251 offset:22528
    ds_read_b64_tr_b16 a[246:247], v251 offset:30720
    ds_read_b64_tr_b16 a[248:249], v250 offset:31232
    ds_read_b64_tr_b16 a[250:251], v248 offset:31744
    ds_read_b64_tr_b16 a[252:253], v251 offset:31232
    ds_read_b64_tr_b16 a[254:255], v249 offset:31744
    ds_read_b64_tr_b16 a[0:1], v248 offset:31232
    ds_read_b64_tr_b16 a[2:3], v250 offset:31744
    ds_read_b64_tr_b16 a[4:5], v249 offset:31232
    ds_read_b64_tr_b16 a[6:7], v251 offset:31744
    ds_read_b64_tr_b16 a[8:9], v250 offset:32256
    ds_read_b64_tr_b16 a[10:11], v248 offset:32768
    ds_read_b64_tr_b16 a[12:13], v251 offset:32256
    ds_read_b64_tr_b16 a[14:15], v249 offset:32768
    ds_read_b64_tr_b16 a[16:17], v248 offset:32256
    ds_read_b64_tr_b16 a[18:19], v250 offset:32768
    ds_read_b64_tr_b16 a[20:21], v249 offset:32256
    ds_read_b64_tr_b16 a[22:23], v251 offset:32768
    ds_read_b64_tr_b16 a[24:25], v244 offset:10752
    ds_read_b64_tr_b16 a[26:27], v246 offset:11264
    ds_read_b64_tr_b16 a[28:29], v245 offset:10752
    ds_read_b64_tr_b16 a[30:31], v247 offset:11264
    ds_read_b64_tr_b16 a[32:33], v246 offset:10752
    ds_read_b64_tr_b16 a[34:35], v244 offset:11264
    ds_read_b64_tr_b16 a[36:37], v247 offset:10752
    ds_read_b64_tr_b16 a[38:39], v245 offset:11264
    ds_read_b64_tr_b16 a[40:41], v244 offset:11776
    ds_read_b64_tr_b16 a[42:43], v246 offset:12288
    ds_read_b64_tr_b16 a[44:45], v245 offset:11776
    ds_read_b64_tr_b16 a[46:47], v247 offset:12288
    ds_read_b64_tr_b16 a[48:49], v246 offset:11776
    ds_read_b64_tr_b16 a[50:51], v244 offset:12288
    ds_read_b64_tr_b16 a[52:53], v247 offset:11776
    ds_read_b64_tr_b16 a[54:55], v245 offset:12288
    ds_read_b64_tr_b16 a[56:57], v244 offset:12800
    ds_read_b64_tr_b16 a[58:59], v244 offset:20992
    ds_read_b64_tr_b16 a[60:61], v245 offset:12800
    ds_read_b64_tr_b16 a[62:63], v245 offset:20992
    ds_read_b64_tr_b16 a[64:65], v246 offset:12800
    ds_read_b64_tr_b16 a[66:67], v246 offset:20992
    ds_read_b64_tr_b16 a[68:69], v247 offset:12800
    ds_read_b64_tr_b16 a[70:71], v247 offset:20992
    ds_read_b64_tr_b16 a[72:73], v246 offset:21504
    ds_read_b64_tr_b16 a[74:75], v244 offset:22016
    ds_read_b64_tr_b16 a[76:77], v247 offset:21504
    ds_read_b64_tr_b16 a[78:79], v245 offset:22016
    ds_read_b64_tr_b16 a[80:81], v244 offset:21504
    ds_read_b64_tr_b16 a[82:83], v246 offset:22016
    ds_read_b64_tr_b16 a[84:85], v245 offset:21504
    ds_read_b64_tr_b16 a[86:87], v247 offset:22016
    ds_read_b64_tr_b16 a[88:89], v246 offset:22528
    ds_read_b64_tr_b16 a[90:91], v244 offset:23040
    ds_read_b64_tr_b16 a[92:93], v247 offset:22528
    ds_read_b64_tr_b16 a[94:95], v245 offset:23040
    ds_read_b64_tr_b16 a[96:97], v244 offset:22528
    ds_read_b64_tr_b16 a[98:99], v246 offset:23040
    ds_read_b64_tr_b16 a[100:101], v245 offset:22528
    ds_read_b64_tr_b16 a[102:103], v247 offset:23040
    ds_read_b64_tr_b16 a[104:105], v244 offset:31232
    ds_read_b64_tr_b16 a[106:107], v246 offset:31744
    ds_read_b64_tr_b16 a[108:109], v245 offset:31232
    ds_read_b64_tr_b16 a[110:111], v247 offset:31744
    ds_read_b64_tr_b16 a[112:113], v246 offset:31232
    ds_read_b64_tr_b16 a[114:115], v244 offset:31744
    ds_read_b64_tr_b16 a[116:117], v247 offset:31232
    ds_read_b64_tr_b16 a[118:119], v245 offset:31744
    s_lshl2_add_u32 s44, s38, s37
    s_lshl2_add_u32 s44, s44, s32
    s_mul_i32 s44, s44, 5248
    s_mul_i32 s45, s36, 1048576
    s_add_u32 s44, s44, s45
    s_add_u32 s44, s44, 152576
    s_mul_i32 s45, s37, 524288
    v_mov_b32 v7, s45
    s_mov_b32 s50, 60000
GH_hs:
    buffer_load_dword v6, v7, s[60:63], s44 offen sc1
    s_waitcnt vmcnt(0)
    v_cmp_eq_u32 vcc, -1, v6
    s_nop 4
    s_cbranch_vccz GH_hs_ok
    s_sleep 3
    s_sub_u32 s50, s50, 1
    s_cmp_lg_u32 s50, 0
    s_cbranch_scc1 GH_hs
GH_hs_ok:
    s_barrier
    s_waitcnt lgkmcnt(0)
    buffer_load_dwordx4 v[84:87], v252, s[60:63], s16 offen offset:0 sc1
    buffer_load_dwordx4 v[88:91], v252, s[60:63], s16 offen offset:1024 sc1
    buffer_load_dwordx2 v[92:93], v253, s[60:63], s16 offen offset:0 sc1
    buffer_load_dwordx4 v[94:97], v252, s[60:63], s17 offen offset:0 sc1
    buffer_load_dwordx4 v[98:101], v252, s[60:63], s17 offen offset:1024 sc1
    buffer_load_dwordx2 v[102:103], v253, s[60:63], s17 offen offset:0 sc1
    buffer_load_dwordx4 v[104:107], v252, s[60:63], s18 offen offset:0 sc1
    buffer_load_dwordx4 v[108:111], v252, s[60:63], s18 offen offset:1024 sc1
    buffer_load_dwordx2 v[112:113], v253, s[60:63], s18 offen offset:0 sc1
GH_begin:
    s_waitcnt vmcnt(6)
    v_max3_u32 v6, v84, v88, v92
    v_cmp_eq_u32 vcc, -1, v6
    s_nop 4
    s_cbranch_vccnz GH_00_slow
GH_00_back:
    v_mfma_f32_16x16x32_bf16 v[32:35], a[120:123], v[84:87], 0
    buffer_load_dwordx4 v[114:117], v252, s[60:63], s19 offen offset:0 sc1
    v_mfma_f32_16x16x32_bf16 v[36:39], a[124:127], v[84:87], 0
    v_mfma_f32_16x16x32_bf16 v[40:43], a[128:131], v[84:87], 0
    buffer_load_dwordx4 v[118:121], v252, s[60:63], s19 offen offset:1024 sc1
    v_mfma_f32_16x16x32_bf16 v[44:47], a[132:135], v[84:87], 0
    s_waitcnt vmcnt(5)
    v_mfma_f32_16x16x32_bf16 v[32:35], a[136:139], v[88:91], v[32:35]
    v_max3_u32 v6, v94, v98, v102
    v_mfma_f32_16x16x32_bf16 v[36:39], a[140:143], v[88:91], v[36:39]
    buffer_load_dwordx2 v[122:123], v253, s[60:63], s19 offen offset:0 sc1
    v_cmp_eq_u32 vcc, -1, v6
    v_mfma_f32_16x16x32_bf16 v[40:43], a[144:147], v[88:91], v[40:43]
    v_mfma_f32_16x16x32_bf16 v[44:47], a[148:151], v[88:91], v[44:47]
    buffer_load_dwordx4 v[124:127], v252, s[60:63], s20 offen offset:0 sc1
    s_nop 1
    s_cbranch_vccnz GH_10_slow
GH_10_back:
    v_mfma_f32_16x16x32_bf16 v[32:35], a[152:155], v[92:95], v[32:35]
    v_mfma_f32_16x16x32_bf16 v[36:39], a[156:159], v[92:95], v[36:39]
    v_mfma_f32_16x16x32_bf16 v[40:43], a[160:163], v[92:95], v[40:43]
    buffer_load_dwordx4 v[128:131], v252, s[60:63], s20 offen offset:1024 sc1
    v_mfma_f32_16x16x32_bf16 v[44:47], a[164:167], v[92:95], v[44:47]
    v_mfma_f32_16x16x32_bf16 v[32:35], a[168:171], v[96:99], v[32:35]
    buffer_load_dwordx2 v[132:133], v253, s[60:63], s20 offen offset:0 sc1
    v_mfma_f32_16x16x32_bf16 v[36:39], a[172:175], v[96:99], v[36:39]
    v_mfma_f32_16x16x32_bf16 v[40:43], a[176:179], v[96:99], v[40:43]
    v_mfma_f32_16x16x32_bf16 v[44:47], a[180:183], v[96:99], v[44:47]
    buffer_load_dwordx4 v[134:137], v252, s[60:63], s21 offen offset:0 sc1
    s_waitcnt vmcnt(7)
    v_mfma_f32_16x16x32_bf16 v[32:35], a[184:187], v[100:103], v[32:35]
    v_max3_u32 v6, v104, v108, v112
    v_mfma_f32_16x16x32_bf16 v[36:39], a[188:191], v[100:103], v[36:39]
    buffer_load_dwordx4 v[138:141], v252, s[60:63], s21 offen offset:1024 sc1
    v_cmp_eq_u32 vcc, -1, v6
    v_mfma_f32_16x16x32_bf16 v[40:43], a[192:195], v[100:103], v[40:43]
    v_mfma_f32_16x16x32_bf16 v[44:47], a[196:199], v[100:103], v[44:47]
    s_nop 2
    s_cbranch_vccnz GH_20_slow
GH_20_back:
    v_mfma_f32_16x16x32_bf16 v[32:35], a[200:203], v[104:107], v[32:35]
    buffer_load_dwordx2 v[142:143], v253, s[60:63], s21 offen offset:0 sc1
    v_mfma_f32_16x16x32_bf16 v[36:39], a[204:207], v[104:107], v[36:39]
    v_mfma_f32_16x16x32_bf16 v[40:43], a[208:211], v[104:107], v[40:43]
    buffer_load_dwordx4 v[144:147], v252, s[60:63], s22 offen offset:0 sc1
    v_mfma_f32_16x16x32_bf16 v[44:47], a[212:215], v[104:107], v[44:47]
    s_waitcnt vmcnt(7)
    v_mfma_f32_16x16x32_bf16 v[32:35], a[216:219], v[108:111], v[32:35]
    v_max3_u32 v6, v114, v118, v122
    v_mfma_f32_16x16x32_bf16 v[36:39], a[220:223], v[108:111], v[36:39]
    buffer_load_dwordx4 v[148:151], v252, s[60:63], s22 offen offset:1024 sc1
    v_cmp_eq_u32 vcc, -1, v6
    v_mfma_f32_16x16x32_bf16 v[40:43], a[224:227], v[108:111], v[40:43]
    v_mfma_f32_16x16x32_bf16 v[44:47], a[228:231], v[108:111], v[44:47]
    buffer_load_dwordx2 v[152:153], v253, s[60:63], s22 offen offset:0 sc1
    s_nop 1
    s_cbranch_vccnz GH_30_slow
GH_30_back:
    v_mfma_f32_16x16x32_bf16 v[32:35], a[232:235], v[112:115], v[32:35]
    v_mfma_f32_16x16x32_bf16 v[36:39], a[236:239], v[112:115], v[36:39]
    v_mfma_f32_16x16x32_bf16 v[40:43], a[240:243], v[112:115], v[40:43]
    buffer_load_dwordx4 v[154:157], v252, s[60:63], s23 offen offset:0 sc1
    v_mfma_f32_16x16x32_bf16 v[44:47], a[244:247], v[112:115], v[44:47]
    v_mfma_f32_16x16x32_bf16 v[32:35], a[248:251], v[116:119], v[32:35]
    buffer_load_dwordx4 v[158:161], v252, s[60:63], s23 offen offset:1024 sc1
    v_mfma_f32_16x16x32_bf16 v[36:39], a[252:255], v[116:119], v[36:39]
    v_mfma_f32_16x16x32_bf16 v[40:43], a[0:3], v[116:119], v[40:43]
    v_mfma_f32_16x16x32_bf16 v[44:47], a[4:7], v[116:119], v[44:47]
    buffer_load_dwordx2 v[162:163], v253, s[60:63], s23 offen offset:0 sc1
    s_waitcnt vmcnt(9)
    v_mfma_f32_16x16x32_bf16 v[32:35], a[8:11], v[120:123], v[32:35]
    v_max3_u32 v6, v124, v128, v132
    v_mfma_f32_16x16x32_bf16 v[36:39], a[12:15], v[120:123], v[36:39]
    v_cmp_eq_u32 vcc, -1, v6
    v_mfma_f32_16x16x32_bf16 v[40:43], a[16:19], v[120:123], v[40:43]
    v_mfma_f32_16x16x32_bf16 v[44:47], a[20:23], v[120:123], v[44:47]
    s_nop 2
    s_cbranch_vccnz GH_40_slow
GH_40_back:
    v_mfma_f32_16x16x32_bf16 v[32:35], a[24:27], v[124:127], v[32:35]
    v_mfma_f32_16x16x32_bf16 v[36:39], a[28:31], v[124:127], v[36:39]
    v_mfma_f32_16x16x32_bf16 v[40:43], a[32:35], v[124:127], v[40:43]
    buffer_load_dwordx4 v[164:167], v252, s[60:63], s16 offen offset:2048 sc1
    v_mfma_f32_16x16x32_bf16 v[44:47], a[36:39], v[124:127], v[44:47]
    s_waitcnt vmcnt(7)
    v_mfma_f32_16x16x32_bf16 v[32:35], a[40:43], v[128:131], v[32:35]
    ds_read_b64_tr_b16 a[40:41], v244 offset:32256
    v_max3_u32 v6, v134, v138, v142
    v_mfma_f32_16x16x32_bf16 v[36:39], a[44:47], v[128:131], v[36:39]
    ds_read_b64_tr_b16 a[42:43], v246 offset:32768
    v_cmp_eq_u32 vcc, -1, v6
    v_mfma_f32_16x16x32_bf16 v[40:43], a[48:51], v[128:131], v[40:43]
    ds_read_b64_tr_b16 a[44:45], v245 offset:32256
    buffer_load_dwordx4 v[168:171], v252, s[60:63], s16 offen offset:3072 sc1
    v_mfma_f32_16x16x32_bf16 v[44:47], a[52:55], v[128:131], v[44:47]
    ds_read_b64_tr_b16 a[46:47], v247 offset:32768
    s_cbranch_vccnz GH_50_slow
GH_50_back:
    v_mfma_f32_16x16x32_bf16 v[32:35], a[56:59], v[132:135], v[32:35]
    ds_read_b64_tr_b16 a[48:49], v246 offset:32256
    buffer_load_dwordx2 v[172:173], v253, s[60:63], s16 offen offset:512 sc1
    v_mfma_f32_16x16x32_bf16 v[36:39], a[60:63], v[132:135], v[36:39]
    ds_read_b64_tr_b16 a[50:51], v244 offset:32768
    buffer_load_dwordx4 v[174:177], v252, s[60:63], s17 offen offset:2048 sc1
    v_mfma_f32_16x16x32_bf16 v[40:43], a[64:67], v[132:135], v[40:43]
    ds_read_b64_tr_b16 a[52:53], v247 offset:32256
    buffer_load_dwordx4 v[178:181], v252, s[60:63], s17 offen offset:3072 sc1
    v_mfma_f32_16x16x32_bf16 v[44:47], a[68:71], v[132:135], v[44:47]
    ds_read_b64_tr_b16 a[54:55], v245 offset:32768
    v_mfma_f32_16x16x32_bf16 v[32:35], a[72:75], v[136:139], v[32:35]
    ds_read_b64_tr_b16 a[56:57], v244 offset:33280
    buffer_load_dwordx2 v[182:183], v253, s[60:63], s17 offen offset:512 sc1
    v_mfma_f32_16x16x32_bf16 v[36:39], a[76:79], v[136:139], v[36:39]
    ds_read_b64_tr_b16 a[58:59], v244 offset:41472
    v_mfma_f32_16x16x32_bf16 v[40:43], a[80:83], v[136:139], v[40:43]
    ds_read_b64_tr_b16 a[60:61], v245 offset:33280
    ds_read_b64_tr_b16 a[62:63], v245 offset:41472
    v_mfma_f32_16x16x32_bf16 v[44:47], a[84:87], v[136:139], v[44:47]
    ds_read_b64_tr_b16 a[64:65], v246 offset:33280
    s_waitcnt vmcnt(9)
    v_mfma_f32_16x16x32_bf16 v[32:35], a[88:91], v[140:143], v[32:35]
    ds_read_b64_tr_b16 a[66:67], v246 offset:41472
    v_max3_u32 v6, v144, v148, v152
    v_mfma_f32_16x16x32_bf16 v[36:39], a[92:95], v[140:143], v[36:39]
    ds_read_b64_tr_b16 a[68:69], v247 offset:33280
    buffer_load_dwordx4 v[184:187], v252, s[60:63], s18 offen offset:2048 sc1
    v_cmp_eq_u32 vcc, -1, v6
    v_mfma_f32_16x16x32_bf16 v[40:43], a[96:99], v[140:143], v[40:43]
    ds_read_b64_tr_b16 a[70:71], v247 offset:41472
    buffer_load_dwordx4 v[188:191], v252, s[60:63], s18 offen offset:3072 sc1
    v_mfma_f32_16x16x32_bf16 v[44:47], a[100:103], v[140:143], v[44:47]
    ds_read_b64_tr_b16 a[72:73], v246 offset:41984
    ds_read_b64_tr_b16 a[74:75], v244 offset:42496
    s_cbranch_vccnz GH_60_slow
GH_60_back:
    v_mfma_f32_16x16x32_bf16 v[32:35], a[104:107], v[144:147], v[32:35]
    ds_read_b64_tr_b16 a[76:77], v247 offset:41984
    buffer_load_dwordx2 v[192:193], v253, s[60:63], s18 offen offset:512 sc1
    v_mfma_f32_16x16x32_bf16 v[36:39], a[108:111], v[144:147], v[36:39]
    ds_read_b64_tr_b16 a[78:79], v245 offset:42496
    v_mfma_f32_16x16x32_bf16 v[40:43], a[112:115], v[144:147], v[40:43]
    ds_read_b64_tr_b16 a[80:81], v244 offset:41984
    buffer_load_dwordx4 v[194:197], v252, s[60:63], s19 offen offset:2048 sc1
    v_mfma_f32_16x16x32_bf16 v[44:47], a[116:119], v[144:147], v[44:47]
    ds_read_b64_tr_b16 a[82:83], v246 offset:42496
    s_waitcnt lgkmcnt(14)
    s_waitcnt vmcnt(10)
    v_mfma_f32_16x16x32_bf16 v[32:35], a[40:43], v[148:151], v[32:35]
    ds_read_b64_tr_b16 a[84:85], v245 offset:41984
    ds_read_b64_tr_b16 a[86:87], v247 offset:42496
    v_max3_u32 v6, v154, v158, v162
    v_mfma_f32_16x16x32_bf16 v[36:39], a[44:47], v[148:151], v[36:39]
    ds_read_b64_tr_b16 a[88:89], v246 offset:43008
    v_cmp_eq_u32 vcc, -1, v6
    v_mfma_f32_16x16x32_bf16 v[40:43], a[48:51], v[148:151], v[40:43]
    ds_read_b64_tr_b16 a[90:91], v244 offset:43520
    buffer_load_dwordx4 v[198:201], v252, s[60:63], s19 offen offset:3072 sc1
    v_mfma_f32_16x16x32_bf16 v[44:47], a[52:55], v[148:151], v[44:47]
    ds_read_b64_tr_b16 a[92:93], v247 offset:43008
    s_waitcnt lgkmcnt(11)
    s_cbranch_vccnz GH_70_slow
GH_70_back:
    v_mfma_f32_16x16x32_bf16 v[32:35], a[56:59], v[152:155], v[32:35]
    ds_read_b64_tr_b16 a[94:95], v245 offset:43520
    buffer_load_dwordx2 v[202:203], v253, s[60:63], s19 offen offset:512 sc1
    v_mfma_f32_16x16x32_bf16 v[36:39], a[60:63], v[152:155], v[36:39]
    ds_read_b64_tr_b16 a[96:97], v244 offset:43008
    ds_read_b64_tr_b16 a[98:99], v246 offset:43520
    v_mfma_f32_16x16x32_bf16 v[40:43], a[64:67], v[152:155], v[40:43]
    ds_read_b64_tr_b16 a[100:101], v245 offset:43008
    buffer_load_dwordx4 v[204:207], v252, s[60:63], s20 offen offset:2048 sc1
    v_mfma_f32_16x16x32_bf16 v[44:47], a[68:71], v[152:155], v[44:47]
    ds_read_b64_tr_b16 a[102:103], v247 offset:43520
    s_waitcnt lgkmcnt(8)
    v_mfma_f32_16x16x32_bf16 v[32:35], a[72:75], v[156:159], v[32:35]
    buffer_load_dwordx4 v[208:211], v252, s[60:63], s20 offen offset:3072 sc1
    v_mfma_f32_16x16x32_bf16 v[36:39], a[76:79], v[156:159], v[36:39]
    v_mfma_f32_16x16x32_bf16 v[40:43], a[80:83], v[156:159], v[40:43]
    buffer_load_dwordx2 v[212:213], v253, s[60:63], s20 offen offset:512 sc1
    v_mfma_f32_16x16x32_bf16 v[44:47], a[84:87], v[156:159], v[44:47]
    s_waitcnt lgkmcnt(4)
    v_mfma_f32_16x16x32_bf16 v[32:35], a[88:91], v[160:163], v[32:35]
    v_mfma_f32_16x16x32_bf16 v[36:39], a[92:95], v[160:163], v[36:39]
    buffer_load_dwordx4 v[214:217], v252, s[60:63], s21 offen offset:2048 sc1
    s_waitcnt lgkmcnt(2)
    v_mfma_f32_16x16x32_bf16 v[40:43], a[96:99], v[160:163], v[40:43]
    s_waitcnt lgkmcnt(0)
    v_mfma_f32_16x16x32_bf16 v[44:47], a[100:103], v[160:163], v[44:47]
    s_waitcnt vmcnt(13)
    v_max3_u32 v6, v164, v168, v172
    v_cmp_eq_u32 vcc, -1, v6
    s_nop 4
    s_cbranch_vccnz GH_01_slow
GH_01_back:
    v_mfma_f32_16x16x32_bf16 v[48:51], a[120:123], v[164:167], 0
    ds_read_b64_tr_b16 a[120:121], v244 offset:11776
    buffer_load_dwordx4 v[218:221], v252, s[60:63], s21 offen offset:3072 sc1
    v_mfma_f32_16x16x32_bf16 v[52:55], a[124:127], v[164:167], 0
    ds_read_b64_tr_b16 a[122:123], v246 offset:12288
    v_mfma_f32_16x16x32_bf16 v[56:59], a[128:131], v[164:167], 0
    ds_read_b64_tr_b16 a[124:125], v245 offset:11776
    buffer_load_dwordx2 v[222:223], v253, s[60:63], s21 offen offset:512 sc1
    v_mfma_f32_16x16x32_bf16 v[60:63], a[132:135], v[164:167], 0
    ds_read_b64_tr_b16 a[126:127], v247 offset:12288
    s_waitcnt vmcnt(12)
    v_mfma_f32_16x16x32_bf16 v[48:51], a[136:139], v[168:171], v[48:51]
    ds_read_b64_tr_b16 a[128:129], v246 offset:11776
    v_max3_u32 v6, v174, v178, v182
    v_mfma_f32_16x16x32_bf16 v[52:55], a[140:143], v[168:171], v[52:55]
    ds_read_b64_tr_b16 a[130:131], v244 offset:12288
    v_cmp_eq_u32 vcc, -1, v6
    v_mfma_f32_16x16x32_bf16 v[56:59], a[144:147], v[168:171], v[56:59]
    ds_read_b64_tr_b16 a[132:133], v247 offset:11776
    buffer_load_dwordx4 v[224:227], v252, s[60:63], s22 offen offset:2048 sc1
    v_mfma_f32_16x16x32_bf16 v[60:63], a[148:151], v[168:171], v[60:63]
    ds_read_b64_tr_b16 a[134:135], v245 offset:12288
    v_cvt_pk_bf16_f32 v64, v32, v33
    s_cbranch_vccnz GH_11_slow
GH_11_back:
    v_mfma_f32_16x16x32_bf16 v[48:51], a[152:155], v[172:175], v[48:51]
    ds_read_b64_tr_b16 a[136:137], v244 offset:12800
    v_cvt_pk_bf16_f32 v65, v34, v35
    v_cvt_pk_bf16_f32 v66, v36, v37
    v_mfma_f32_16x16x32_bf16 v[52:55], a[156:159], v[172:175], v[52:55]
    ds_read_b64_tr_b16 a[138:139], v244 offset:20992
    v_cvt_pk_bf16_f32 v67, v38, v39
    v_cvt_pk_bf16_f32 v68, v40, v41
    v_mfma_f32_16x16x32_bf16 v[56:59], a[160:163], v[172:175], v[56:59]
    ds_read_b64_tr_b16 a[140:141], v245 offset:12800
    v_cvt_pk_bf16_f32 v69, v42, v43
    v_cvt_pk_bf16_f32 v70, v44, v45
    v_mfma_f32_16x16x32_bf16 v[60:63], a[164:167], v[172:175], v[60:63]
    ds_read_b64_tr_b16 a[142:143], v245 offset:20992
    v_cvt_pk_bf16_f32 v71, v46, v47
    v_permlane16_swap_b32 v64, v66
    v_mfma_f32_16x16x32_bf16 v[48:51], a[168:171], v[176:179], v[48:51]
    ds_read_b64_tr_b16 a[144:145], v246 offset:12800
    v_permlane16_swap_b32 v65, v67
    v_permlane16_swap_b32 v68, v70
    v_mfma_f32_16x16x32_bf16 v[52:55], a[172:175], v[176:179], v[52:55]
    ds_read_b64_tr_b16 a[146:147], v246 offset:20992
    v_permlane16_swap_b32 v69, v71
    buffer_load_dwordx4 v[228:231], v252, s[60:63], s22 offen offset:3072 sc1
    v_mfma_f32_16x16x32_bf16 v[56:59], a[176:179], v[176:179], v[56:59]
    ds_read_b64_tr_b16 a[148:149], v247 offset:12800
    buffer_load_dwordx2 v[232:233], v253, s[60:63], s22 offen offset:512 sc1
    v_mfma_f32_16x16x32_bf16 v[60:63], a[180:183], v[176:179], v[60:63]
    ds_read_b64_tr_b16 a[150:151], v247 offset:20992
    buffer_load_dwordx4 v[234:237], v252, s[60:63], s23 offen offset:2048 sc1
    s_waitcnt vmcnt(13)
    v_mfma_f32_16x16x32_bf16 v[48:51], a[184:187], v[180:183], v[48:51]
    ds_read_b64_tr_b16 a[152:153], v246 offset:21504
    v_max3_u32 v6, v184, v188, v192
    v_mfma_f32_16x16x32_bf16 v[52:55], a[188:191], v[180:183], v[52:55]
    ds_read_b64_tr_b16 a[154:155], v244 offset:22016
    buffer_load_dwordx4 v[238:241], v252, s[60:63], s23 offen offset:3072 sc1
    v_cmp_eq_u32 vcc, -1, v6
    v_mfma_f32_16x16x32_bf16 v[56:59], a[192:195], v[180:183], v[56:59]
    ds_read_b64_tr_b16 a[156:157], v247 offset:21504
    buffer_load_dwordx2 v[242:243], v253, s[60:63], s23 offen offset:512 sc1
    v_mfma_f32_16x16x32_bf16 v[60:63], a[196:199], v[180:183], v[60:63]
    ds_read_b64_tr_b16 a[158:159], v245 offset:22016
    s_cbranch_vccnz GH_21_slow
GH_21_back:
    v_mfma_f32_16x16x32_bf16 v[48:51], a[200:203], v[184:187], v[48:51]
    ds_read_b64_tr_b16 a[160:161], v244 offset:21504
    v_mfma_f32_16x16x32_bf16 v[52:55], a[204:207], v[184:187], v[52:55]
    ds_read_b64_tr_b16 a[162:163], v246 offset:22016
    v_mfma_f32_16x16x32_bf16 v[56:59], a[208:211], v[184:187], v[56:59]
    ds_read_b64_tr_b16 a[164:165], v245 offset:21504
    v_mfma_f32_16x16x32_bf16 v[60:63], a[212:215], v[184:187], v[60:63]
    ds_read_b64_tr_b16 a[166:167], v247 offset:22016
    s_waitcnt vmcnt(12)
    v_mfma_f32_16x16x32_bf16 v[48:51], a[216:219], v[188:191], v[48:51]
    ds_read_b64_tr_b16 a[168:169], v246 offset:22528
    v_max3_u32 v6, v194, v198, v202
    v_mfma_f32_16x16x32_bf16 v[52:55], a[220:223], v[188:191], v[52:55]
    ds_read_b64_tr_b16 a[170:171], v244 offset:23040
    v_cmp_eq_u32 vcc, -1, v6
    v_mfma_f32_16x16x32_bf16 v[56:59], a[224:227], v[188:191], v[56:59]
    ds_read_b64_tr_b16 a[172:173], v247 offset:22528
    v_mfma_f32_16x16x32_bf16 v[60:63], a[228:231], v[188:191], v[60:63]
    ds_read_b64_tr_b16 a[174:175], v245 offset:23040
    s_nop 0
    s_cbranch_vccnz GH_31_slow
GH_31_back:
    v_mfma_f32_16x16x32_bf16 v[48:51], a[232:235], v[192:195], v[48:51]
    ds_read_b64_tr_b16 a[176:177], v244 offset:22528
    v_mfma_f32_16x16x32_bf16 v[52:55], a[236:239], v[192:195], v[52:55]
    ds_read_b64_tr_b16 a[178:179], v246 offset:23040
    v_mfma_f32_16x16x32_bf16 v[56:59], a[240:243], v[192:195], v[56:59]
    ds_read_b64_tr_b16 a[180:181], v245 offset:22528
    v_mfma_f32_16x16x32_bf16 v[60:63], a[244:247], v[192:195], v[60:63]
    ds_read_b64_tr_b16 a[182:183], v247 offset:23040
    v_mfma_f32_16x16x32_bf16 v[48:51], a[248:251], v[196:199], v[48:51]
    v_mfma_f32_16x16x32_bf16 v[52:55], a[252:255], v[196:199], v[52:55]
    v_mfma_f32_16x16x32_bf16 v[56:59], a[0:3], v[196:199], v[56:59]
    v_mfma_f32_16x16x32_bf16 v[60:63], a[4:7], v[196:199], v[60:63]
    s_waitcnt vmcnt(9)
    v_mfma_f32_16x16x32_bf16 v[48:51], a[8:11], v[200:203], v[48:51]
    ds_write_b128 v255, v[64:67] offset:51712
    v_max3_u32 v6, v204, v208, v212
    v_mfma_f32_16x16x32_bf16 v[52:55], a[12:15], v[200:203], v[52:55]
    ds_write_b128 v255, v[68:71] offset:51776
    v_cmp_eq_u32 vcc, -1, v6
    v_mfma_f32_16x16x32_bf16 v[56:59], a[16:19], v[200:203], v[56:59]
    v_mfma_f32_16x16x32_bf16 v[60:63], a[20:23], v[200:203], v[60:63]
    s_nop 2
    s_cbranch_vccnz GH_41_slow
GH_41_back:
    v_mfma_f32_16x16x32_bf16 v[48:51], a[24:27], v[204:207], v[48:51]
    v_mfma_f32_16x16x32_bf16 v[52:55], a[28:31], v[204:207], v[52:55]
    v_mfma_f32_16x16x32_bf16 v[56:59], a[32:35], v[204:207], v[56:59]
    ds_read_b128 v[32:35], v9 offset:51712
    v_mfma_f32_16x16x32_bf16 v[60:63], a[36:39], v[204:207], v[60:63]
    ds_read_b128 v[36:39], v9 offset:52864
    s_waitcnt lgkmcnt(14)
    s_waitcnt vmcnt(6)
    v_mfma_f32_16x16x32_bf16 v[48:51], a[120:123], v[208:211], v[48:51]
    v_max3_u32 v6, v214, v218, v222
    v_mfma_f32_16x16x32_bf16 v[52:55], a[124:127], v[208:211], v[52:55]
    v_cmp_eq_u32 vcc, -1, v6
    v_mfma_f32_16x16x32_bf16 v[56:59], a[128:131], v[208:211], v[56:59]
    v_mfma_f32_16x16x32_bf16 v[60:63], a[132:135], v[208:211], v[60:63]
    s_nop 2
    s_cbranch_vccnz GH_51_slow
GH_51_back:
    v_mfma_f32_16x16x32_bf16 v[48:51], a[136:139], v[212:215], v[48:51]
    v_mfma_f32_16x16x32_bf16 v[52:55], a[140:143], v[212:215], v[52:55]
    v_mfma_f32_16x16x32_bf16 v[56:59], a[144:147], v[212:215], v[56:59]
    s_mov_b32 s44, 0
    s_waitcnt lgkmcnt(1)
    v_mfma_f32_16x16x32_bf16 v[60:63], a[148:151], v[212:215], v[60:63]
    buffer_store_dwordx4 v[32:35], v254, s[68:71], s44 offen sc1
    s_mov_b32 s44, 20480
    v_mfma_f32_16x16x32_bf16 v[48:51], a[152:155], v[216:219], v[48:51]
    s_waitcnt lgkmcnt(0)
    buffer_store_dwordx4 v[36:39], v254, s[68:71], s44 offen sc1
    v_mfma_f32_16x16x32_bf16 v[52:55], a[156:159], v[216:219], v[52:55]
    v_mfma_f32_16x16x32_bf16 v[56:59], a[160:163], v[216:219], v[56:59]
    v_mfma_f32_16x16x32_bf16 v[60:63], a[164:167], v[216:219], v[60:63]
    s_waitcnt vmcnt(5)
    v_mfma_f32_16x16x32_bf16 v[48:51], a[168:171], v[220:223], v[48:51]
    v_max3_u32 v6, v224, v228, v232
    v_mfma_f32_16x16x32_bf16 v[52:55], a[172:175], v[220:223], v[52:55]
    v_cmp_eq_u32 vcc, -1, v6
    v_mfma_f32_16x16x32_bf16 v[56:59], a[176:179], v[220:223], v[56:59]
    v_mfma_f32_16x16x32_bf16 v[60:63], a[180:183], v[220:223], v[60:63]
    s_nop 2
    s_cbranch_vccnz GH_61_slow
GH_61_back:
    v_mfma_f32_16x16x32_bf16 v[48:51], a[104:107], v[224:227], v[48:51]
    v_mfma_f32_16x16x32_bf16 v[52:55], a[108:111], v[224:227], v[52:55]
    v_mfma_f32_16x16x32_bf16 v[56:59], a[112:115], v[224:227], v[56:59]
    v_mfma_f32_16x16x32_bf16 v[60:63], a[116:119], v[224:227], v[60:63]
    s_waitcnt vmcnt(2)
    v_mfma_f32_16x16x32_bf16 v[48:51], a[40:43], v[228:231], v[48:51]
    v_max3_u32 v6, v234, v238, v242
    v_mfma_f32_16x16x32_bf16 v[52:55], a[44:47], v[228:231], v[52:55]
    v_cmp_eq_u32 vcc, -1, v6
    v_mfma_f32_16x16x32_bf16 v[56:59], a[48:51], v[228:231], v[56:59]
    v_mfma_f32_16x16x32_bf16 v[60:63], a[52:55], v[228:231], v[60:63]
    s_nop 2
    s_cbranch_vccnz GH_71_slow
GH_71_back:
    v_mfma_f32_16x16x32_bf16 v[48:51], a[56:59], v[232:235], v[48:51]
    v_mfma_f32_16x16x32_bf16 v[52:55], a[60:63], v[232:235], v[52:55]
    v_mfma_f32_16x16x32_bf16 v[48:51], a[72:75], v[236:239], v[48:51]
    v_mfma_f32_16x16x32_bf16 v[52:55], a[76:79], v[236:239], v[52:55]
    v_mfma_f32_16x16x32_bf16 v[48:51], a[88:91], v[240:243], v[48:51]
    v_mfma_f32_16x16x32_bf16 v[52:55], a[92:95], v[240:243], v[52:55]
    v_mfma_f32_16x16x32_bf16 v[56:59], a[64:67], v[232:235], v[56:59]
    v_mfma_f32_16x16x32_bf16 v[60:63], a[68:71], v[232:235], v[60:63]
    v_mfma_f32_16x16x32_bf16 v[56:59], a[80:83], v[236:239], v[56:59]
    s_nop 3
    v_cvt_pk_bf16_f32 v72, v48, v49
    v_cvt_pk_bf16_f32 v73, v50, v51
    v_mfma_f32_16x16x32_bf16 v[60:63], a[84:87], v[236:239], v[60:63]
    v_cvt_pk_bf16_f32 v74, v52, v53
    v_cvt_pk_bf16_f32 v75, v54, v55
    v_mfma_f32_16x16x32_bf16 v[56:59], a[96:99], v[240:243], v[56:59]
    v_permlane16_swap_b32 v72, v74
    v_permlane16_swap_b32 v73, v75
    v_mfma_f32_16x16x32_bf16 v[60:63], a[100:103], v[240:243], v[60:63]
    ds_write_b128 v255, v[72:75] offset:54016
    s_nop 3
    v_cvt_pk_bf16_f32 v76, v56, v57
    v_cvt_pk_bf16_f32 v77, v58, v59
    s_nop 0
    v_cvt_pk_bf16_f32 v78, v60, v61
    v_cvt_pk_bf16_f32 v79, v62, v63
    s_nop 0
    v_permlane16_swap_b32 v76, v78
    v_permlane16_swap_b32 v77, v79
    ds_write_b128 v255, v[76:79] offset:54080
    ds_read_b128 v[48:51], v9 offset:54016
    ds_read_b128 v[52:55], v9 offset:55168
    s_mov_b32 s44, 40960
    s_waitcnt lgkmcnt(1)
    buffer_store_dwordx4 v[48:51], v254, s[68:71], s44 offen
    s_mov_b32 s44, 61440
    s_waitcnt lgkmcnt(0)
    buffer_store_dwordx4 v[52:55], v254, s[68:71], s44 offen
    s_endpgm
L_cold:
L_P:
    s_mov_b32 s60, s30
    s_and_b32 s61, s31, 0xffff
    s_mov_b32 s62, 4194304
    s_mov_b32 s63, 0x20000
    s_mov_b32 s68, s28
    s_and_b32 s69, s29, 0xffff
    s_mov_b32 s70, 256
    s_mov_b32 s71, 0x20000
    s_bfe_u32 s44, s34, 0x10001
    s_lshl_b32 s44, s44, 0
    s_xor_b32 s46, s33, s44
    s_and_b32 s44, s34, 1
    s_lshl2_add_u32 s43, s44, s32
    v_mov_b32 v28, -1
    v_mov_b32 v29, -1
    v_mov_b32 v30, -1
    v_mov_b32 v31, -1
    v_lshlrev_b32 v8, 4, v1
    v_mov_b32 v9, 1073741824
    v_cmp_ne_u32 vcc, 0, v0
    v_mov_b32 v6, 1
    s_nop 0
    v_cndmask_b32_e64 v9, 0, v9, vcc
    s_waitcnt vmcnt(0)
    s_mul_i32 s44, s46, 524288
    s_mul_i32 s45, s43, 18432
    s_add_u32 s44, s44, s45
    s_add_u32 s44, s44, 0
    buffer_store_dwordx4 v[28:31], v8, s[60:63], s44 offen offset:0 sc1
    buffer_store_dwordx4 v[28:31], v8, s[60:63], s44 offen offset:1024 sc1
    buffer_store_dwordx4 v[28:31], v8, s[60:63], s44 offen offset:2048 sc1
    buffer_store_dwordx4 v[28:31], v8, s[60:63], s44 offen offset:3072 sc1
    s_add_u32 s44, s44, 4096
    buffer_store_dwordx4 v[28:31], v8, s[60:63], s44 offen offset:0 sc1
    buffer_store_dwordx4 v[28:31], v8, s[60:63], s44 offen offset:1024 sc1
    buffer_store_dwordx4 v[28:31], v8, s[60:63], s44 offen offset:2048 sc1
    buffer_store_dwordx4 v[28:31], v8, s[60:63], s44 offen offset:3072 sc1
    s_add_u32 s44, s44, 4096
    buffer_store_dwordx4 v[28:31], v8, s[60:63], s44 offen offset:0 sc1
    buffer_store_dwordx4 v[28:31], v8, s[60:63], s44 offen offset:1024 sc1
    buffer_store_dwordx4 v[28:31], v8, s[60:63], s44 offen offset:2048 sc1
    buffer_store_dwordx4 v[28:31], v8, s[60:63], s44 offen offset:3072 sc1
    s_add_u32 s44, s44, 4096
    buffer_store_dwordx4 v[28:31], v8, s[60:63], s44 offen offset:0 sc1
    buffer_store_dwordx4 v[28:31], v8, s[60:63], s44 offen offset:1024 sc1
    buffer_store_dwordx4 v[28:31], v8, s[60:63], s44 offen offset:2048 sc1
    buffer_store_dwordx4 v[28:31], v8, s[60:63], s44 offen offset:3072 sc1
    s_add_u32 s44, s44, 4096
    buffer_store_dwordx4 v[28:31], v8, s[60:63], s44 offen offset:0 sc1
    buffer_store_dwordx4 v[28:31], v8, s[60:63], s44 offen offset:1024 sc1
    s_waitcnt vmcnt(0)
    s_barrier
    s_cmp_lg_u32 s32, 0
    s_cbranch_scc1 CL_n0
    v_mov_b32 v7, 1
    buffer_atomic_add v7, v9, s[68:71], 0 offen offset:128 sc0 sc1
    s_waitcnt vmcnt(0)
    v_readfirstlane_b32 s44, v7
    s_nop 1
    s_cmp_lg_u32 s44, 15
    s_cbranch_scc1 CL_n0
    buffer_store_dword v6, v9, s[68:71], 0 offen offset:0 sc1
CL_n0:
    s_mul_i32 s44, s46, 524288
    s_mul_i32 s45, s43, 41984
    s_add_u32 s44, s44, s45
    s_nop 0
    s_add_u32 s44, s44, 147456
    buffer_store_dwordx4 v[28:31], v8, s[60:63], s44 offen offset:0 sc1
    buffer_store_dwordx4 v[28:31], v8, s[60:63], s44 offen offset:1024 sc1
    buffer_store_dwordx4 v[28:31], v8, s[60:63], s44 offen offset:2048 sc1
    buffer_store_dwordx4 v[28:31], v8, s[60:63], s44 offen offset:3072 sc1
    s_add_u32 s44, s44, 4096
    buffer_store_dwordx4 v[28:31], v8, s[60:63], s44 offen offset:0 sc1
    buffer_store_dwordx4 v[28:31], v8, s[60:63], s44 offen offset:1024 sc1
    buffer_store_dwordx4 v[28:31], v8, s[60:63], s44 offen offset:2048 sc1
    buffer_store_dwordx4 v[28:31], v8, s[60:63], s44 offen offset:3072 sc1
    s_add_u32 s44, s44, 4096
    buffer_store_dwordx4 v[28:31], v8, s[60:63], s44 offen offset:0 sc1
    buffer_store_dwordx4 v[28:31], v8, s[60:63], s44 offen offset:1024 sc1
    buffer_store_dwordx4 v[28:31], v8, s[60:63], s44 offen offset:2048 sc1
    buffer_store_dwordx4 v[28:31], v8, s[60:63], s44 offen offset:3072 sc1
    s_add_u32 s44, s44, 4096
    buffer_store_dwordx4 v[28:31], v8, s[60:63], s44 offen offset:0 sc1
    buffer_store_dwordx4 v[28:31], v8, s[60:63], s44 offen offset:1024 sc1
    buffer_store_dwordx4 v[28:31], v8, s[60:63], s44 offen offset:2048 sc1
    buffer_store_dwordx4 v[28:31], v8, s[60:63], s44 offen offset:3072 sc1
    s_add_u32 s44, s44, 4096
    buffer_store_dwordx4 v[28:31], v8, s[60:63], s44 offen offset:0 sc1
    buffer_store_dwordx4 v[28:31], v8, s[60:63], s44 offen offset:1024 sc1
    buffer_store_dwordx4 v[28:31], v8, s[60:63], s44 offen offset:2048 sc1
    buffer_store_dwordx4 v[28:31], v8, s[60:63], s44 offen offset:3072 sc1
    s_add_u32 s44, s44, 4096
    buffer_store_dwordx4 v[28:31], v8, s[60:63], s44 offen offset:0 sc1
    buffer_store_dwordx4 v[28:31], v8, s[60:63], s44 offen offset:1024 sc1
    buffer_store_dwordx4 v[28:31], v8, s[60:63], s44 offen offset:2048 sc1
    buffer_store_dwordx4 v[28:31], v8, s[60:63], s44 offen offset:3072 sc1
    s_add_u32 s44, s44, 4096
    buffer_store_dwordx4 v[28:31], v8, s[60:63], s44 offen offset:0 sc1
    buffer_store_dwordx4 v[28:31], v8, s[60:63], s44 offen offset:1024 sc1
    buffer_store_dwordx4 v[28:31], v8, s[60:63], s44 offen offset:2048 sc1
    buffer_store_dwordx4 v[28:31], v8, s[60:63], s44 offen offset:3072 sc1
    s_add_u32 s44, s44, 4096
    buffer_store_dwordx4 v[28:31], v8, s[60:63], s44 offen offset:0 sc1
    buffer_store_dwordx4 v[28:31], v8, s[60:63], s44 offen offset:1024 sc1
    buffer_store_dwordx4 v[28:31], v8, s[60:63], s44 offen offset:2048 sc1
    buffer_store_dwordx4 v[28:31], v8, s[60:63], s44 offen offset:3072 sc1
    s_add_u32 s44, s44, 4096
    buffer_store_dwordx4 v[28:31], v8, s[60:63], s44 offen offset:0 sc1
    buffer_store_dwordx4 v[28:31], v8, s[60:63], s44 offen offset:1024 sc1
    buffer_store_dwordx4 v[28:31], v8, s[60:63], s44 offen offset:2048 sc1
    buffer_store_dwordx4 v[28:31], v8, s[60:63], s44 offen offset:3072 sc1
    s_add_u32 s44, s44, 4096
    buffer_store_dwordx4 v[28:31], v8, s[60:63], s44 offen offset:0 sc1
    buffer_store_dwordx4 v[28:31], v8, s[60:63], s44 offen offset:1024 sc1
    buffer_store_dwordx4 v[28:31], v8, s[60:63], s44 offen offset:2048 sc1
    buffer_store_dwordx4 v[28:31], v8, s[60:63], s44 offen offset:3072 sc1
    s_add_u32 s44, s44, 4096
    buffer_store_dwordx4 v[28:31], v8, s[60:63], s44 offen offset:0 sc1
    s_waitcnt vmcnt(0)
    s_barrier
    s_cmp_lg_u32 s32, 0
    s_cbranch_scc1 CL_n1
    v_mov_b32 v7, 1
    buffer_atomic_add v7, v9, s[68:71], 0 offen offset:132 sc0 sc1
    s_waitcnt vmcnt(0)
    v_readfirstlane_b32 s44, v7
    s_nop 1
    s_cmp_lg_u32 s44, 15
    s_cbranch_scc1 CL_n1
    buffer_store_dword v6, v9, s[68:71], 0 offen offset:4 sc1
CL_n1:
    s_branch L_done
A_cnt_slow:
    s_mov_b32 s50, 60000
A_cnt:
    buffer_load_dword v31, v26, s[12:15], 0 offen sc1
    s_waitcnt vmcnt(0)
    v_cmp_eq_u32 vcc, 0, v31
    s_nop 4
    s_cbranch_vccz A_cnt_ok
    s_sleep 8
    s_sub_u32 s50, s50, 1
    s_cmp_lg_u32 s50, 0
    s_cbranch_scc1 A_cnt
A_cnt_ok:
    s_branch A_cnt_back
A_c2_slow:
    s_mov_b32 s50, 60000
A_c2:
    buffer_load_dword v31, v26, s[12:15], 0 offen offset:4 sc1
    s_waitcnt vmcnt(0)
    v_cmp_eq_u32_e64 vcc, 0, v31
    s_nop 4
    s_cbranch_vccz A_c2_ok
    s_sleep 8
    s_sub_u32 s50, s50, 1
    s_cmp_lg_u32 s50, 0
    s_cbranch_scc1 A_c2
A_c2_ok:
    s_branch A_c2_back
A_red_slow:
    s_mov_b32 s50, 60000
A_red:
    buffer_load_dwordx4 v[212:215], v252, s[60:63], s76 offen offset:0 sc1
    buffer_load_dwordx4 v[216:219], v252, s[60:63], s76 offen offset:1024 sc1
    s_waitcnt vmcnt(0)
    v_max3_u32 v6, v212, v214, v216
    v_max_u32 v6, v6, v218
    v_cmp_eq_u32 vcc, -1, v6
    s_nop 4
    s_cbranch_vccz A_red_ok
    s_sleep 2
    s_sub_u32 s50, s50, 1
    s_cmp_lg_u32 s50, 0
    s_cbranch_scc1 A_red
A_red_ok:
    s_branch A_red_back
G2_10_slow:
    s_mov_b32 s50, 60000
G2_10_s:
    buffer_load_dwordx4 v[94:97], v252, s[60:63], s17 offen offset:0 sc1
    buffer_load_dwordx4 v[98:101], v252, s[60:63], s17 offen offset:1024 sc1
    buffer_load_dwordx2 v[102:103], v253, s[60:63], s17 offen offset:0 sc1
    s_waitcnt vmcnt(0)
    v_max3_u32 v6, v94, v98, v102
    v_cmp_eq_u32_e64 vcc, -1, v6
    s_nop 4
    s_cbranch_vccz G2_10_s_ok
    s_sleep 2
    s_sub_u32 s50, s50, 1
    s_cmp_lg_u32 s50, 0
    s_cbranch_scc1 G2_10_s
G2_10_s_ok:
    s_branch G2_10_back
G2_20_slow:
    s_mov_b32 s50, 60000
G2_20_s:
    buffer_load_dwordx4 v[104:107], v252, s[60:63], s18 offen offset:0 sc1
    buffer_load_dwordx4 v[108:111], v252, s[60:63], s18 offen offset:1024 sc1
    buffer_load_dwordx2 v[112:113], v253, s[60:63], s18 offen offset:0 sc1
    s_waitcnt vmcnt(0)
    v_max3_u32 v6, v104, v108, v112
    v_cmp_eq_u32_e64 vcc, -1, v6
    s_nop 4
    s_cbranch_vccz G2_20_s_ok
    s_sleep 2
    s_sub_u32 s50, s50, 1
    s_cmp_lg_u32 s50, 0
    s_cbranch_scc1 G2_20_s
G2_20_s_ok:
    s_branch G2_20_back
G2_30_slow:
    s_mov_b32 s50, 60000
G2_30_s:
    buffer_load_dwordx4 v[114:117], v252, s[60:63], s19 offen offset:0 sc1
    buffer_load_dwordx4 v[118:121], v252, s[60:63], s19 offen offset:1024 sc1
    buffer_load_dwordx2 v[122:123], v253, s[60:63], s19 offen offset:0 sc1
    s_waitcnt vmcnt(0)
    v_max3_u32 v6, v114, v118, v122
    v_cmp_eq_u32_e64 vcc, -1, v6
    s_nop 4
    s_cbranch_vccz G2_30_s_ok
    s_sleep 2
    s_sub_u32 s50, s50, 1
    s_cmp_lg_u32 s50, 0
    s_cbranch_scc1 G2_30_s
G2_30_s_ok:
    s_branch G2_30_back
G2_40_slow:
    s_mov_b32 s50, 60000
G2_40_s:
    buffer_load_dwordx4 v[124:127], v252, s[60:63], s20 offen offset:0 sc1
    buffer_load_dwordx4 v[128:131], v252, s[60:63], s20 offen offset:1024 sc1
    buffer_load_dwordx2 v[132:133], v253, s[60:63], s20 offen offset:0 sc1
    s_waitcnt vmcnt(0)
    v_max3_u32 v6, v124, v128, v132
    v_cmp_eq_u32_e64 vcc, -1, v6
    s_nop 4
    s_cbranch_vccz G2_40_s_ok
    s_sleep 2
    s_sub_u32 s50, s50, 1
    s_cmp_lg_u32 s50, 0
    s_cbranch_scc1 G2_40_s
G2_40_s_ok:
    s_branch G2_40_back
G2_50_slow:
    s_mov_b32 s50, 60000
G2_50_s:
    buffer_load_dwordx4 v[134:137], v252, s[60:63], s21 offen offset:0 sc1
    buffer_load_dwordx4 v[138:141], v252, s[60:63], s21 offen offset:1024 sc1
    buffer_load_dwordx2 v[142:143], v253, s[60:63], s21 offen offset:0 sc1
    s_waitcnt vmcnt(0)
    v_max3_u32 v6, v134, v138, v142
    v_cmp_eq_u32_e64 vcc, -1, v6
    s_nop 4
    s_cbranch_vccz G2_50_s_ok
    s_sleep 2
    s_sub_u32 s50, s50, 1
    s_cmp_lg_u32 s50, 0
    s_cbranch_scc1 G2_50_s
G2_50_s_ok:
    s_branch G2_50_back
G2_60_slow:
    s_mov_b32 s50, 60000
G2_60_s:
    buffer_load_dwordx4 v[144:147], v252, s[60:63], s22 offen offset:0 sc1
    buffer_load_dwordx4 v[148:151], v252, s[60:63], s22 offen offset:1024 sc1
    buffer_load_dwordx2 v[152:153], v253, s[60:63], s22 offen offset:0 sc1
    s_waitcnt vmcnt(0)
    v_max3_u32 v6, v144, v148, v152
    v_cmp_eq_u32_e64 vcc, -1, v6
    s_nop 4
    s_cbranch_vccz G2_60_s_ok
    s_sleep 2
    s_sub_u32 s50, s50, 1
    s_cmp_lg_u32 s50, 0
    s_cbranch_scc1 G2_60_s
G2_60_s_ok:
    s_branch G2_60_back
G2_70_slow:
    s_mov_b32 s50, 60000
G2_70_s:
    buffer_load_dwordx4 v[154:157], v252, s[60:63], s23 offen offset:0 sc1
    buffer_load_dwordx4 v[158:161], v252, s[60:63], s23 offen offset:1024 sc1
    buffer_load_dwordx2 v[162:163], v253, s[60:63], s23 offen offset:0 sc1
    s_waitcnt vmcnt(0)
    v_max3_u32 v6, v154, v158, v162
    v_cmp_eq_u32_e64 vcc, -1, v6
    s_nop 4
    s_cbranch_vccz G2_70_s_ok
    s_sleep 2
    s_sub_u32 s50, s50, 1
    s_cmp_lg_u32 s50, 0
    s_cbranch_scc1 G2_70_s
G2_70_s_ok:
    s_branch G2_70_back
G2_11_slow:
    s_mov_b32 s50, 60000
G2_11_s:
    buffer_load_dwordx4 v[174:177], v252, s[60:63], s17 offen offset:2048 sc1
    buffer_load_dwordx4 v[178:181], v252, s[60:63], s17 offen offset:3072 sc1
    buffer_load_dwordx2 v[182:183], v253, s[60:63], s17 offen offset:512 sc1
    s_waitcnt vmcnt(0)
    v_max3_u32 v6, v174, v178, v182
    v_cmp_eq_u32_e64 vcc, -1, v6
    s_nop 4
    s_cbranch_vccz G2_11_s_ok
    s_sleep 2
    s_sub_u32 s50, s50, 1
    s_cmp_lg_u32 s50, 0
    s_cbranch_scc1 G2_11_s
G2_11_s_ok:
    s_branch G2_11_back
G2_21_slow:
    s_mov_b32 s50, 60000
G2_21_s:
    buffer_load_dwordx4 v[184:187], v252, s[60:63], s18 offen offset:2048 sc1
    buffer_load_dwordx4 v[188:191], v252, s[60:63], s18 offen offset:3072 sc1
    buffer_load_dwordx2 v[192:193], v253, s[60:63], s18 offen offset:512 sc1
    s_waitcnt vmcnt(0)
    v_max3_u32 v6, v184, v188, v192
    v_cmp_eq_u32_e64 vcc, -1, v6
    s_nop 4
    s_cbranch_vccz G2_21_s_ok
    s_sleep 2
    s_sub_u32 s50, s50, 1
    s_cmp_lg_u32 s50, 0
    s_cbranch_scc1 G2_21_s
G2_21_s_ok:
    s_branch G2_21_back
G2_31_slow:
    s_mov_b32 s50, 60000
G2_31_s:
    buffer_load_dwordx4 v[194:197], v252, s[60:63], s19 offen offset:2048 sc1
    buffer_load_dwordx4 v[198:201], v252, s[60:63], s19 offen offset:3072 sc1
    buffer_load_dwordx2 v[202:203], v253, s[60:63], s19 offen offset:512 sc1
    s_waitcnt vmcnt(0)
    v_max3_u32 v6, v194, v198, v202
    v_cmp_eq_u32_e64 vcc, -1, v6
    s_nop 4
    s_cbranch_vccz G2_31_s_ok
    s_sleep 2
    s_sub_u32 s50, s50, 1
    s_cmp_lg_u32 s50, 0
    s_cbranch_scc1 G2_31_s
G2_31_s_ok:
    s_branch G2_31_back
G2_41_slow:
    s_mov_b32 s50, 60000
G2_41_s:
    buffer_load_dwordx4 v[204:207], v252, s[60:63], s20 offen offset:2048 sc1
    buffer_load_dwordx4 v[208:211], v252, s[60:63], s20 offen offset:3072 sc1
    buffer_load_dwordx2 v[212:213], v253, s[60:63], s20 offen offset:512 sc1
    s_waitcnt vmcnt(0)
    v_max3_u32 v6, v204, v208, v212
    v_cmp_eq_u32_e64 vcc, -1, v6
    s_nop 4
    s_cbranch_vccz G2_41_s_ok
    s_sleep 2
    s_sub_u32 s50, s50, 1
    s_cmp_lg_u32 s50, 0
    s_cbranch_scc1 G2_41_s
G2_41_s_ok:
    s_branch G2_41_back
G2_51_slow:
    s_mov_b32 s50, 60000
G2_51_s:
    buffer_load_dwordx4 v[214:217], v252, s[60:63], s21 offen offset:2048 sc1
    buffer_load_dwordx4 v[218:221], v252, s[60:63], s21 offen offset:3072 sc1
    buffer_load_dwordx2 v[222:223], v253, s[60:63], s21 offen offset:512 sc1
    s_waitcnt vmcnt(0)
    v_max3_u32 v6, v214, v218, v222
    v_cmp_eq_u32_e64 vcc, -1, v6
    s_nop 4
    s_cbranch_vccz G2_51_s_ok
    s_sleep 2
    s_sub_u32 s50, s50, 1
    s_cmp_lg_u32 s50, 0
    s_cbranch_scc1 G2_51_s
G2_51_s_ok:
    s_branch G2_51_back
G2_61_slow:
    s_mov_b32 s50, 60000
G2_61_s:
    buffer_load_dwordx4 v[224:227], v252, s[60:63], s22 offen offset:2048 sc1
    buffer_load_dwordx4 v[228:231], v252, s[60:63], s22 offen offset:3072 sc1
    buffer_load_dwordx2 v[232:233], v253, s[60:63], s22 offen offset:512 sc1
    s_waitcnt vmcnt(0)
    v_max3_u32 v6, v224, v228, v232
    v_cmp_eq_u32_e64 vcc, -1, v6
    s_nop 4
    s_cbranch_vccz G2_61_s_ok
    s_sleep 2
    s_sub_u32 s50, s50, 1
    s_cmp_lg_u32 s50, 0
    s_cbranch_scc1 G2_61_s
G2_61_s_ok:
    s_branch G2_61_back
G2_71_slow:
    s_mov_b32 s50, 60000
G2_71_s:
    buffer_load_dwordx4 v[234:237], v252, s[60:63], s23 offen offset:2048 sc1
    buffer_load_dwordx4 v[238:241], v252, s[60:63], s23 offen offset:3072 sc1
    buffer_load_dwordx2 v[242:243], v253, s[60:63], s23 offen offset:512 sc1
    s_waitcnt vmcnt(0)
    v_max3_u32 v6, v234, v238, v242
    v_cmp_eq_u32 vcc, -1, v6
    s_nop 4
    s_cbranch_vccz G2_71_s_ok
    s_sleep 2
    s_sub_u32 s50, s50, 1
    s_cmp_lg_u32 s50, 0
    s_cbranch_scc1 G2_71_s
G2_71_s_ok:
    s_branch G2_71_back
H_retry:
    s_sleep 2
    s_sub_u32 s50, s50, 1
    s_cmp_lg_u32 s50, 0
    s_cbranch_scc1 H_load
    s_branch H_store
GH_00_slow:
    s_mov_b32 s50, 60000
GH_00_s:
    buffer_load_dwordx4 v[84:87], v252, s[60:63], s16 offen offset:0 sc1
    buffer_load_dwordx4 v[88:91], v252, s[60:63], s16 offen offset:1024 sc1
    buffer_load_dwordx2 v[92:93], v253, s[60:63], s16 offen offset:0 sc1
    s_waitcnt vmcnt(0)
    v_max3_u32 v6, v84, v88, v92
    v_cmp_eq_u32_e64 vcc, -1, v6
    s_nop 4
    s_cbranch_vccz GH_00_s_ok
    s_sleep 2
    s_sub_u32 s50, s50, 1
    s_cmp_lg_u32 s50, 0
    s_cbranch_scc1 GH_00_s
GH_00_s_ok:
    s_branch GH_00_back
GH_10_slow:
    s_mov_b32 s50, 60000
GH_10_s:
    buffer_load_dwordx4 v[94:97], v252, s[60:63], s17 offen offset:0 sc1
    buffer_load_dwordx4 v[98:101], v252, s[60:63], s17 offen offset:1024 sc1
    buffer_load_dwordx2 v[102:103], v253, s[60:63], s17 offen offset:0 sc1
    s_waitcnt vmcnt(0)
    v_max3_u32 v6, v94, v98, v102
    v_cmp_eq_u32_e64 vcc, -1, v6
    s_nop 4
    s_cbranch_vccz GH_10_s_ok
    s_sleep 2
    s_sub_u32 s50, s50, 1
    s_cmp_lg_u32 s50, 0
    s_cbranch_scc1 GH_10_s
GH_10_s_ok:
    s_branch GH_10_back
GH_20_slow:
    s_mov_b32 s50, 60000
GH_20_s:
    buffer_load_dwordx4 v[104:107], v252, s[60:63], s18 offen offset:0 sc1
    buffer_load_dwordx4 v[108:111], v252, s[60:63], s18 offen offset:1024 sc1
    buffer_load_dwordx2 v[112:113], v253, s[60:63], s18 offen offset:0 sc1
    s_waitcnt vmcnt(0)
    v_max3_u32 v6, v104, v108, v112
    v_cmp_eq_u32_e64 vcc, -1, v6
    s_nop 4
    s_cbranch_vccz GH_20_s_ok
    s_sleep 2
    s_sub_u32 s50, s50, 1
    s_cmp_lg_u32 s50, 0
    s_cbranch_scc1 GH_20_s
GH_20_s_ok:
    s_branch GH_20_back
GH_30_slow:
    s_mov_b32 s50, 60000
GH_30_s:
    buffer_load_dwordx4 v[114:117], v252, s[60:63], s19 offen offset:0 sc1
    buffer_load_dwordx4 v[118:121], v252, s[60:63], s19 offen offset:1024 sc1
    buffer_load_dwordx2 v[122:123], v253, s[60:63], s19 offen offset:0 sc1
    s_waitcnt vmcnt(0)
    v_max3_u32 v6, v114, v118, v122
    v_cmp_eq_u32_e64 vcc, -1, v6
    s_nop 4
    s_cbranch_vccz GH_30_s_ok
    s_sleep 2
    s_sub_u32 s50, s50, 1
    s_cmp_lg_u32 s50, 0
    s_cbranch_scc1 GH_30_s
GH_30_s_ok:
    s_branch GH_30_back
GH_40_slow:
    s_mov_b32 s50, 60000
GH_40_s:
    buffer_load_dwordx4 v[124:127], v252, s[60:63], s20 offen offset:0 sc1
    buffer_load_dwordx4 v[128:131], v252, s[60:63], s20 offen offset:1024 sc1
    buffer_load_dwordx2 v[132:133], v253, s[60:63], s20 offen offset:0 sc1
    s_waitcnt vmcnt(0)
    v_max3_u32 v6, v124, v128, v132
    v_cmp_eq_u32_e64 vcc, -1, v6
    s_nop 4
    s_cbranch_vccz GH_40_s_ok
    s_sleep 2
    s_sub_u32 s50, s50, 1
    s_cmp_lg_u32 s50, 0
    s_cbranch_scc1 GH_40_s
GH_40_s_ok:
    s_branch GH_40_back
GH_50_slow:
    s_mov_b32 s50, 60000
GH_50_s:
    buffer_load_dwordx4 v[134:137], v252, s[60:63], s21 offen offset:0 sc1
    buffer_load_dwordx4 v[138:141], v252, s[60:63], s21 offen offset:1024 sc1
    buffer_load_dwordx2 v[142:143], v253, s[60:63], s21 offen offset:0 sc1
    s_waitcnt vmcnt(0)
    v_max3_u32 v6, v134, v138, v142
    v_cmp_eq_u32_e64 vcc, -1, v6
    s_nop 4
    s_cbranch_vccz GH_50_s_ok
    s_sleep 2
    s_sub_u32 s50, s50, 1
    s_cmp_lg_u32 s50, 0
    s_cbranch_scc1 GH_50_s
GH_50_s_ok:
    s_branch GH_50_back
GH_60_slow:
    s_mov_b32 s50, 60000
GH_60_s:
    buffer_load_dwordx4 v[144:147], v252, s[60:63], s22 offen offset:0 sc1
    buffer_load_dwordx4 v[148:151], v252, s[60:63], s22 offen offset:1024 sc1
    buffer_load_dwordx2 v[152:153], v253, s[60:63], s22 offen offset:0 sc1
    s_waitcnt vmcnt(0)
    v_max3_u32 v6, v144, v148, v152
    v_cmp_eq_u32_e64 vcc, -1, v6
    s_nop 4
    s_cbranch_vccz GH_60_s_ok
    s_sleep 2
    s_sub_u32 s50, s50, 1
    s_cmp_lg_u32 s50, 0
    s_cbranch_scc1 GH_60_s
GH_60_s_ok:
    s_branch GH_60_back
GH_70_slow:
    s_mov_b32 s50, 60000
GH_70_s:
    buffer_load_dwordx4 v[154:157], v252, s[60:63], s23 offen offset:0 sc1
    buffer_load_dwordx4 v[158:161], v252, s[60:63], s23 offen offset:1024 sc1
    buffer_load_dwordx2 v[162:163], v253, s[60:63], s23 offen offset:0 sc1
    s_waitcnt vmcnt(0)
    v_max3_u32 v6, v154, v158, v162
    v_cmp_eq_u32_e64 vcc, -1, v6
    s_nop 4
    s_cbranch_vccz GH_70_s_ok
    s_sleep 2
    s_sub_u32 s50, s50, 1
    s_cmp_lg_u32 s50, 0
    s_cbranch_scc1 GH_70_s
GH_70_s_ok:
    s_branch GH_70_back
GH_01_slow:
    s_mov_b32 s50, 60000
GH_01_s:
    buffer_load_dwordx4 v[164:167], v252, s[60:63], s16 offen offset:2048 sc1
    buffer_load_dwordx4 v[168:171], v252, s[60:63], s16 offen offset:3072 sc1
    buffer_load_dwordx2 v[172:173], v253, s[60:63], s16 offen offset:512 sc1
    s_waitcnt vmcnt(0)
    v_max3_u32 v6, v164, v168, v172
    v_cmp_eq_u32_e64 vcc, -1, v6
    s_nop 4
    s_cbranch_vccz GH_01_s_ok
    s_sleep 2
    s_sub_u32 s50, s50, 1
    s_cmp_lg_u32 s50, 0
    s_cbranch_scc1 GH_01_s
GH_01_s_ok:
    s_branch GH_01_back
GH_11_slow:
    s_mov_b32 s50, 60000
GH_11_s:
    buffer_load_dwordx4 v[174:177], v252, s[60:63], s17 offen offset:2048 sc1
    buffer_load_dwordx4 v[178:181], v252, s[60:63], s17 offen offset:3072 sc1
    buffer_load_dwordx2 v[182:183], v253, s[60:63], s17 offen offset:512 sc1
    s_waitcnt vmcnt(0)
    v_max3_u32 v6, v174, v178, v182
    v_cmp_eq_u32_e64 vcc, -1, v6
    s_nop 4
    s_cbranch_vccz GH_11_s_ok
    s_sleep 2
    s_sub_u32 s50, s50, 1
    s_cmp_lg_u32 s50, 0
    s_cbranch_scc1 GH_11_s
GH_11_s_ok:
    s_branch GH_11_back
GH_21_slow:
    s_mov_b32 s50, 60000
GH_21_s:
    buffer_load_dwordx4 v[184:187], v252, s[60:63], s18 offen offset:2048 sc1
    buffer_load_dwordx4 v[188:191], v252, s[60:63], s18 offen offset:3072 sc1
    buffer_load_dwordx2 v[192:193], v253, s[60:63], s18 offen offset:512 sc1
    s_waitcnt vmcnt(0)
    v_max3_u32 v6, v184, v188, v192
    v_cmp_eq_u32_e64 vcc, -1, v6
    s_nop 4
    s_cbranch_vccz GH_21_s_ok
    s_sleep 2
    s_sub_u32 s50, s50, 1
    s_cmp_lg_u32 s50, 0
    s_cbranch_scc1 GH_21_s
GH_21_s_ok:
    s_branch GH_21_back
GH_31_slow:
    s_mov_b32 s50, 60000
GH_31_s:
    buffer_load_dwordx4 v[194:197], v252, s[60:63], s19 offen offset:2048 sc1
    buffer_load_dwordx4 v[198:201], v252, s[60:63], s19 offen offset:3072 sc1
    buffer_load_dwordx2 v[202:203], v253, s[60:63], s19 offen offset:512 sc1
    s_waitcnt vmcnt(0)
    v_max3_u32 v6, v194, v198, v202
    v_cmp_eq_u32_e64 vcc, -1, v6
    s_nop 4
    s_cbranch_vccz GH_31_s_ok
    s_sleep 2
    s_sub_u32 s50, s50, 1
    s_cmp_lg_u32 s50, 0
    s_cbranch_scc1 GH_31_s
GH_31_s_ok:
    s_branch GH_31_back
GH_41_slow:
    s_mov_b32 s50, 60000
GH_41_s:
    buffer_load_dwordx4 v[204:207], v252, s[60:63], s20 offen offset:2048 sc1
    buffer_load_dwordx4 v[208:211], v252, s[60:63], s20 offen offset:3072 sc1
    buffer_load_dwordx2 v[212:213], v253, s[60:63], s20 offen offset:512 sc1
    s_waitcnt vmcnt(0)
    v_max3_u32 v6, v204, v208, v212
    v_cmp_eq_u32_e64 vcc, -1, v6
    s_nop 4
    s_cbranch_vccz GH_41_s_ok
    s_sleep 2
    s_sub_u32 s50, s50, 1
    s_cmp_lg_u32 s50, 0
    s_cbranch_scc1 GH_41_s
GH_41_s_ok:
    s_branch GH_41_back
GH_51_slow:
    s_mov_b32 s50, 60000
GH_51_s:
    buffer_load_dwordx4 v[214:217], v252, s[60:63], s21 offen offset:2048 sc1
    buffer_load_dwordx4 v[218:221], v252, s[60:63], s21 offen offset:3072 sc1
    buffer_load_dwordx2 v[222:223], v253, s[60:63], s21 offen offset:512 sc1
    s_waitcnt vmcnt(0)
    v_max3_u32 v6, v214, v218, v222
    v_cmp_eq_u32_e64 vcc, -1, v6
    s_nop 4
    s_cbranch_vccz GH_51_s_ok
    s_sleep 2
    s_sub_u32 s50, s50, 1
    s_cmp_lg_u32 s50, 0
    s_cbranch_scc1 GH_51_s
GH_51_s_ok:
    s_branch GH_51_back
GH_61_slow:
    s_mov_b32 s50, 60000
GH_61_s:
    buffer_load_dwordx4 v[224:227], v252, s[60:63], s22 offen offset:2048 sc1
    buffer_load_dwordx4 v[228:231], v252, s[60:63], s22 offen offset:3072 sc1
    buffer_load_dwordx2 v[232:233], v253, s[60:63], s22 offen offset:512 sc1
    s_waitcnt vmcnt(0)
    v_max3_u32 v6, v224, v228, v232
    v_cmp_eq_u32_e64 vcc, -1, v6
    s_nop 4
    s_cbranch_vccz GH_61_s_ok
    s_sleep 2
    s_sub_u32 s50, s50, 1
    s_cmp_lg_u32 s50, 0
    s_cbranch_scc1 GH_61_s
GH_61_s_ok:
    s_branch GH_61_back
GH_71_slow:
    s_mov_b32 s50, 60000
GH_71_s:
    buffer_load_dwordx4 v[234:237], v252, s[60:63], s23 offen offset:2048 sc1
    buffer_load_dwordx4 v[238:241], v252, s[60:63], s23 offen offset:3072 sc1
    buffer_load_dwordx2 v[242:243], v253, s[60:63], s23 offen offset:512 sc1
    s_waitcnt vmcnt(0)
    v_max3_u32 v6, v234, v238, v242
    v_cmp_eq_u32 vcc, -1, v6
    s_nop 4
    s_cbranch_vccz GH_71_s_ok
    s_sleep 2
    s_sub_u32 s50, s50, 1
    s_cmp_lg_u32 s50, 0
    s_cbranch_scc1 GH_71_s
GH_71_s_ok:
    s_branch GH_71_back
    .p2align 3
    .p2align 12,,768
L_B:
    s_mov_b32 s40, s48
    s_add_u32 s41, s40, 64
    s_min_u32 s47, s41, 179
    s_mul_i32 s46, s47, 911
    s_lshr_b32 s46, s46, 14
    s_mul_i32 s44, s46, 18
    s_sub_u32 s47, s47, s44
    s_and_b32 s44, s33, 1
    s_cmp_ge_u32 s47, 13
    s_addc_u32 s44, s44, 0
    s_mul_i32 s44, s44, 5
    s_add_u32 s44, s44, s47
    s_mul_i32 s45, s46, 1920
    s_add_u32 s44, s44, s45
    s_add_u32 s44, s44, 2
    s_and_b32 s45, s33, 6
    s_lshl2_add_u32 s45, s45, s47
    s_mulk_i32 s45, 640
    s_add_u32 s45, s45, s46
    s_cmp_lt_u32 s47, 8
    s_cselect_b32 s44, s45, s44
    s_cselect_b32 s45, 10, 30
    v_mul_u32_u24 v25, s45, v1
    v_add_lshl_u32 v25, v25, s44, 7
    s_cselect_b64 s[76:77], s[4:5], s[6:7]
    s_nop 0
    s_add_u32 s41, s40, 128
    s_min_u32 s47, s41, 179
    s_mul_i32 s46, s47, 911
    s_lshr_b32 s46, s46, 14
    s_mul_i32 s44, s46, 18
    s_sub_u32 s47, s47, s44
    s_and_b32 s44, s33, 1
    s_cmp_ge_u32 s47, 13
    s_addc_u32 s44, s44, 0
    s_mul_i32 s44, s44, 5
    s_add_u32 s44, s44, s47
    s_mul_i32 s45, s46, 1920
    s_add_u32 s44, s44, s45
    s_add_u32 s44, s44, 2
    s_and_b32 s45, s33, 6
    s_lshl2_add_u32 s45, s45, s47
    s_mulk_i32 s45, 640
    s_add_u32 s45, s45, s46
    s_cmp_lt_u32 s47, 8
    s_cselect_b32 s44, s45, s44
    s_cselect_b32 s45, 10, 30
    v_mul_u32_u24 v62, s45, v1
    v_add_lshl_u32 v62, v62, s44, 7
    s_cselect_b64 s[78:79], s[4:5], s[6:7]
    s_mov_b32 s64, s12
    s_and_b32 s65, s13, 0xffff
    s_mov_b32 s66, 2621440
    s_mov_b32 s67, 0x20000
    s_mov_b32 s68, s26
    s_nop 0
    s_and_b32 s69, s27, 0xffff
    s_mov_b32 s70, 5242880
    s_mov_b32 s71, 0x20000
    v_mul_u32_u24 v23, 1280, v0
    s_lshl_b32 s51, s60, 4
    v_add_u32 v23, s51, v23
    v_mul_u32_u24 v53, 2560, v0
    s_add_u32 s51, s51, 1280
    v_add_u32_e64 v53, s51, v53
    s_lshl_b32 s48, s32, 13
    s_lshl_b32 s37, s32, 7
    s_add_u32 s54, s37, 63984
    s_add_u32 s58, s37, 100224
    s_mul_i32 s55, s32, 9184
    s_add_u32 s55, s55, 63488
    s_mul_i32 s56, s32, 7680
    s_add_u32 s56, s56, 32768
    s_mul_i32 s57, s32, 8224
    s_add_u32 s57, s57, 100224
    s_mov_b32 s49, s60
    s_nop 0
    s_mul_i32 s51, s32, 15360
    s_add_u32 s51, s51, 100224
    v_mul_u32_u24 v50, 240, v1
    v_add_u32 v50, s51, v50
    v_lshrrev_b32 v2, 5, v1
    v_bfe_u32 v3, v1, 3, 1
    v_lshl_add_u32 v2, v3, 3, v2
    v_mul_u32_u24 v2, 240, v2
    v_bfe_u32 v3, v1, 4, 1
    v_lshl_add_u32 v2, v3, 5, v2
    v_and_b32 v3, 3, v1
    v_lshl_add_u32 v2, v3, 3, v2
    v_add_u32 v2, s51, v2
    v_bfe_u32 v3, v1, 2, 1
    v_lshl_add_u32 v52, v3, 6, v2
    v_mul_u32_u24_e64 v3, 48, v3
    v_add3_u32 v51, v2, v3, 64
    v_add_u32 v51, 64, v51
    s_getpc_b64 s[72:73]
B_pc:
    s_add_u32 s72, s72, L_tbl-B_pc+4096
    s_addc_u32 s73, s73, 0
    v_lshlrev_b32 v4, 4, v1
    s_waitcnt lgkmcnt(0)
    s_lshl_b32 s37, s38, 16
    s_and_b32 s51, s38, 0xffff0000
    v_cmp_gt_u32 vcc, 32, v1
    v_mov_b32 v2, s37
    v_mov_b32 v3, s51
    v_cndmask_b32 v2, v3, v2, vcc
    v_mul_f32 v2, 0x3fb8aa3b, v2
    v_exp_f32 v2, v2
    s_lshl_b32 s37, s39, 16
    s_and_b32 s51, s39, 0xffff0000
    v_cvt_pk_bf16_f32 v2, v2, v2
    v_and_b32 v2, 0xffff0000, v2
    v_mul_f32 v6, 0xbfb8aa3b, v2
    v_mul_f32 v7, 0x3e22f983, v2
    v_add_f32 v11, v2, v2
    v_cmp_eq_u32 vcc, 0, v1
    v_mov_b32 v2, s37
    v_mov_b32 v3, s51
    v_cndmask_b32 v15, 0, v2, vcc
    v_cndmask_b32 v19, 0, v3, vcc
    s_mov_b64 exec, 0
    s_cmp_eq_u32 s32, 0
    s_cbranch_scc1 WB_P0
    s_cmp_eq_u32 s32, 1
    s_cbranch_scc1 WB_P1
    s_cmp_eq_u32 s32, 2
    s_cbranch_scc1 WB_P2
    s_branch WB_P3
WB_R:
    s_mov_b64 exec, -1
    s_waitcnt vmcnt(1)
    s_cmp_lt_u32 s40, 36
    s_cbranch_scc1 B_w1
    s_waitcnt vmcnt(0)
    global_load_dword v63, v24, s[52:53]
B_w1:
    v_lshlrev_b32 v96, 16, v8
    v_lshlrev_b32 v97, 16, v12
    v_lshlrev_b32 v98, 16, v16
    v_lshlrev_b32 v99, 16, v20
    v_mul_f32 v96, 0x3fb8aa3b, v96
    v_mul_f32 v97, v7, v97
    v_exp_f32 v96, v96
    v_mul_f32 v100, 0xc1000000, v97
    v_mul_f32 v101, 0x43800000, v97
    v_cvt_pk_bf16_f32 v96, v96, v96
    v_fract_f32 v97, v97
    v_fract_f32 v100, v100
    v_fract_f32 v101, v101
    v_and_b32 v96, 0xffff0000, v96
    v_mul_f32 v96, v6, v96
    v_cos_f32 v54, v97
    v_sin_f32 v55, v97
    v_mul_f32 v102, 0x41000000, v96
    v_mul_f32 v103, 0x43800000, v96
    v_cos_f32 v56, v100
    v_sin_f32 v57, v100
    v_cos_f32 v58, v101
    v_sin_f32 v59, v101
    v_exp_f32 v96, v96
    v_exp_f32 v102, v102
    v_exp_f32 v103, v103
    v_mul_f32 v60, v11, v98
    v_mul_f32 v61, v11, v99
    v_mul_f32 v54, v96, v54
    v_mul_f32 v55, v96, v55
    v_mul_f32 v56, v102, v56
    v_mul_f32 v57, v102, v57
    v_mul_f32 v58, v103, v58
    v_mul_f32_e64 v59, v103, v59
    v_pk_mul_f32 v[120:121], v[56:57], v[56:57] op_sel:[0,0] op_sel_hi:[0,1]
    v_pk_mul_f32 v[140:141], v[60:61], v[54:55] op_sel:[0,0] op_sel_hi:[0,1]
    v_pk_fma_f32 v[120:121], v[56:57], v[56:57], v[120:121] op_sel:[1,1,0] op_sel_hi:[1,0,1] neg_lo:[1,0,0]
    v_pk_mul_f32 v[154:155], v[60:61], v[58:59] op_sel:[0,0] op_sel_hi:[0,1]
    v_cvt_pk_bf16_f32 v124, 1.0, v56
    v_cvt_pk_bf16_f32 v132, 0, v57
    v_pk_fma_f32 v[140:141], v[60:61], v[54:55], v[140:141] op_sel:[1,1,0] op_sel_hi:[1,0,1] neg_lo:[1,0,0]
    v_pk_mul_f32 v[118:119], v[56:57], v[120:121] op_sel:[0,0] op_sel_hi:[0,1]
    v_pk_fma_f32 v[154:155], v[60:61], v[58:59], v[154:155] op_sel:[1,1,0] op_sel_hi:[1,0,1] neg_lo:[1,0,0]
    v_pk_fma_f32 v[118:119], v[56:57], v[120:121], v[118:119] op_sel:[1,1,0] op_sel_hi:[1,0,1] neg_lo:[1,0,0]
    v_cvt_pk_bf16_f32 v125, v120, v118
    v_cvt_pk_bf16_f32 v180, v60, v140
    v_cvt_pk_bf16_f32 v133, v121, v119
    v_cvt_pk_bf16_f32 v192, v61, v141
    v_pk_mul_f32 v[112:113], v[120:121], v[120:121] op_sel:[0,0] op_sel_hi:[0,1]
    v_pk_mul_f32 v[116:117], v[118:119], v[120:121] op_sel:[0,0] op_sel_hi:[0,1]
    v_pk_mul_f32 v[142:143], v[140:141], v[54:55] op_sel:[0,0] op_sel_hi:[0,1]
WB_P0:
    s_cbranch_execz WB_P4
    s_nop 0
    v_pk_fma_f32 v[112:113], v[120:121], v[120:121], v[112:113] op_sel:[1,1,0] op_sel_hi:[1,0,1] neg_lo:[1,0,0]
    v_pk_mul_f32 v[162:163], v[154:155], v[58:59] op_sel:[0,0] op_sel_hi:[0,1]
    v_pk_fma_f32 v[116:117], v[118:119], v[120:121], v[116:117] op_sel:[1,1,0] op_sel_hi:[1,0,1] neg_lo:[1,0,0]
    v_cvt_pk_bf16_f32 v126, v112, v116
    v_pk_fma_f32 v[142:143], v[140:141], v[54:55], v[142:143] op_sel:[1,1,0] op_sel_hi:[1,0,1] neg_lo:[1,0,0]
    v_cvt_pk_bf16_f32 v134, v113, v117
    v_pk_fma_f32 v[162:163], v[154:155], v[58:59], v[162:163] op_sel:[1,1,0] op_sel_hi:[1,0,1] neg_lo:[1,0,0]
    v_pk_mul_f32 v[114:115], v[112:113], v[120:121] op_sel:[0,0] op_sel_hi:[0,1]
    v_pk_mul_f32 v[144:145], v[142:143], v[54:55] op_sel:[0,0] op_sel_hi:[0,1]
    v_pk_mul_f32 v[118:119], v[116:117], v[120:121] op_sel:[0,0] op_sel_hi:[0,1]
    v_pk_fma_f32 v[114:115], v[112:113], v[120:121], v[114:115] op_sel:[1,1,0] op_sel_hi:[1,0,1] neg_lo:[1,0,0]
    v_pk_mul_f32 v[166:167], v[162:163], v[58:59] op_sel:[0,0] op_sel_hi:[0,1]
    v_pk_fma_f32 v[118:119], v[116:117], v[120:121], v[118:119] op_sel:[1,1,0] op_sel_hi:[1,0,1] neg_lo:[1,0,0]
    v_pk_fma_f32 v[144:145], v[142:143], v[54:55], v[144:145] op_sel:[1,1,0] op_sel_hi:[1,0,1] neg_lo:[1,0,0]
    v_cvt_pk_bf16_f32 v127, v114, v118
    v_cvt_pk_bf16_f32 v135, v115, v119
    v_pk_fma_f32 v[166:167], v[162:163], v[58:59], v[166:167] op_sel:[1,1,0] op_sel_hi:[1,0,1] neg_lo:[1,0,0]
    v_cvt_pk_bf16_f32 v181, v142, v144
    ds_write_b128 v50, v[124:127] offset:0
    ds_write_b128 v50, v[132:135] offset:64
    v_pk_mul_f32 v[112:113], v[114:115], v[120:121] op_sel:[0,0] op_sel_hi:[0,1]
    v_cvt_pk_bf16_f32 v193, v143, v145
    v_pk_mul_f32 v[116:117], v[118:119], v[120:121] op_sel:[0,0] op_sel_hi:[0,1]
    v_pk_mul_f32 v[146:147], v[144:145], v[54:55] op_sel:[0,0] op_sel_hi:[0,1]
    v_pk_fma_f32 v[112:113], v[114:115], v[120:121], v[112:113] op_sel:[1,1,0] op_sel_hi:[1,0,1] neg_lo:[1,0,0]
    v_pk_fma_f32 v[116:117], v[118:119], v[120:121], v[116:117] op_sel:[1,1,0] op_sel_hi:[1,0,1] neg_lo:[1,0,0]
    v_pk_mul_f32 v[170:171], v[166:167], v[58:59] op_sel:[0,0] op_sel_hi:[0,1]
    v_cvt_pk_bf16_f32 v128, v112, v116
    v_pk_fma_f32 v[146:147], v[144:145], v[54:55], v[146:147] op_sel:[1,1,0] op_sel_hi:[1,0,1] neg_lo:[1,0,0]
    v_cvt_pk_bf16_f32 v136, v113, v117
    v_pk_mul_f32 v[114:115], v[112:113], v[120:121] op_sel:[0,0] op_sel_hi:[0,1]
    v_pk_fma_f32 v[170:171], v[166:167], v[58:59], v[170:171] op_sel:[1,1,0] op_sel_hi:[1,0,1] neg_lo:[1,0,0]
    v_pk_mul_f32 v[118:119], v[116:117], v[120:121] op_sel:[0,0] op_sel_hi:[0,1]
    v_pk_mul_f32 v[148:149], v[146:147], v[54:55] op_sel:[0,0] op_sel_hi:[0,1]
    v_pk_fma_f32 v[114:115], v[112:113], v[120:121], v[114:115] op_sel:[1,1,0] op_sel_hi:[1,0,1] neg_lo:[1,0,0]
    v_pk_fma_f32 v[118:119], v[116:117], v[120:121], v[118:119] op_sel:[1,1,0] op_sel_hi:[1,0,1] neg_lo:[1,0,0]
    v_pk_mul_f32 v[172:173], v[170:171], v[58:59] op_sel:[0,0] op_sel_hi:[0,1]
    v_cvt_pk_bf16_f32 v129, v114, v118
    v_pk_fma_f32 v[148:149], v[146:147], v[54:55], v[148:149] op_sel:[1,1,0] op_sel_hi:[1,0,1] neg_lo:[1,0,0]
    v_cvt_pk_bf16_f32 v137, v115, v119
    v_pk_mul_f32 v[112:113], v[114:115], v[120:121] op_sel:[0,0] op_sel_hi:[0,1]
    v_pk_fma_f32 v[172:173], v[170:171], v[58:59], v[172:173] op_sel:[1,1,0] op_sel_hi:[1,0,1] neg_lo:[1,0,0]
    v_pk_mul_f32 v[116:117], v[118:119], v[120:121] op_sel:[0,0] op_sel_hi:[0,1]
    v_cvt_pk_bf16_f32 v182, v146, v148
    v_pk_fma_f32 v[112:113], v[114:115], v[120:121], v[112:113] op_sel:[1,1,0] op_sel_hi:[1,0,1] neg_lo:[1,0,0]
    v_pk_fma_f32 v[116:117], v[118:119], v[120:121], v[116:117] op_sel:[1,1,0] op_sel_hi:[1,0,1] neg_lo:[1,0,0]
    v_cvt_pk_bf16_f32 v194, v147, v149
    v_cvt_pk_bf16_f32 v130, v112, v116
    v_cvt_pk_bf16_f32 v188, v170, v172
    v_cvt_pk_bf16_f32 v138, v113, v117
    v_cvt_pk_bf16_f32 v200, v171, v173
    v_pk_mul_f32 v[114:115], v[112:113], v[120:121] op_sel:[0,0] op_sel_hi:[0,1]
    v_pk_mul_f32 v[118:119], v[116:117], v[120:121] op_sel:[0,0] op_sel_hi:[0,1]
    v_pk_mul_f32 v[150:151], v[148:149], v[54:55] op_sel:[0,0] op_sel_hi:[0,1]
    v_pk_fma_f32 v[114:115], v[112:113], v[120:121], v[114:115] op_sel:[1,1,0] op_sel_hi:[1,0,1] neg_lo:[1,0,0]
    v_pk_mul_f32 v[174:175], v[172:173], v[58:59] op_sel:[0,0] op_sel_hi:[0,1]
    v_pk_fma_f32 v[118:119], v[116:117], v[120:121], v[118:119] op_sel:[1,1,0] op_sel_hi:[1,0,1] neg_lo:[1,0,0]
    v_cvt_pk_bf16_f32 v131, v114, v118
    v_pk_fma_f32 v[150:151], v[148:149], v[54:55], v[150:151] op_sel:[1,1,0] op_sel_hi:[1,0,1] neg_lo:[1,0,0]
    v_cvt_pk_bf16_f32 v139, v115, v119
    v_pk_fma_f32 v[174:175], v[172:173], v[58:59], v[174:175] op_sel:[1,1,0] op_sel_hi:[1,0,1] neg_lo:[1,0,0]
    ds_write_b128 v50, v[128:131] offset:16
    ds_write_b128 v50, v[136:139] offset:80
    v_pk_mul_f32 v[152:153], v[150:151], v[54:55] op_sel:[0,0] op_sel_hi:[0,1]
    v_pk_mul_f32 v[112:113], v[114:115], v[120:121] op_sel:[0,0] op_sel_hi:[0,1]
    v_pk_mul_f32 v[176:177], v[174:175], v[58:59] op_sel:[0,0] op_sel_hi:[0,1]
    v_pk_mul_f32 v[116:117], v[118:119], v[120:121] op_sel:[0,0] op_sel_hi:[0,1]
    v_pk_fma_f32 v[112:113], v[114:115], v[120:121], v[112:113] op_sel:[1,1,0] op_sel_hi:[1,0,1] neg_lo:[1,0,0]
    v_pk_fma_f32 v[152:153], v[150:151], v[54:55], v[152:153] op_sel:[1,1,0] op_sel_hi:[1,0,1] neg_lo:[1,0,0]
    v_pk_fma_f32 v[116:117], v[118:119], v[120:121], v[116:117] op_sel:[1,1,0] op_sel_hi:[1,0,1] neg_lo:[1,0,0]
    v_pk_fma_f32 v[176:177], v[174:175], v[58:59], v[176:177] op_sel:[1,1,0] op_sel_hi:[1,0,1] neg_lo:[1,0,0]
    v_cvt_pk_bf16_f32 v124, v112, v116
    v_cvt_pk_bf16_f32 v132, v113, v117
    v_cvt_pk_bf16_f32 v183, v150, v152
    v_pk_mul_f32 v[114:115], v[112:113], v[120:121] op_sel:[0,0] op_sel_hi:[0,1]
    v_cvt_pk_bf16_f32 v195, v151, v153
    v_pk_mul_f32 v[118:119], v[116:117], v[120:121] op_sel:[0,0] op_sel_hi:[0,1]
    v_pk_fma_f32 v[114:115], v[112:113], v[120:121], v[114:115] op_sel:[1,1,0] op_sel_hi:[1,0,1] neg_lo:[1,0,0]
    v_pk_fma_f32 v[118:119], v[116:117], v[120:121], v[118:119] op_sel:[1,1,0] op_sel_hi:[1,0,1] neg_lo:[1,0,0]
    ds_write_b128 v50, v[180:183] offset:128
    ds_write_b128 v50, v[192:195] offset:176
    global_load_dword v63, v25, s[76:77]
    v_cvt_pk_bf16_f32 v125, v114, v118
    v_cvt_pk_bf16_f32 v133, v115, v119
    v_cvt_pk_bf16_f32 v190, v174, v176
    v_pk_mul_f32 v[112:113], v[114:115], v[120:121] op_sel:[0,0] op_sel_hi:[0,1]
    v_cvt_pk_bf16_f32 v202, v175, v177
    v_pk_mul_f32 v[116:117], v[118:119], v[120:121] op_sel:[0,0] op_sel_hi:[0,1]
    v_pk_fma_f32 v[112:113], v[114:115], v[120:121], v[112:113] op_sel:[1,1,0] op_sel_hi:[1,0,1] neg_lo:[1,0,0]
    v_pk_mul_f32 v[156:157], v[142:143], v[58:59] op_sel:[0,0] op_sel_hi:[0,1]
    v_pk_fma_f32 v[116:117], v[118:119], v[120:121], v[116:117] op_sel:[1,1,0] op_sel_hi:[1,0,1] neg_lo:[1,0,0]
    v_pk_mul_f32 v[178:179], v[176:177], v[58:59] op_sel:[0,0] op_sel_hi:[0,1]
    v_cvt_pk_bf16_f32 v126, v112, v116
    v_pk_fma_f32 v[156:157], v[142:143], v[58:59], v[156:157] op_sel:[1,1,0] op_sel_hi:[1,0,1] neg_lo:[1,0,0]
    v_cvt_pk_bf16_f32 v134, v113, v117
    v_pk_mul_f32 v[114:115], v[112:113], v[120:121] op_sel:[0,0] op_sel_hi:[0,1]
    v_pk_fma_f32 v[178:179], v[176:177], v[58:59], v[178:179] op_sel:[1,1,0] op_sel_hi:[1,0,1] neg_lo:[1,0,0]
    v_pk_mul_f32 v[118:119], v[116:117], v[120:121] op_sel:[0,0] op_sel_hi:[0,1]
    v_cvt_pk_bf16_f32 v184, v154, v156
    v_pk_fma_f32 v[114:115], v[112:113], v[120:121], v[114:115] op_sel:[1,1,0] op_sel_hi:[1,0,1] neg_lo:[1,0,0]
    v_pk_fma_f32 v[118:119], v[116:117], v[120:121], v[118:119] op_sel:[1,1,0] op_sel_hi:[1,0,1] neg_lo:[1,0,0]
    v_cvt_pk_bf16_f32 v196, v155, v157
    v_cvt_pk_bf16_f32 v127, v114, v118
    v_cvt_pk_bf16_f32 v189, v178, v178
    v_cvt_pk_bf16_f32 v135, v115, v119
    v_cvt_pk_bf16_f32 v201, v179, v179
    ds_write_b128 v50, v[124:127] offset:32
    ds_write_b128 v50, v[132:135] offset:96
    v_pk_mul_f32 v[112:113], v[114:115], v[120:121] op_sel:[0,0] op_sel_hi:[0,1]
    v_pk_mul_f32 v[116:117], v[118:119], v[120:121] op_sel:[0,0] op_sel_hi:[0,1]
    ds_write_b128 v50, v[188:191] offset:160
    ds_write_b128 v50, v[200:203] offset:208
    v_pk_fma_f32 v[112:113], v[114:115], v[120:121], v[112:113] op_sel:[1,1,0] op_sel_hi:[1,0,1] neg_lo:[1,0,0]
    v_pk_mul_f32 v[158:159], v[146:147], v[58:59] op_sel:[0,0] op_sel_hi:[0,1]
    v_pk_fma_f32 v[116:117], v[118:119], v[120:121], v[116:117] op_sel:[1,1,0] op_sel_hi:[1,0,1] neg_lo:[1,0,0]
    v_cvt_pk_bf16_f32 v128, v112, v116
    v_pk_fma_f32 v[158:159], v[146:147], v[58:59], v[158:159] op_sel:[1,1,0] op_sel_hi:[1,0,1] neg_lo:[1,0,0]
    v_cvt_pk_bf16_f32 v136, v113, v117
    v_pk_mul_f32 v[160:161], v[150:151], v[58:59] op_sel:[0,0] op_sel_hi:[0,1]
    v_pk_mul_f32 v[114:115], v[112:113], v[120:121] op_sel:[0,0] op_sel_hi:[0,1]
    v_pk_mul_f32 v[118:119], v[116:117], v[120:121] op_sel:[0,0] op_sel_hi:[0,1]
    v_pk_fma_f32 v[160:161], v[150:151], v[58:59], v[160:161] op_sel:[1,1,0] op_sel_hi:[1,0,1] neg_lo:[1,0,0]
    v_pk_fma_f32 v[114:115], v[112:113], v[120:121], v[114:115] op_sel:[1,1,0] op_sel_hi:[1,0,1] neg_lo:[1,0,0]
    v_cvt_pk_bf16_f32 v186, v158, v160
    v_pk_fma_f32 v[118:119], v[116:117], v[120:121], v[118:119] op_sel:[1,1,0] op_sel_hi:[1,0,1] neg_lo:[1,0,0]
    v_cvt_pk_bf16_f32 v129, v114, v118
    v_cvt_pk_bf16_f32 v198, v159, v161
    v_cvt_pk_bf16_f32 v137, v115, v119
    v_pk_mul_f32 v[164:165], v[158:159], v[58:59] op_sel:[0,0] op_sel_hi:[0,1]
    v_pk_mul_f32 v[112:113], v[114:115], v[120:121] op_sel:[0,0] op_sel_hi:[0,1]
    v_pk_mul_f32 v[116:117], v[118:119], v[120:121] op_sel:[0,0] op_sel_hi:[0,1]
    v_pk_fma_f32 v[164:165], v[158:159], v[58:59], v[164:165] op_sel:[1,1,0] op_sel_hi:[1,0,1] neg_lo:[1,0,0]
    v_pk_fma_f32 v[112:113], v[114:115], v[120:121], v[112:113] op_sel:[1,1,0] op_sel_hi:[1,0,1] neg_lo:[1,0,0]
    v_cvt_pk_bf16_f32 v185, v162, v164
    v_pk_fma_f32 v[116:117], v[118:119], v[120:121], v[116:117] op_sel:[1,1,0] op_sel_hi:[1,0,1] neg_lo:[1,0,0]
    v_cvt_pk_bf16_f32 v197, v163, v165
    v_cvt_pk_bf16_f32 v130, v112, v116
    v_cvt_pk_bf16_f32 v138, v113, v117
    v_pk_mul_f32 v[168:169], v[164:165], v[58:59] op_sel:[0,0] op_sel_hi:[0,1]
    v_pk_mul_f32 v[114:115], v[112:113], v[120:121] op_sel:[0,0] op_sel_hi:[0,1]
    v_pk_fma_f32 v[168:169], v[164:165], v[58:59], v[168:169] op_sel:[1,1,0] op_sel_hi:[1,0,1] neg_lo:[1,0,0]
    v_pk_mul_f32 v[118:119], v[116:117], v[120:121] op_sel:[0,0] op_sel_hi:[0,1]
    v_pk_fma_f32 v[114:115], v[112:113], v[120:121], v[114:115] op_sel:[1,1,0] op_sel_hi:[1,0,1] neg_lo:[1,0,0]
    v_cvt_pk_bf16_f32 v187, v166, v168
    v_pk_fma_f32 v[118:119], v[116:117], v[120:121], v[118:119] op_sel:[1,1,0] op_sel_hi:[1,0,1] neg_lo:[1,0,0]
    v_cvt_pk_bf16_f32 v199, v167, v169
    v_cvt_pk_bf16_f32 v131, v114, v118
    v_cvt_pk_bf16_f32 v139, v115, v119
    ds_write_b128 v50, v[184:187] offset:144
    ds_write_b128 v50, v[128:131] offset:48
    ds_write_b128 v50, v[196:199] offset:192
    ds_write_b128 v50, v[136:139] offset:112
    v_and_b32 v96, 0xffff0000, v8
    v_and_b32 v97, 0xffff0000, v12
    v_and_b32 v98, 0xffff0000, v16
    v_and_b32 v99, 0xffff0000, v20
    v_mul_f32 v96, 0x3fb8aa3b, v96
    v_mul_f32 v97, v7, v97
    v_exp_f32 v96, v96
    v_mul_f32 v100, 0xc1000000, v97
    v_mul_f32 v101, 0x43800000, v97
    v_cvt_pk_bf16_f32 v96, v96, v96
    v_fract_f32 v97, v97
    v_fract_f32 v100, v100
    v_fract_f32_e64 v101, v101
    ds_read_b64_tr_b16 v[112:113], v51 offset:0
    ds_read_b64_tr_b16 v[116:117], v52 offset:0
    ds_read_b64_tr_b16 v[114:115], v51 offset:480
    ds_read_b64_tr_b16 v[118:119], v52 offset:480
    ds_read_b64_tr_b16 v[120:121], v51 offset:960
    ds_read_b64_tr_b16 v[124:125], v52 offset:960
    ds_read_b64_tr_b16 v[122:123], v51 offset:1440
    ds_read_b64_tr_b16 v[126:127], v52 offset:1440
    v_and_b32 v96, 0xffff0000, v96
    v_mul_f32 v96, v6, v96
    v_cos_f32 v54, v97
    v_sin_f32_e64 v55, v97
    v_mul_f32 v102, 0x41000000, v96
    v_mul_f32 v103, 0x43800000, v96
    v_cos_f32 v56, v100
    s_waitcnt lgkmcnt(4)
    v_mfma_f32_32x32x16_bf16 v[64:79], v[112:115], v[116:119], 0
    ds_read_b64_tr_b16 v[128:129], v51 offset:3840
    ds_read_b64_tr_b16 v[132:133], v52 offset:3840
    ds_read_b64_tr_b16 v[130:131], v51 offset:4320
    ds_read_b64_tr_b16 v[134:135], v52 offset:4320
    v_sin_f32 v57, v100
    s_waitcnt lgkmcnt(4)
    v_mfma_f32_32x32x16_bf16 v[64:79], v[120:123], v[124:127], v[64:79]
    ds_read_b64_tr_b16 v[136:137], v51 offset:4800
    ds_read_b64_tr_b16 v[140:141], v52 offset:4800
    ds_read_b64_tr_b16 v[138:139], v51 offset:5280
    ds_read_b64_tr_b16 v[142:143], v52 offset:5280
    v_cos_f32 v58, v101
    s_waitcnt lgkmcnt(4)
    v_mfma_f32_32x32x16_bf16 v[64:79], v[128:131], v[132:135], v[64:79]
    ds_read_b64_tr_b16 v[144:145], v51 offset:7680
    ds_read_b64_tr_b16 v[148:149], v52 offset:7680
    ds_read_b64_tr_b16 v[146:147], v51 offset:8160
    ds_read_b64_tr_b16 v[150:151], v52 offset:8160
    v_sin_f32 v59, v101
    s_waitcnt lgkmcnt(4)
    v_mfma_f32_32x32x16_bf16 v[64:79], v[136:139], v[140:143], v[64:79]
    ds_read_b64_tr_b16 v[152:153], v51 offset:8640
    ds_read_b64_tr_b16 v[156:157], v52 offset:8640
    ds_read_b64_tr_b16 v[154:155], v51 offset:9120
    ds_read_b64_tr_b16 v[158:159], v52 offset:9120
    v_exp_f32 v96, v96
    s_waitcnt lgkmcnt(4)
    v_mfma_f32_32x32x16_bf16 v[80:95], v[144:147], v[148:151], 0
    ds_read_b64_tr_b16 v[160:161], v51 offset:11520
    ds_read_b64_tr_b16 v[164:165], v52 offset:11520
    ds_read_b64_tr_b16 v[162:163], v51 offset:12000
    ds_read_b64_tr_b16 v[166:167], v52 offset:12000
    v_exp_f32 v102, v102
    s_waitcnt lgkmcnt(4)
    v_mfma_f32_32x32x16_bf16 v[80:95], v[152:155], v[156:159], v[80:95]
    ds_read_b64_tr_b16 v[168:169], v51 offset:12480
    ds_read_b64_tr_b16 v[172:173], v52 offset:12480
    ds_read_b64_tr_b16 v[170:171], v51 offset:12960
    ds_read_b64_tr_b16 v[174:175], v52 offset:12960
    v_exp_f32 v103, v103
    s_waitcnt lgkmcnt(4)
    v_mfma_f32_32x32x16_bf16 v[80:95], v[160:163], v[164:167], v[80:95]
    v_mul_f32 v60, v11, v98
    v_mul_f32 v61, v11, v99
    v_mul_f32 v54, v96, v54
    v_mul_f32 v55, v96, v55
    v_mul_f32 v56, v102, v56
    s_waitcnt lgkmcnt(0)
    v_mfma_f32_32x32x16_bf16 v[80:95], v[168:171], v[172:175], v[80:95]
    v_mul_f32 v57, v102, v57
    v_mul_f32 v58, v103, v58
    v_mul_f32_e64 v59, v103, v59
    global_load_dword v63, v62, s[78:79]
    v_pk_mul_f32 v[120:121], v[56:57], v[56:57] op_sel:[0,0] op_sel_hi:[0,1]
    v_pk_mul_f32 v[140:141], v[60:61], v[54:55] op_sel:[0,0] op_sel_hi:[0,1]
    v_pk_fma_f32 v[120:121], v[56:57], v[56:57], v[120:121] op_sel:[1,1,0] op_sel_hi:[1,0,1] neg_lo:[1,0,0]
    v_pk_mul_f32 v[154:155], v[60:61], v[58:59] op_sel:[0,0] op_sel_hi:[0,1]
    v_cvt_pk_bf16_f32 v124, 1.0, v56
    v_cvt_pk_bf16_f32 v132, 0, v57
    v_pk_fma_f32 v[140:141], v[60:61], v[54:55], v[140:141] op_sel:[1,1,0] op_sel_hi:[1,0,1] neg_lo:[1,0,0]
    v_pk_mul_f32 v[118:119], v[56:57], v[120:121] op_sel:[0,0] op_sel_hi:[0,1]
    v_pk_fma_f32 v[154:155], v[60:61], v[58:59], v[154:155] op_sel:[1,1,0] op_sel_hi:[1,0,1] neg_lo:[1,0,0]
    v_pk_fma_f32 v[118:119], v[56:57], v[120:121], v[118:119] op_sel:[1,1,0] op_sel_hi:[1,0,1] neg_lo:[1,0,0]
    v_cvt_pk_bf16_f32 v125, v120, v118
    v_cvt_pk_bf16_f32 v180, v60, v140
    v_cvt_pk_bf16_f32 v133, v121, v119
    v_cvt_pk_bf16_f32 v192, v61, v141
    v_pk_mul_f32 v[112:113], v[120:121], v[120:121] op_sel:[0,0] op_sel_hi:[0,1]
    v_pk_mul_f32 v[116:117], v[118:119], v[120:121] op_sel:[0,0] op_sel_hi:[0,1]
    v_pk_mul_f32 v[142:143], v[140:141], v[54:55] op_sel:[0,0] op_sel_hi:[0,1]
    v_pk_fma_f32 v[112:113], v[120:121], v[120:121], v[112:113] op_sel:[1,1,0] op_sel_hi:[1,0,1] neg_lo:[1,0,0]
    v_pk_mul_f32 v[162:163], v[154:155], v[58:59] op_sel:[0,0] op_sel_hi:[0,1]
    v_pk_fma_f32 v[116:117], v[118:119], v[120:121], v[116:117] op_sel:[1,1,0] op_sel_hi:[1,0,1] neg_lo:[1,0,0]
    v_cvt_pk_bf16_f32 v126, v112, v116
    v_pk_fma_f32 v[142:143], v[140:141], v[54:55], v[142:143] op_sel:[1,1,0] op_sel_hi:[1,0,1] neg_lo:[1,0,0]
    v_cvt_pk_bf16_f32 v134, v113, v117
    v_pk_fma_f32 v[162:163], v[154:155], v[58:59], v[162:163] op_sel:[1,1,0] op_sel_hi:[1,0,1] neg_lo:[1,0,0]
    v_pk_mul_f32 v[114:115], v[112:113], v[120:121] op_sel:[0,0] op_sel_hi:[0,1]
    v_pk_mul_f32 v[144:145], v[142:143], v[54:55] op_sel:[0,0] op_sel_hi:[0,1]
    v_pk_mul_f32 v[118:119], v[116:117], v[120:121] op_sel:[0,0] op_sel_hi:[0,1]
    v_pk_fma_f32 v[114:115], v[112:113], v[120:121], v[114:115] op_sel:[1,1,0] op_sel_hi:[1,0,1] neg_lo:[1,0,0]
    v_pk_mul_f32 v[166:167], v[162:163], v[58:59] op_sel:[0,0] op_sel_hi:[0,1]
    v_pk_fma_f32 v[118:119], v[116:117], v[120:121], v[118:119] op_sel:[1,1,0] op_sel_hi:[1,0,1] neg_lo:[1,0,0]
    v_pk_fma_f32 v[144:145], v[142:143], v[54:55], v[144:145] op_sel:[1,1,0] op_sel_hi:[1,0,1] neg_lo:[1,0,0]
    v_cvt_pk_bf16_f32 v127, v114, v118
    v_cvt_pk_bf16_f32 v135, v115, v119
    v_pk_fma_f32 v[166:167], v[162:163], v[58:59], v[166:167] op_sel:[1,1,0] op_sel_hi:[1,0,1] neg_lo:[1,0,0]
    v_cvt_pk_bf16_f32 v181, v142, v144
    ds_write_b128 v50, v[124:127] offset:0
    ds_write_b128 v50, v[132:135] offset:64
    v_pk_mul_f32 v[112:113], v[114:115], v[120:121] op_sel:[0,0] op_sel_hi:[0,1]
    v_cvt_pk_bf16_f32 v193, v143, v145
    v_pk_mul_f32 v[116:117], v[118:119], v[120:121] op_sel:[0,0] op_sel_hi:[0,1]
    v_pk_mul_f32 v[146:147], v[144:145], v[54:55] op_sel:[0,0] op_sel_hi:[0,1]
    v_pk_fma_f32 v[112:113], v[114:115], v[120:121], v[112:113] op_sel:[1,1,0] op_sel_hi:[1,0,1] neg_lo:[1,0,0]
    v_pk_fma_f32 v[116:117], v[118:119], v[120:121], v[116:117] op_sel:[1,1,0] op_sel_hi:[1,0,1] neg_lo:[1,0,0]
    v_pk_mul_f32 v[170:171], v[166:167], v[58:59] op_sel:[0,0] op_sel_hi:[0,1]
    v_cvt_pk_bf16_f32 v128, v112, v116
    v_pk_fma_f32 v[146:147], v[144:145], v[54:55], v[146:147] op_sel:[1,1,0] op_sel_hi:[1,0,1] neg_lo:[1,0,0]
    v_cvt_pk_bf16_f32 v136, v113, v117
    v_pk_mul_f32 v[114:115], v[112:113], v[120:121] op_sel:[0,0] op_sel_hi:[0,1]
    v_pk_fma_f32 v[170:171], v[166:167], v[58:59], v[170:171] op_sel:[1,1,0] op_sel_hi:[1,0,1] neg_lo:[1,0,0]
    v_pk_mul_f32 v[118:119], v[116:117], v[120:121] op_sel:[0,0] op_sel_hi:[0,1]
    v_pk_mul_f32 v[148:149], v[146:147], v[54:55] op_sel:[0,0] op_sel_hi:[0,1]
    v_pk_fma_f32 v[114:115], v[112:113], v[120:121], v[114:115] op_sel:[1,1,0] op_sel_hi:[1,0,1] neg_lo:[1,0,0]
    v_pk_fma_f32 v[118:119], v[116:117], v[120:121], v[118:119] op_sel:[1,1,0] op_sel_hi:[1,0,1] neg_lo:[1,0,0]
    v_pk_mul_f32 v[172:173], v[170:171], v[58:59] op_sel:[0,0] op_sel_hi:[0,1]
    v_cvt_pk_bf16_f32 v129, v114, v118
    v_pk_fma_f32 v[148:149], v[146:147], v[54:55], v[148:149] op_sel:[1,1,0] op_sel_hi:[1,0,1] neg_lo:[1,0,0]
    v_cvt_pk_bf16_f32 v137, v115, v119
    v_pk_mul_f32 v[112:113], v[114:115], v[120:121] op_sel:[0,0] op_sel_hi:[0,1]
    v_pk_fma_f32 v[172:173], v[170:171], v[58:59], v[172:173] op_sel:[1,1,0] op_sel_hi:[1,0,1] neg_lo:[1,0,0]
    v_pk_mul_f32 v[116:117], v[118:119], v[120:121] op_sel:[0,0] op_sel_hi:[0,1]
    v_cvt_pk_bf16_f32 v182, v146, v148
    v_pk_fma_f32 v[112:113], v[114:115], v[120:121], v[112:113] op_sel:[1,1,0] op_sel_hi:[1,0,1] neg_lo:[1,0,0]
    v_pk_fma_f32 v[116:117], v[118:119], v[120:121], v[116:117] op_sel:[1,1,0] op_sel_hi:[1,0,1] neg_lo:[1,0,0]
    v_cvt_pk_bf16_f32 v194, v147, v149
    v_cvt_pk_bf16_f32 v130, v112, v116
    v_cvt_pk_bf16_f32 v188, v170, v172
    v_cvt_pk_bf16_f32 v138, v113, v117
    v_cvt_pk_bf16_f32 v200, v171, v173
    v_pk_mul_f32 v[114:115], v[112:113], v[120:121] op_sel:[0,0] op_sel_hi:[0,1]
    v_pk_mul_f32 v[118:119], v[116:117], v[120:121] op_sel:[0,0] op_sel_hi:[0,1]
    v_pk_mul_f32 v[150:151], v[148:149], v[54:55] op_sel:[0,0] op_sel_hi:[0,1]
    v_pk_fma_f32 v[114:115], v[112:113], v[120:121], v[114:115] op_sel:[1,1,0] op_sel_hi:[1,0,1] neg_lo:[1,0,0]
    v_pk_mul_f32 v[174:175], v[172:173], v[58:59] op_sel:[0,0] op_sel_hi:[0,1]
    v_pk_fma_f32 v[118:119], v[116:117], v[120:121], v[118:119] op_sel:[1,1,0] op_sel_hi:[1,0,1] neg_lo:[1,0,0]
    v_cvt_pk_bf16_f32 v131, v114, v118
    v_pk_fma_f32 v[150:151], v[148:149], v[54:55], v[150:151] op_sel:[1,1,0] op_sel_hi:[1,0,1] neg_lo:[1,0,0]
    v_cvt_pk_bf16_f32 v139, v115, v119
    v_pk_fma_f32 v[174:175], v[172:173], v[58:59], v[174:175] op_sel:[1,1,0] op_sel_hi:[1,0,1] neg_lo:[1,0,0]
    ds_write_b128 v50, v[128:131] offset:16
    ds_write_b128 v50, v[136:139] offset:80
    v_pk_mul_f32 v[152:153], v[150:151], v[54:55] op_sel:[0,0] op_sel_hi:[0,1]
    v_pk_mul_f32 v[112:113], v[114:115], v[120:121] op_sel:[0,0] op_sel_hi:[0,1]
    v_pk_mul_f32 v[176:177], v[174:175], v[58:59] op_sel:[0,0] op_sel_hi:[0,1]
    v_pk_mul_f32 v[116:117], v[118:119], v[120:121] op_sel:[0,0] op_sel_hi:[0,1]
    v_pk_fma_f32 v[112:113], v[114:115], v[120:121], v[112:113] op_sel:[1,1,0] op_sel_hi:[1,0,1] neg_lo:[1,0,0]
    v_pk_fma_f32 v[152:153], v[150:151], v[54:55], v[152:153] op_sel:[1,1,0] op_sel_hi:[1,0,1] neg_lo:[1,0,0]
    v_pk_fma_f32 v[116:117], v[118:119], v[120:121], v[116:117] op_sel:[1,1,0] op_sel_hi:[1,0,1] neg_lo:[1,0,0]
    v_pk_fma_f32 v[176:177], v[174:175], v[58:59], v[176:177] op_sel:[1,1,0] op_sel_hi:[1,0,1] neg_lo:[1,0,0]
    v_cvt_pk_bf16_f32 v124, v112, v116
    v_cvt_pk_bf16_f32 v132, v113, v117
    v_cvt_pk_bf16_f32 v183, v150, v152
    v_pk_mul_f32 v[114:115], v[112:113], v[120:121] op_sel:[0,0] op_sel_hi:[0,1]
    v_cvt_pk_bf16_f32 v195, v151, v153
    v_pk_mul_f32 v[118:119], v[116:117], v[120:121] op_sel:[0,0] op_sel_hi:[0,1]
    v_pk_fma_f32 v[114:115], v[112:113], v[120:121], v[114:115] op_sel:[1,1,0] op_sel_hi:[1,0,1] neg_lo:[1,0,0]
    v_pk_fma_f32 v[118:119], v[116:117], v[120:121], v[118:119] op_sel:[1,1,0] op_sel_hi:[1,0,1] neg_lo:[1,0,0]
    ds_write_b128 v50, v[180:183] offset:128
    ds_write_b128 v50, v[192:195] offset:176
    v_cvt_pk_bf16_f32 v125, v114, v118
    v_cvt_pk_bf16_f32 v133, v115, v119
    v_cvt_pk_bf16_f32 v190, v174, v176
    v_pk_mul_f32 v[112:113], v[114:115], v[120:121] op_sel:[0,0] op_sel_hi:[0,1]
    v_cvt_pk_bf16_f32 v202, v175, v177
    v_pk_mul_f32 v[116:117], v[118:119], v[120:121] op_sel:[0,0] op_sel_hi:[0,1]
    v_pk_fma_f32 v[112:113], v[114:115], v[120:121], v[112:113] op_sel:[1,1,0] op_sel_hi:[1,0,1] neg_lo:[1,0,0]
    v_pk_mul_f32 v[156:157], v[142:143], v[58:59] op_sel:[0,0] op_sel_hi:[0,1]
    v_pk_fma_f32 v[116:117], v[118:119], v[120:121], v[116:117] op_sel:[1,1,0] op_sel_hi:[1,0,1] neg_lo:[1,0,0]
    v_pk_mul_f32 v[178:179], v[176:177], v[58:59] op_sel:[0,0] op_sel_hi:[0,1]
    v_cvt_pk_bf16_f32 v126, v112, v116
    v_pk_fma_f32 v[156:157], v[142:143], v[58:59], v[156:157] op_sel:[1,1,0] op_sel_hi:[1,0,1] neg_lo:[1,0,0]
    v_cvt_pk_bf16_f32 v134, v113, v117
    v_pk_mul_f32 v[114:115], v[112:113], v[120:121] op_sel:[0,0] op_sel_hi:[0,1]
    v_pk_fma_f32 v[178:179], v[176:177], v[58:59], v[178:179] op_sel:[1,1,0] op_sel_hi:[1,0,1] neg_lo:[1,0,0]
    v_pk_mul_f32 v[118:119], v[116:117], v[120:121] op_sel:[0,0] op_sel_hi:[0,1]
    v_cvt_pk_bf16_f32 v184, v154, v156
    v_pk_fma_f32 v[114:115], v[112:113], v[120:121], v[114:115] op_sel:[1,1,0] op_sel_hi:[1,0,1] neg_lo:[1,0,0]
    v_pk_fma_f32 v[118:119], v[116:117], v[120:121], v[118:119] op_sel:[1,1,0] op_sel_hi:[1,0,1] neg_lo:[1,0,0]
    v_cvt_pk_bf16_f32 v196, v155, v157
    v_cvt_pk_bf16_f32 v127, v114, v118
    v_cvt_pk_bf16_f32 v189, v178, v178
    v_cvt_pk_bf16_f32 v135, v115, v119
    v_cvt_pk_bf16_f32 v201, v179, v179
    ds_write_b128 v50, v[124:127] offset:32
    ds_write_b128 v50, v[132:135] offset:96
    v_pk_mul_f32 v[112:113], v[114:115], v[120:121] op_sel:[0,0] op_sel_hi:[0,1]
    v_pk_mul_f32 v[116:117], v[118:119], v[120:121] op_sel:[0,0] op_sel_hi:[0,1]
    ds_write_b128 v50, v[188:191] offset:160
    ds_write_b128 v50, v[200:203] offset:208
    v_pk_fma_f32 v[112:113], v[114:115], v[120:121], v[112:113] op_sel:[1,1,0] op_sel_hi:[1,0,1] neg_lo:[1,0,0]
    v_pk_mul_f32 v[158:159], v[146:147], v[58:59] op_sel:[0,0] op_sel_hi:[0,1]
    v_pk_fma_f32 v[116:117], v[118:119], v[120:121], v[116:117] op_sel:[1,1,0] op_sel_hi:[1,0,1] neg_lo:[1,0,0]
    v_cvt_pk_bf16_f32 v128, v112, v116
    v_pk_fma_f32 v[158:159], v[146:147], v[58:59], v[158:159] op_sel:[1,1,0] op_sel_hi:[1,0,1] neg_lo:[1,0,0]
    v_cvt_pk_bf16_f32 v136, v113, v117
    v_pk_mul_f32 v[160:161], v[150:151], v[58:59] op_sel:[0,0] op_sel_hi:[0,1]
    v_pk_mul_f32 v[114:115], v[112:113], v[120:121] op_sel:[0,0] op_sel_hi:[0,1]
    v_pk_mul_f32 v[118:119], v[116:117], v[120:121] op_sel:[0,0] op_sel_hi:[0,1]
    v_pk_fma_f32 v[160:161], v[150:151], v[58:59], v[160:161] op_sel:[1,1,0] op_sel_hi:[1,0,1] neg_lo:[1,0,0]
    v_pk_fma_f32 v[114:115], v[112:113], v[120:121], v[114:115] op_sel:[1,1,0] op_sel_hi:[1,0,1] neg_lo:[1,0,0]
    v_cvt_pk_bf16_f32 v186, v158, v160
    v_pk_fma_f32 v[118:119], v[116:117], v[120:121], v[118:119] op_sel:[1,1,0] op_sel_hi:[1,0,1] neg_lo:[1,0,0]
    v_cvt_pk_bf16_f32 v129, v114, v118
    v_cvt_pk_bf16_f32 v198, v159, v161
    v_cvt_pk_bf16_f32 v137, v115, v119
    v_pk_mul_f32 v[164:165], v[158:159], v[58:59] op_sel:[0,0] op_sel_hi:[0,1]
    v_pk_mul_f32 v[112:113], v[114:115], v[120:121] op_sel:[0,0] op_sel_hi:[0,1]
    v_pk_mul_f32 v[116:117], v[118:119], v[120:121] op_sel:[0,0] op_sel_hi:[0,1]
    v_pk_fma_f32 v[164:165], v[158:159], v[58:59], v[164:165] op_sel:[1,1,0] op_sel_hi:[1,0,1] neg_lo:[1,0,0]
    v_pk_fma_f32 v[112:113], v[114:115], v[120:121], v[112:113] op_sel:[1,1,0] op_sel_hi:[1,0,1] neg_lo:[1,0,0]
    v_cvt_pk_bf16_f32 v185, v162, v164
    v_pk_fma_f32 v[116:117], v[118:119], v[120:121], v[116:117] op_sel:[1,1,0] op_sel_hi:[1,0,1] neg_lo:[1,0,0]
    v_cvt_pk_bf16_f32 v197, v163, v165
    v_cvt_pk_bf16_f32 v130, v112, v116
    v_cvt_pk_bf16_f32 v138, v113, v117
    v_pk_mul_f32 v[168:169], v[164:165], v[58:59] op_sel:[0,0] op_sel_hi:[0,1]
    v_pk_mul_f32 v[114:115], v[112:113], v[120:121] op_sel:[0,0] op_sel_hi:[0,1]
    v_pk_fma_f32 v[168:169], v[164:165], v[58:59], v[168:169] op_sel:[1,1,0] op_sel_hi:[1,0,1] neg_lo:[1,0,0]
    v_pk_mul_f32 v[118:119], v[116:117], v[120:121] op_sel:[0,0] op_sel_hi:[0,1]
    v_pk_fma_f32 v[114:115], v[112:113], v[120:121], v[114:115] op_sel:[1,1,0] op_sel_hi:[1,0,1] neg_lo:[1,0,0]
    v_cvt_pk_bf16_f32 v187, v166, v168
    v_pk_fma_f32 v[118:119], v[116:117], v[120:121], v[118:119] op_sel:[1,1,0] op_sel_hi:[1,0,1] neg_lo:[1,0,0]
    v_cvt_pk_bf16_f32 v199, v167, v169
    v_cvt_pk_bf16_f32 v131, v114, v118
    v_cvt_pk_bf16_f32 v139, v115, v119
    ds_write_b128 v50, v[184:187] offset:144
    ds_write_b128 v50, v[128:131] offset:48
    ds_write_b128 v50, v[196:199] offset:192
    ds_write_b128 v50, v[136:139] offset:112
    v_lshlrev_b32 v96, 16, v9
    v_lshlrev_b32 v97, 16, v13
    v_lshlrev_b32 v98, 16, v17
    v_lshlrev_b32 v99, 16, v21
    v_mul_f32 v96, 0x3fb8aa3b, v96
    v_mul_f32 v97, v7, v97
    v_exp_f32 v96, v96
    v_mul_f32 v100, 0xc1000000, v97
    v_mul_f32 v101, 0x43800000, v97
    v_cvt_pk_bf16_f32 v96, v96, v96
    v_fract_f32 v97, v97
    v_fract_f32 v100, v100
    v_fract_f32_e64 v101, v101
    ds_read_b64_tr_b16 v[112:113], v51 offset:0
    ds_read_b64_tr_b16 v[116:117], v52 offset:0
    ds_read_b64_tr_b16 v[114:115], v51 offset:480
    ds_read_b64_tr_b16 v[118:119], v52 offset:480
    ds_read_b64_tr_b16 v[120:121], v51 offset:960
    ds_read_b64_tr_b16 v[124:125], v52 offset:960
    ds_read_b64_tr_b16 v[122:123], v51 offset:1440
    ds_read_b64_tr_b16 v[126:127], v52 offset:1440
    v_and_b32 v96, 0xffff0000, v96
    v_mul_f32 v96, v6, v96
    v_cos_f32 v54, v97
    v_sin_f32_e64 v55, v97
    v_mul_f32 v102, 0x41000000, v96
    v_mul_f32 v103, 0x43800000, v96
    v_cos_f32 v56, v100
    s_waitcnt lgkmcnt(4)
    v_mfma_f32_32x32x16_bf16 v[64:79], v[112:115], v[116:119], v[64:79]
    ds_read_b64_tr_b16 v[128:129], v51 offset:3840
    ds_read_b64_tr_b16 v[132:133], v52 offset:3840
    ds_read_b64_tr_b16 v[130:131], v51 offset:4320
    ds_read_b64_tr_b16 v[134:135], v52 offset:4320
    v_sin_f32 v57, v100
    s_waitcnt lgkmcnt(4)
    v_mfma_f32_32x32x16_bf16 v[64:79], v[120:123], v[124:127], v[64:79]
    ds_read_b64_tr_b16 v[136:137], v51 offset:4800
    ds_read_b64_tr_b16 v[140:141], v52 offset:4800
    ds_read_b64_tr_b16 v[138:139], v51 offset:5280
    ds_read_b64_tr_b16 v[142:143], v52 offset:5280
    v_cos_f32 v58, v101
    s_waitcnt lgkmcnt(4)
    v_mfma_f32_32x32x16_bf16 v[64:79], v[128:131], v[132:135], v[64:79]
    ds_read_b64_tr_b16 v[144:145], v51 offset:7680
    ds_read_b64_tr_b16 v[148:149], v52 offset:7680
    ds_read_b64_tr_b16 v[146:147], v51 offset:8160
    ds_read_b64_tr_b16 v[150:151], v52 offset:8160
    v_sin_f32 v59, v101
    s_waitcnt lgkmcnt(4)
    v_mfma_f32_32x32x16_bf16 v[64:79], v[136:139], v[140:143], v[64:79]
    ds_read_b64_tr_b16 v[152:153], v51 offset:8640
    ds_read_b64_tr_b16 v[156:157], v52 offset:8640
    ds_read_b64_tr_b16 v[154:155], v51 offset:9120
    ds_read_b64_tr_b16 v[158:159], v52 offset:9120
    v_exp_f32 v96, v96
    s_waitcnt lgkmcnt(4)
    v_mfma_f32_32x32x16_bf16 v[80:95], v[144:147], v[148:151], v[80:95]
    ds_read_b64_tr_b16 v[160:161], v51 offset:11520
    ds_read_b64_tr_b16 v[164:165], v52 offset:11520
    ds_read_b64_tr_b16 v[162:163], v51 offset:12000
    ds_read_b64_tr_b16 v[166:167], v52 offset:12000
    v_exp_f32 v102, v102
    s_waitcnt lgkmcnt(4)
    v_mfma_f32_32x32x16_bf16 v[80:95], v[152:155], v[156:159], v[80:95]
    ds_read_b64_tr_b16 v[168:169], v51 offset:12480
    ds_read_b64_tr_b16 v[172:173], v52 offset:12480
    ds_read_b64_tr_b16 v[170:171], v51 offset:12960
    ds_read_b64_tr_b16 v[174:175], v52 offset:12960
    v_exp_f32 v103, v103
    s_waitcnt lgkmcnt(4)
    v_mfma_f32_32x32x16_bf16 v[80:95], v[160:163], v[164:167], v[80:95]
    v_mul_f32 v60, v11, v98
    v_mul_f32 v61, v11, v99
    v_mul_f32 v54, v96, v54
    v_mul_f32 v55, v96, v55
    v_mul_f32 v56, v102, v56
    s_waitcnt lgkmcnt(0)
    v_mfma_f32_32x32x16_bf16 v[80:95], v[168:171], v[172:175], v[80:95]
    v_mul_f32 v57, v102, v57
    v_mul_f32 v58, v103, v58
    v_mul_f32_e64 v59, v103, v59
    global_load_dwordx4 v[204:207], v4, s[72:73] offset:-4096
    global_load_dwordx4 v[208:211], v4, s[72:73] offset:-3072
    global_load_dwordx4 v[212:215], v4, s[72:73] offset:-2048
    global_load_dwordx4 v[216:219], v4, s[72:73] offset:-1024
    global_load_dwordx4 v[220:223], v4, s[72:73] offset:0
    global_load_dwordx4 v[224:227], v4, s[72:73] offset:1024
    global_load_dwordx4 v[228:231], v4, s[72:73] offset:2048
    global_load_dwordx4 v[232:235], v4, s[72:73] offset:3072
    v_pk_mul_f32 v[120:121], v[56:57], v[56:57] op_sel:[0,0] op_sel_hi:[0,1]
    v_pk_mul_f32 v[140:141], v[60:61], v[54:55] op_sel:[0,0] op_sel_hi:[0,1]
    v_pk_fma_f32 v[120:121], v[56:57], v[56:57], v[120:121] op_sel:[1,1,0] op_sel_hi:[1,0,1] neg_lo:[1,0,0]
    v_pk_mul_f32 v[154:155], v[60:61], v[58:59] op_sel:[0,0] op_sel_hi:[0,1]
    v_cvt_pk_bf16_f32 v124, 1.0, v56
    v_cvt_pk_bf16_f32 v132, 0, v57
    v_pk_fma_f32 v[140:141], v[60:61], v[54:55], v[140:141] op_sel:[1,1,0] op_sel_hi:[1,0,1] neg_lo:[1,0,0]
    v_pk_mul_f32 v[118:119], v[56:57], v[120:121] op_sel:[0,0] op_sel_hi:[0,1]
    v_pk_fma_f32 v[154:155], v[60:61], v[58:59], v[154:155] op_sel:[1,1,0] op_sel_hi:[1,0,1] neg_lo:[1,0,0]
    v_pk_fma_f32 v[118:119], v[56:57], v[120:121], v[118:119] op_sel:[1,1,0] op_sel_hi:[1,0,1] neg_lo:[1,0,0]
    v_cvt_pk_bf16_f32 v125, v120, v118
    v_cvt_pk_bf16_f32 v180, v60, v140
    v_cvt_pk_bf16_f32 v133, v121, v119
    v_cvt_pk_bf16_f32 v192, v61, v141
    v_pk_mul_f32 v[112:113], v[120:121], v[120:121] op_sel:[0,0] op_sel_hi:[0,1]
    v_pk_mul_f32 v[116:117], v[118:119], v[120:121] op_sel:[0,0] op_sel_hi:[0,1]
    v_pk_mul_f32 v[142:143], v[140:141], v[54:55] op_sel:[0,0] op_sel_hi:[0,1]
    v_pk_fma_f32 v[112:113], v[120:121], v[120:121], v[112:113] op_sel:[1,1,0] op_sel_hi:[1,0,1] neg_lo:[1,0,0]
    v_pk_mul_f32 v[162:163], v[154:155], v[58:59] op_sel:[0,0] op_sel_hi:[0,1]
    v_pk_fma_f32 v[116:117], v[118:119], v[120:121], v[116:117] op_sel:[1,1,0] op_sel_hi:[1,0,1] neg_lo:[1,0,0]
    v_cvt_pk_bf16_f32 v126, v112, v116
    v_pk_fma_f32 v[142:143], v[140:141], v[54:55], v[142:143] op_sel:[1,1,0] op_sel_hi:[1,0,1] neg_lo:[1,0,0]
    v_cvt_pk_bf16_f32 v134, v113, v117
    v_pk_fma_f32 v[162:163], v[154:155], v[58:59], v[162:163] op_sel:[1,1,0] op_sel_hi:[1,0,1] neg_lo:[1,0,0]
    v_pk_mul_f32 v[114:115], v[112:113], v[120:121] op_sel:[0,0] op_sel_hi:[0,1]
    v_pk_mul_f32 v[144:145], v[142:143], v[54:55] op_sel:[0,0] op_sel_hi:[0,1]
    v_pk_mul_f32 v[118:119], v[116:117], v[120:121] op_sel:[0,0] op_sel_hi:[0,1]
    v_pk_fma_f32 v[114:115], v[112:113], v[120:121], v[114:115] op_sel:[1,1,0] op_sel_hi:[1,0,1] neg_lo:[1,0,0]
    v_pk_mul_f32 v[166:167], v[162:163], v[58:59] op_sel:[0,0] op_sel_hi:[0,1]
    v_pk_fma_f32 v[118:119], v[116:117], v[120:121], v[118:119] op_sel:[1,1,0] op_sel_hi:[1,0,1] neg_lo:[1,0,0]
    v_pk_fma_f32 v[144:145], v[142:143], v[54:55], v[144:145] op_sel:[1,1,0] op_sel_hi:[1,0,1] neg_lo:[1,0,0]
    v_cvt_pk_bf16_f32 v127, v114, v118
    v_cvt_pk_bf16_f32 v135, v115, v119
    v_pk_fma_f32 v[166:167], v[162:163], v[58:59], v[166:167] op_sel:[1,1,0] op_sel_hi:[1,0,1] neg_lo:[1,0,0]
    v_cvt_pk_bf16_f32 v181, v142, v144
    ds_write_b128 v50, v[124:127] offset:0
    ds_write_b128 v50, v[132:135] offset:64
    v_pk_mul_f32 v[112:113], v[114:115], v[120:121] op_sel:[0,0] op_sel_hi:[0,1]
    v_cvt_pk_bf16_f32 v193, v143, v145
    v_pk_mul_f32 v[116:117], v[118:119], v[120:121] op_sel:[0,0] op_sel_hi:[0,1]
    v_pk_mul_f32 v[146:147], v[144:145], v[54:55] op_sel:[0,0] op_sel_hi:[0,1]
    v_pk_fma_f32 v[112:113], v[114:115], v[120:121], v[112:113] op_sel:[1,1,0] op_sel_hi:[1,0,1] neg_lo:[1,0,0]
    v_pk_fma_f32 v[116:117], v[118:119], v[120:121], v[116:117] op_sel:[1,1,0] op_sel_hi:[1,0,1] neg_lo:[1,0,0]
    v_pk_mul_f32 v[170:171], v[166:167], v[58:59] op_sel:[0,0] op_sel_hi:[0,1]
    v_cvt_pk_bf16_f32 v128, v112, v116
    v_pk_fma_f32 v[146:147], v[144:145], v[54:55], v[146:147] op_sel:[1,1,0] op_sel_hi:[1,0,1] neg_lo:[1,0,0]
    v_cvt_pk_bf16_f32 v136, v113, v117
    v_pk_mul_f32 v[114:115], v[112:113], v[120:121] op_sel:[0,0] op_sel_hi:[0,1]
WB_P1:
    s_cbranch_execz WB_P5
    s_nop 0
    v_pk_fma_f32 v[170:171], v[166:167], v[58:59], v[170:171] op_sel:[1,1,0] op_sel_hi:[1,0,1] neg_lo:[1,0,0]
    v_pk_mul_f32 v[118:119], v[116:117], v[120:121] op_sel:[0,0] op_sel_hi:[0,1]
    v_pk_mul_f32 v[148:149], v[146:147], v[54:55] op_sel:[0,0] op_sel_hi:[0,1]
    v_pk_fma_f32 v[114:115], v[112:113], v[120:121], v[114:115] op_sel:[1,1,0] op_sel_hi:[1,0,1] neg_lo:[1,0,0]
    v_pk_fma_f32 v[118:119], v[116:117], v[120:121], v[118:119] op_sel:[1,1,0] op_sel_hi:[1,0,1] neg_lo:[1,0,0]
    v_pk_mul_f32 v[172:173], v[170:171], v[58:59] op_sel:[0,0] op_sel_hi:[0,1]
    v_cvt_pk_bf16_f32 v129, v114, v118
    v_pk_fma_f32 v[148:149], v[146:147], v[54:55], v[148:149] op_sel:[1,1,0] op_sel_hi:[1,0,1] neg_lo:[1,0,0]
    v_cvt_pk_bf16_f32 v137, v115, v119
    v_pk_mul_f32 v[112:113], v[114:115], v[120:121] op_sel:[0,0] op_sel_hi:[0,1]
    v_pk_fma_f32 v[172:173], v[170:171], v[58:59], v[172:173] op_sel:[1,1,0] op_sel_hi:[1,0,1] neg_lo:[1,0,0]
    v_pk_mul_f32 v[116:117], v[118:119], v[120:121] op_sel:[0,0] op_sel_hi:[0,1]
    v_cvt_pk_bf16_f32 v182, v146, v148
    v_pk_fma_f32 v[112:113], v[114:115], v[120:121], v[112:113] op_sel:[1,1,0] op_sel_hi:[1,0,1] neg_lo:[1,0,0]
    v_pk_fma_f32 v[116:117], v[118:119], v[120:121], v[116:117] op_sel:[1,1,0] op_sel_hi:[1,0,1] neg_lo:[1,0,0]
    v_cvt_pk_bf16_f32 v194, v147, v149
    v_cvt_pk_bf16_f32 v130, v112, v116
    v_cvt_pk_bf16_f32 v188, v170, v172
    v_cvt_pk_bf16_f32 v138, v113, v117
    v_cvt_pk_bf16_f32 v200, v171, v173
    v_pk_mul_f32 v[114:115], v[112:113], v[120:121] op_sel:[0,0] op_sel_hi:[0,1]
    v_pk_mul_f32 v[118:119], v[116:117], v[120:121] op_sel:[0,0] op_sel_hi:[0,1]
    v_pk_mul_f32 v[150:151], v[148:149], v[54:55] op_sel:[0,0] op_sel_hi:[0,1]
    v_pk_fma_f32 v[114:115], v[112:113], v[120:121], v[114:115] op_sel:[1,1,0] op_sel_hi:[1,0,1] neg_lo:[1,0,0]
    v_pk_mul_f32 v[174:175], v[172:173], v[58:59] op_sel:[0,0] op_sel_hi:[0,1]
    v_pk_fma_f32 v[118:119], v[116:117], v[120:121], v[118:119] op_sel:[1,1,0] op_sel_hi:[1,0,1] neg_lo:[1,0,0]
    v_cvt_pk_bf16_f32 v131, v114, v118
    v_pk_fma_f32 v[150:151], v[148:149], v[54:55], v[150:151] op_sel:[1,1,0] op_sel_hi:[1,0,1] neg_lo:[1,0,0]
    v_cvt_pk_bf16_f32 v139, v115, v119
    v_pk_fma_f32 v[174:175], v[172:173], v[58:59], v[174:175] op_sel:[1,1,0] op_sel_hi:[1,0,1] neg_lo:[1,0,0]
    ds_write_b128 v50, v[128:131] offset:16
    ds_write_b128 v50, v[136:139] offset:80
    v_pk_mul_f32 v[152:153], v[150:151], v[54:55] op_sel:[0,0] op_sel_hi:[0,1]
    v_pk_mul_f32 v[112:113], v[114:115], v[120:121] op_sel:[0,0] op_sel_hi:[0,1]
    v_pk_mul_f32 v[176:177], v[174:175], v[58:59] op_sel:[0,0] op_sel_hi:[0,1]
    v_pk_mul_f32 v[116:117], v[118:119], v[120:121] op_sel:[0,0] op_sel_hi:[0,1]
    v_pk_fma_f32 v[112:113], v[114:115], v[120:121], v[112:113] op_sel:[1,1,0] op_sel_hi:[1,0,1] neg_lo:[1,0,0]
    v_pk_fma_f32 v[152:153], v[150:151], v[54:55], v[152:153] op_sel:[1,1,0] op_sel_hi:[1,0,1] neg_lo:[1,0,0]
    v_pk_fma_f32 v[116:117], v[118:119], v[120:121], v[116:117] op_sel:[1,1,0] op_sel_hi:[1,0,1] neg_lo:[1,0,0]
    v_pk_fma_f32 v[176:177], v[174:175], v[58:59], v[176:177] op_sel:[1,1,0] op_sel_hi:[1,0,1] neg_lo:[1,0,0]
    v_cvt_pk_bf16_f32 v124, v112, v116
    v_cvt_pk_bf16_f32 v132, v113, v117
    v_cvt_pk_bf16_f32 v183, v150, v152
    v_pk_mul_f32 v[114:115], v[112:113], v[120:121] op_sel:[0,0] op_sel_hi:[0,1]
    v_cvt_pk_bf16_f32 v195, v151, v153
    v_pk_mul_f32 v[118:119], v[116:117], v[120:121] op_sel:[0,0] op_sel_hi:[0,1]
    v_pk_fma_f32 v[114:115], v[112:113], v[120:121], v[114:115] op_sel:[1,1,0] op_sel_hi:[1,0,1] neg_lo:[1,0,0]
    v_pk_fma_f32 v[118:119], v[116:117], v[120:121], v[118:119] op_sel:[1,1,0] op_sel_hi:[1,0,1] neg_lo:[1,0,0]
    ds_write_b128 v50, v[180:183] offset:128
    ds_write_b128 v50, v[192:195] offset:176
    v_cvt_pk_bf16_f32 v125, v114, v118
    v_cvt_pk_bf16_f32 v133, v115, v119
    v_cvt_pk_bf16_f32 v190, v174, v176
    v_pk_mul_f32 v[112:113], v[114:115], v[120:121] op_sel:[0,0] op_sel_hi:[0,1]
    v_cvt_pk_bf16_f32 v202, v175, v177
    v_pk_mul_f32 v[116:117], v[118:119], v[120:121] op_sel:[0,0] op_sel_hi:[0,1]
    v_pk_fma_f32 v[112:113], v[114:115], v[120:121], v[112:113] op_sel:[1,1,0] op_sel_hi:[1,0,1] neg_lo:[1,0,0]
    v_pk_mul_f32 v[156:157], v[142:143], v[58:59] op_sel:[0,0] op_sel_hi:[0,1]
    v_pk_fma_f32 v[116:117], v[118:119], v[120:121], v[116:117] op_sel:[1,1,0] op_sel_hi:[1,0,1] neg_lo:[1,0,0]
    v_pk_mul_f32 v[178:179], v[176:177], v[58:59] op_sel:[0,0] op_sel_hi:[0,1]
    v_cvt_pk_bf16_f32 v126, v112, v116
    v_pk_fma_f32 v[156:157], v[142:143], v[58:59], v[156:157] op_sel:[1,1,0] op_sel_hi:[1,0,1] neg_lo:[1,0,0]
    v_cvt_pk_bf16_f32 v134, v113, v117
    v_pk_mul_f32 v[114:115], v[112:113], v[120:121] op_sel:[0,0] op_sel_hi:[0,1]
    v_pk_fma_f32 v[178:179], v[176:177], v[58:59], v[178:179] op_sel:[1,1,0] op_sel_hi:[1,0,1] neg_lo:[1,0,0]
    v_pk_mul_f32 v[118:119], v[116:117], v[120:121] op_sel:[0,0] op_sel_hi:[0,1]
    v_cvt_pk_bf16_f32 v184, v154, v156
    v_pk_fma_f32 v[114:115], v[112:113], v[120:121], v[114:115] op_sel:[1,1,0] op_sel_hi:[1,0,1] neg_lo:[1,0,0]
    v_pk_fma_f32 v[118:119], v[116:117], v[120:121], v[118:119] op_sel:[1,1,0] op_sel_hi:[1,0,1] neg_lo:[1,0,0]
    v_cvt_pk_bf16_f32 v196, v155, v157
    v_cvt_pk_bf16_f32 v127, v114, v118
    v_cvt_pk_bf16_f32 v189, v178, v178
    v_cvt_pk_bf16_f32 v135, v115, v119
    v_cvt_pk_bf16_f32 v201, v179, v179
    ds_write_b128 v50, v[124:127] offset:32
    ds_write_b128 v50, v[132:135] offset:96
    v_pk_mul_f32 v[112:113], v[114:115], v[120:121] op_sel:[0,0] op_sel_hi:[0,1]
    v_pk_mul_f32 v[116:117], v[118:119], v[120:121] op_sel:[0,0] op_sel_hi:[0,1]
    ds_write_b128 v50, v[188:191] offset:160
    ds_write_b128 v50, v[200:203] offset:208
    v_pk_fma_f32 v[112:113], v[114:115], v[120:121], v[112:113] op_sel:[1,1,0] op_sel_hi:[1,0,1] neg_lo:[1,0,0]
    v_pk_mul_f32 v[158:159], v[146:147], v[58:59] op_sel:[0,0] op_sel_hi:[0,1]
    v_pk_fma_f32 v[116:117], v[118:119], v[120:121], v[116:117] op_sel:[1,1,0] op_sel_hi:[1,0,1] neg_lo:[1,0,0]
    v_cvt_pk_bf16_f32 v128, v112, v116
    v_pk_fma_f32 v[158:159], v[146:147], v[58:59], v[158:159] op_sel:[1,1,0] op_sel_hi:[1,0,1] neg_lo:[1,0,0]
    v_cvt_pk_bf16_f32 v136, v113, v117
    v_pk_mul_f32 v[160:161], v[150:151], v[58:59] op_sel:[0,0] op_sel_hi:[0,1]
    v_pk_mul_f32 v[114:115], v[112:113], v[120:121] op_sel:[0,0] op_sel_hi:[0,1]
    v_pk_mul_f32 v[118:119], v[116:117], v[120:121] op_sel:[0,0] op_sel_hi:[0,1]
    v_pk_fma_f32 v[160:161], v[150:151], v[58:59], v[160:161] op_sel:[1,1,0] op_sel_hi:[1,0,1] neg_lo:[1,0,0]
    v_pk_fma_f32 v[114:115], v[112:113], v[120:121], v[114:115] op_sel:[1,1,0] op_sel_hi:[1,0,1] neg_lo:[1,0,0]
    v_cvt_pk_bf16_f32 v186, v158, v160
    v_pk_fma_f32 v[118:119], v[116:117], v[120:121], v[118:119] op_sel:[1,1,0] op_sel_hi:[1,0,1] neg_lo:[1,0,0]
    v_cvt_pk_bf16_f32 v129, v114, v118
    v_cvt_pk_bf16_f32 v198, v159, v161
    v_cvt_pk_bf16_f32 v137, v115, v119
    v_pk_mul_f32 v[164:165], v[158:159], v[58:59] op_sel:[0,0] op_sel_hi:[0,1]
    v_pk_mul_f32 v[112:113], v[114:115], v[120:121] op_sel:[0,0] op_sel_hi:[0,1]
    v_pk_mul_f32 v[116:117], v[118:119], v[120:121] op_sel:[0,0] op_sel_hi:[0,1]
    v_pk_fma_f32 v[164:165], v[158:159], v[58:59], v[164:165] op_sel:[1,1,0] op_sel_hi:[1,0,1] neg_lo:[1,0,0]
    v_pk_fma_f32 v[112:113], v[114:115], v[120:121], v[112:113] op_sel:[1,1,0] op_sel_hi:[1,0,1] neg_lo:[1,0,0]
    v_cvt_pk_bf16_f32 v185, v162, v164
    v_pk_fma_f32 v[116:117], v[118:119], v[120:121], v[116:117] op_sel:[1,1,0] op_sel_hi:[1,0,1] neg_lo:[1,0,0]
    v_cvt_pk_bf16_f32 v197, v163, v165
    v_cvt_pk_bf16_f32 v130, v112, v116
    v_cvt_pk_bf16_f32 v138, v113, v117
    v_pk_mul_f32 v[168:169], v[164:165], v[58:59] op_sel:[0,0] op_sel_hi:[0,1]
    v_pk_mul_f32 v[114:115], v[112:113], v[120:121] op_sel:[0,0] op_sel_hi:[0,1]
    v_pk_fma_f32 v[168:169], v[164:165], v[58:59], v[168:169] op_sel:[1,1,0] op_sel_hi:[1,0,1] neg_lo:[1,0,0]
    v_pk_mul_f32 v[118:119], v[116:117], v[120:121] op_sel:[0,0] op_sel_hi:[0,1]
    v_pk_fma_f32 v[114:115], v[112:113], v[120:121], v[114:115] op_sel:[1,1,0] op_sel_hi:[1,0,1] neg_lo:[1,0,0]
    v_cvt_pk_bf16_f32 v187, v166, v168
    v_pk_fma_f32 v[118:119], v[116:117], v[120:121], v[118:119] op_sel:[1,1,0] op_sel_hi:[1,0,1] neg_lo:[1,0,0]
    v_cvt_pk_bf16_f32 v199, v167, v169
    v_cvt_pk_bf16_f32 v131, v114, v118
    v_cvt_pk_bf16_f32 v139, v115, v119
    ds_write_b128 v50, v[184:187] offset:144
    ds_write_b128 v50, v[128:131] offset:48
    ds_write_b128 v50, v[196:199] offset:192
    ds_write_b128 v50, v[136:139] offset:112
    v_and_b32 v96, 0xffff0000, v9
    v_and_b32 v97, 0xffff0000, v13
    v_and_b32 v98, 0xffff0000, v17
    v_and_b32 v99, 0xffff0000, v21
    v_mul_f32 v96, 0x3fb8aa3b, v96
    v_mul_f32 v97, v7, v97
    v_exp_f32 v96, v96
    v_mul_f32 v100, 0xc1000000, v97
    v_mul_f32 v101, 0x43800000, v97
    v_cvt_pk_bf16_f32 v96, v96, v96
    v_fract_f32 v97, v97
    v_fract_f32 v100, v100
    v_fract_f32_e64 v101, v101
    ds_read_b64_tr_b16 v[112:113], v51 offset:0
    ds_read_b64_tr_b16 v[116:117], v52 offset:0
    ds_read_b64_tr_b16 v[114:115], v51 offset:480
    ds_read_b64_tr_b16 v[118:119], v52 offset:480
    ds_read_b64_tr_b16 v[120:121], v51 offset:960
    ds_read_b64_tr_b16 v[124:125], v52 offset:960
    ds_read_b64_tr_b16 v[122:123], v51 offset:1440
    ds_read_b64_tr_b16 v[126:127], v52 offset:1440
    v_and_b32 v96, 0xffff0000, v96
    v_mul_f32 v96, v6, v96
    v_cos_f32 v54, v97
    v_sin_f32_e64 v55, v97
    v_mul_f32 v102, 0x41000000, v96
    v_mul_f32 v103, 0x43800000, v96
    v_cos_f32 v56, v100
    s_waitcnt lgkmcnt(4)
    v_mfma_f32_32x32x16_bf16 v[64:79], v[112:115], v[116:119], v[64:79]
    ds_read_b64_tr_b16 v[128:129], v51 offset:3840
    ds_read_b64_tr_b16 v[132:133], v52 offset:3840
    ds_read_b64_tr_b16 v[130:131], v51 offset:4320
    ds_read_b64_tr_b16 v[134:135], v52 offset:4320
    v_sin_f32 v57, v100
    s_waitcnt lgkmcnt(4)
    v_mfma_f32_32x32x16_bf16 v[64:79], v[120:123], v[124:127], v[64:79]
    ds_read_b64_tr_b16 v[136:137], v51 offset:4800
    ds_read_b64_tr_b16 v[140:141], v52 offset:4800
    ds_read_b64_tr_b16 v[138:139], v51 offset:5280
    ds_read_b64_tr_b16 v[142:143], v52 offset:5280
    v_cos_f32 v58, v101
    s_waitcnt lgkmcnt(4)
    v_mfma_f32_32x32x16_bf16 v[64:79], v[128:131], v[132:135], v[64:79]
    ds_read_b64_tr_b16 v[144:145], v51 offset:7680
    ds_read_b64_tr_b16 v[148:149], v52 offset:7680
    ds_read_b64_tr_b16 v[146:147], v51 offset:8160
    ds_read_b64_tr_b16 v[150:151], v52 offset:8160
    v_sin_f32 v59, v101
    s_waitcnt lgkmcnt(4)
    v_mfma_f32_32x32x16_bf16 v[64:79], v[136:139], v[140:143], v[64:79]
    ds_read_b64_tr_b16 v[152:153], v51 offset:8640
    ds_read_b64_tr_b16 v[156:157], v52 offset:8640
    ds_read_b64_tr_b16 v[154:155], v51 offset:9120
    ds_read_b64_tr_b16 v[158:159], v52 offset:9120
    v_exp_f32 v96, v96
    s_waitcnt lgkmcnt(4)
    v_mfma_f32_32x32x16_bf16 v[80:95], v[144:147], v[148:151], v[80:95]
    ds_read_b64_tr_b16 v[160:161], v51 offset:11520
    ds_read_b64_tr_b16 v[164:165], v52 offset:11520
    ds_read_b64_tr_b16 v[162:163], v51 offset:12000
    ds_read_b64_tr_b16 v[166:167], v52 offset:12000
    v_exp_f32 v102, v102
    s_waitcnt lgkmcnt(4)
    v_mfma_f32_32x32x16_bf16 v[80:95], v[152:155], v[156:159], v[80:95]
    ds_read_b64_tr_b16 v[168:169], v51 offset:12480
    ds_read_b64_tr_b16 v[172:173], v52 offset:12480
    ds_read_b64_tr_b16 v[170:171], v51 offset:12960
    ds_read_b64_tr_b16 v[174:175], v52 offset:12960
    v_exp_f32 v103, v103
    s_waitcnt lgkmcnt(4)
    v_mfma_f32_32x32x16_bf16 v[80:95], v[160:163], v[164:167], v[80:95]
    v_mul_f32 v60, v11, v98
    v_mul_f32 v61, v11, v99
    v_mul_f32 v54, v96, v54
    v_mul_f32 v55, v96, v55
    v_mul_f32 v56, v102, v56
    s_waitcnt lgkmcnt(0)
    v_mfma_f32_32x32x16_bf16 v[80:95], v[168:171], v[172:175], v[80:95]
    v_mul_f32 v57, v102, v57
    v_mul_f32 v58, v103, v58
    v_mul_f32_e64 v59, v103, v59
    v_pk_mul_f32 v[120:121], v[56:57], v[56:57] op_sel:[0,0] op_sel_hi:[0,1]
    v_pk_mul_f32 v[140:141], v[60:61], v[54:55] op_sel:[0,0] op_sel_hi:[0,1]
    v_pk_fma_f32 v[120:121], v[56:57], v[56:57], v[120:121] op_sel:[1,1,0] op_sel_hi:[1,0,1] neg_lo:[1,0,0]
    v_pk_mul_f32 v[154:155], v[60:61], v[58:59] op_sel:[0,0] op_sel_hi:[0,1]
    v_cvt_pk_bf16_f32 v124, 1.0, v56
    v_cvt_pk_bf16_f32 v132, 0, v57
    v_pk_fma_f32 v[140:141], v[60:61], v[54:55], v[140:141] op_sel:[1,1,0] op_sel_hi:[1,0,1] neg_lo:[1,0,0]
    v_pk_mul_f32 v[118:119], v[56:57], v[120:121] op_sel:[0,0] op_sel_hi:[0,1]
    v_pk_fma_f32 v[154:155], v[60:61], v[58:59], v[154:155] op_sel:[1,1,0] op_sel_hi:[1,0,1] neg_lo:[1,0,0]
    v_pk_fma_f32 v[118:119], v[56:57], v[120:121], v[118:119] op_sel:[1,1,0] op_sel_hi:[1,0,1] neg_lo:[1,0,0]
    v_cvt_pk_bf16_f32 v125, v120, v118
    v_cvt_pk_bf16_f32 v180, v60, v140
    v_cvt_pk_bf16_f32 v133, v121, v119
    v_cvt_pk_bf16_f32 v192, v61, v141
    v_pk_mul_f32 v[112:113], v[120:121], v[120:121] op_sel:[0,0] op_sel_hi:[0,1]
    v_pk_mul_f32 v[116:117], v[118:119], v[120:121] op_sel:[0,0] op_sel_hi:[0,1]
    v_pk_mul_f32 v[142:143], v[140:141], v[54:55] op_sel:[0,0] op_sel_hi:[0,1]
    v_pk_fma_f32 v[112:113], v[120:121], v[120:121], v[112:113] op_sel:[1,1,0] op_sel_hi:[1,0,1] neg_lo:[1,0,0]
    v_pk_mul_f32 v[162:163], v[154:155], v[58:59] op_sel:[0,0] op_sel_hi:[0,1]
    v_pk_fma_f32 v[116:117], v[118:119], v[120:121], v[116:117] op_sel:[1,1,0] op_sel_hi:[1,0,1] neg_lo:[1,0,0]
    v_cvt_pk_bf16_f32 v126, v112, v116
    v_pk_fma_f32 v[142:143], v[140:141], v[54:55], v[142:143] op_sel:[1,1,0] op_sel_hi:[1,0,1] neg_lo:[1,0,0]
    v_cvt_pk_bf16_f32 v134, v113, v117
    v_pk_fma_f32 v[162:163], v[154:155], v[58:59], v[162:163] op_sel:[1,1,0] op_sel_hi:[1,0,1] neg_lo:[1,0,0]
    v_pk_mul_f32 v[114:115], v[112:113], v[120:121] op_sel:[0,0] op_sel_hi:[0,1]
    v_pk_mul_f32 v[144:145], v[142:143], v[54:55] op_sel:[0,0] op_sel_hi:[0,1]
    v_pk_mul_f32 v[118:119], v[116:117], v[120:121] op_sel:[0,0] op_sel_hi:[0,1]
    v_pk_fma_f32 v[114:115], v[112:113], v[120:121], v[114:115] op_sel:[1,1,0] op_sel_hi:[1,0,1] neg_lo:[1,0,0]
    v_pk_mul_f32 v[166:167], v[162:163], v[58:59] op_sel:[0,0] op_sel_hi:[0,1]
    v_pk_fma_f32 v[118:119], v[116:117], v[120:121], v[118:119] op_sel:[1,1,0] op_sel_hi:[1,0,1] neg_lo:[1,0,0]
    v_pk_fma_f32 v[144:145], v[142:143], v[54:55], v[144:145] op_sel:[1,1,0] op_sel_hi:[1,0,1] neg_lo:[1,0,0]
    v_cvt_pk_bf16_f32 v127, v114, v118
    v_cvt_pk_bf16_f32 v135, v115, v119
    v_pk_fma_f32 v[166:167], v[162:163], v[58:59], v[166:167] op_sel:[1,1,0] op_sel_hi:[1,0,1] neg_lo:[1,0,0]
    v_cvt_pk_bf16_f32 v181, v142, v144
    ds_write_b128 v50, v[124:127] offset:0
    ds_write_b128 v50, v[132:135] offset:64
    v_pk_mul_f32 v[112:113], v[114:115], v[120:121] op_sel:[0,0] op_sel_hi:[0,1]
    v_cvt_pk_bf16_f32 v193, v143, v145
    v_pk_mul_f32 v[116:117], v[118:119], v[120:121] op_sel:[0,0] op_sel_hi:[0,1]
    v_pk_mul_f32 v[146:147], v[144:145], v[54:55] op_sel:[0,0] op_sel_hi:[0,1]
    v_pk_fma_f32 v[112:113], v[114:115], v[120:121], v[112:113] op_sel:[1,1,0] op_sel_hi:[1,0,1] neg_lo:[1,0,0]
    v_pk_fma_f32 v[116:117], v[118:119], v[120:121], v[116:117] op_sel:[1,1,0] op_sel_hi:[1,0,1] neg_lo:[1,0,0]
    v_pk_mul_f32 v[170:171], v[166:167], v[58:59] op_sel:[0,0] op_sel_hi:[0,1]
    v_cvt_pk_bf16_f32 v128, v112, v116
    v_pk_fma_f32 v[146:147], v[144:145], v[54:55], v[146:147] op_sel:[1,1,0] op_sel_hi:[1,0,1] neg_lo:[1,0,0]
    v_cvt_pk_bf16_f32 v136, v113, v117
    v_pk_mul_f32 v[114:115], v[112:113], v[120:121] op_sel:[0,0] op_sel_hi:[0,1]
    v_pk_fma_f32 v[170:171], v[166:167], v[58:59], v[170:171] op_sel:[1,1,0] op_sel_hi:[1,0,1] neg_lo:[1,0,0]
    v_pk_mul_f32 v[118:119], v[116:117], v[120:121] op_sel:[0,0] op_sel_hi:[0,1]
    v_pk_mul_f32 v[148:149], v[146:147], v[54:55] op_sel:[0,0] op_sel_hi:[0,1]
    v_pk_fma_f32 v[114:115], v[112:113], v[120:121], v[114:115] op_sel:[1,1,0] op_sel_hi:[1,0,1] neg_lo:[1,0,0]
    v_pk_fma_f32 v[118:119], v[116:117], v[120:121], v[118:119] op_sel:[1,1,0] op_sel_hi:[1,0,1] neg_lo:[1,0,0]
    v_pk_mul_f32 v[172:173], v[170:171], v[58:59] op_sel:[0,0] op_sel_hi:[0,1]
    v_cvt_pk_bf16_f32 v129, v114, v118
    v_pk_fma_f32 v[148:149], v[146:147], v[54:55], v[148:149] op_sel:[1,1,0] op_sel_hi:[1,0,1] neg_lo:[1,0,0]
    v_cvt_pk_bf16_f32 v137, v115, v119
    v_pk_mul_f32 v[112:113], v[114:115], v[120:121] op_sel:[0,0] op_sel_hi:[0,1]
    v_pk_fma_f32 v[172:173], v[170:171], v[58:59], v[172:173] op_sel:[1,1,0] op_sel_hi:[1,0,1] neg_lo:[1,0,0]
    v_pk_mul_f32 v[116:117], v[118:119], v[120:121] op_sel:[0,0] op_sel_hi:[0,1]
    v_cvt_pk_bf16_f32 v182, v146, v148
    v_pk_fma_f32 v[112:113], v[114:115], v[120:121], v[112:113] op_sel:[1,1,0] op_sel_hi:[1,0,1] neg_lo:[1,0,0]
    v_pk_fma_f32 v[116:117], v[118:119], v[120:121], v[116:117] op_sel:[1,1,0] op_sel_hi:[1,0,1] neg_lo:[1,0,0]
    v_cvt_pk_bf16_f32 v194, v147, v149
    v_cvt_pk_bf16_f32 v130, v112, v116
    v_cvt_pk_bf16_f32 v188, v170, v172
    v_cvt_pk_bf16_f32 v138, v113, v117
    v_cvt_pk_bf16_f32 v200, v171, v173
    v_pk_mul_f32 v[114:115], v[112:113], v[120:121] op_sel:[0,0] op_sel_hi:[0,1]
    v_pk_mul_f32 v[118:119], v[116:117], v[120:121] op_sel:[0,0] op_sel_hi:[0,1]
    v_pk_mul_f32 v[150:151], v[148:149], v[54:55] op_sel:[0,0] op_sel_hi:[0,1]
    v_pk_fma_f32 v[114:115], v[112:113], v[120:121], v[114:115] op_sel:[1,1,0] op_sel_hi:[1,0,1] neg_lo:[1,0,0]
    v_pk_mul_f32 v[174:175], v[172:173], v[58:59] op_sel:[0,0] op_sel_hi:[0,1]
    v_pk_fma_f32 v[118:119], v[116:117], v[120:121], v[118:119] op_sel:[1,1,0] op_sel_hi:[1,0,1] neg_lo:[1,0,0]
    v_cvt_pk_bf16_f32 v131, v114, v118
    v_pk_fma_f32 v[150:151], v[148:149], v[54:55], v[150:151] op_sel:[1,1,0] op_sel_hi:[1,0,1] neg_lo:[1,0,0]
    v_cvt_pk_bf16_f32 v139, v115, v119
    v_pk_fma_f32 v[174:175], v[172:173], v[58:59], v[174:175] op_sel:[1,1,0] op_sel_hi:[1,0,1] neg_lo:[1,0,0]
    ds_write_b128 v50, v[128:131] offset:16
    ds_write_b128 v50, v[136:139] offset:80
    v_pk_mul_f32 v[152:153], v[150:151], v[54:55] op_sel:[0,0] op_sel_hi:[0,1]
    v_pk_mul_f32 v[112:113], v[114:115], v[120:121] op_sel:[0,0] op_sel_hi:[0,1]
    v_pk_mul_f32 v[176:177], v[174:175], v[58:59] op_sel:[0,0] op_sel_hi:[0,1]
    v_pk_mul_f32 v[116:117], v[118:119], v[120:121] op_sel:[0,0] op_sel_hi:[0,1]
    v_pk_fma_f32 v[112:113], v[114:115], v[120:121], v[112:113] op_sel:[1,1,0] op_sel_hi:[1,0,1] neg_lo:[1,0,0]
    v_pk_fma_f32 v[152:153], v[150:151], v[54:55], v[152:153] op_sel:[1,1,0] op_sel_hi:[1,0,1] neg_lo:[1,0,0]
    v_pk_fma_f32 v[116:117], v[118:119], v[120:121], v[116:117] op_sel:[1,1,0] op_sel_hi:[1,0,1] neg_lo:[1,0,0]
    v_pk_fma_f32 v[176:177], v[174:175], v[58:59], v[176:177] op_sel:[1,1,0] op_sel_hi:[1,0,1] neg_lo:[1,0,0]
    v_cvt_pk_bf16_f32 v124, v112, v116
    v_cvt_pk_bf16_f32 v132, v113, v117
    v_cvt_pk_bf16_f32 v183, v150, v152
    v_pk_mul_f32 v[114:115], v[112:113], v[120:121] op_sel:[0,0] op_sel_hi:[0,1]
    v_cvt_pk_bf16_f32 v195, v151, v153
    v_pk_mul_f32 v[118:119], v[116:117], v[120:121] op_sel:[0,0] op_sel_hi:[0,1]
    v_pk_fma_f32 v[114:115], v[112:113], v[120:121], v[114:115] op_sel:[1,1,0] op_sel_hi:[1,0,1] neg_lo:[1,0,0]
    v_pk_fma_f32 v[118:119], v[116:117], v[120:121], v[118:119] op_sel:[1,1,0] op_sel_hi:[1,0,1] neg_lo:[1,0,0]
    ds_write_b128 v50, v[180:183] offset:128
    ds_write_b128 v50, v[192:195] offset:176
    v_cvt_pk_bf16_f32 v125, v114, v118
    v_cvt_pk_bf16_f32 v133, v115, v119
    v_cvt_pk_bf16_f32 v190, v174, v176
    v_pk_mul_f32 v[112:113], v[114:115], v[120:121] op_sel:[0,0] op_sel_hi:[0,1]
    v_cvt_pk_bf16_f32 v202, v175, v177
    v_pk_mul_f32 v[116:117], v[118:119], v[120:121] op_sel:[0,0] op_sel_hi:[0,1]
    v_pk_fma_f32 v[112:113], v[114:115], v[120:121], v[112:113] op_sel:[1,1,0] op_sel_hi:[1,0,1] neg_lo:[1,0,0]
    v_pk_mul_f32 v[156:157], v[142:143], v[58:59] op_sel:[0,0] op_sel_hi:[0,1]
    v_pk_fma_f32 v[116:117], v[118:119], v[120:121], v[116:117] op_sel:[1,1,0] op_sel_hi:[1,0,1] neg_lo:[1,0,0]
    v_pk_mul_f32 v[178:179], v[176:177], v[58:59] op_sel:[0,0] op_sel_hi:[0,1]
    v_cvt_pk_bf16_f32 v126, v112, v116
    v_pk_fma_f32 v[156:157], v[142:143], v[58:59], v[156:157] op_sel:[1,1,0] op_sel_hi:[1,0,1] neg_lo:[1,0,0]
    v_cvt_pk_bf16_f32 v134, v113, v117
    v_pk_mul_f32 v[114:115], v[112:113], v[120:121] op_sel:[0,0] op_sel_hi:[0,1]
    v_pk_fma_f32 v[178:179], v[176:177], v[58:59], v[178:179] op_sel:[1,1,0] op_sel_hi:[1,0,1] neg_lo:[1,0,0]
    v_pk_mul_f32 v[118:119], v[116:117], v[120:121] op_sel:[0,0] op_sel_hi:[0,1]
    v_cvt_pk_bf16_f32 v184, v154, v156
    v_pk_fma_f32 v[114:115], v[112:113], v[120:121], v[114:115] op_sel:[1,1,0] op_sel_hi:[1,0,1] neg_lo:[1,0,0]
    v_pk_fma_f32 v[118:119], v[116:117], v[120:121], v[118:119] op_sel:[1,1,0] op_sel_hi:[1,0,1] neg_lo:[1,0,0]
    v_cvt_pk_bf16_f32 v196, v155, v157
    v_cvt_pk_bf16_f32 v127, v114, v118
    v_cvt_pk_bf16_f32 v189, v178, v178
    v_cvt_pk_bf16_f32 v135, v115, v119
    v_cvt_pk_bf16_f32 v201, v179, v179
    ds_write_b128 v50, v[124:127] offset:32
    ds_write_b128 v50, v[132:135] offset:96
    v_pk_mul_f32 v[112:113], v[114:115], v[120:121] op_sel:[0,0] op_sel_hi:[0,1]
    v_pk_mul_f32 v[116:117], v[118:119], v[120:121] op_sel:[0,0] op_sel_hi:[0,1]
    ds_write_b128 v50, v[188:191] offset:160
    ds_write_b128 v50, v[200:203] offset:208
    v_pk_fma_f32 v[112:113], v[114:115], v[120:121], v[112:113] op_sel:[1,1,0] op_sel_hi:[1,0,1] neg_lo:[1,0,0]
    v_pk_mul_f32 v[158:159], v[146:147], v[58:59] op_sel:[0,0] op_sel_hi:[0,1]
    v_pk_fma_f32 v[116:117], v[118:119], v[120:121], v[116:117] op_sel:[1,1,0] op_sel_hi:[1,0,1] neg_lo:[1,0,0]
    v_cvt_pk_bf16_f32 v128, v112, v116
    v_pk_fma_f32 v[158:159], v[146:147], v[58:59], v[158:159] op_sel:[1,1,0] op_sel_hi:[1,0,1] neg_lo:[1,0,0]
    v_cvt_pk_bf16_f32 v136, v113, v117
    v_pk_mul_f32 v[160:161], v[150:151], v[58:59] op_sel:[0,0] op_sel_hi:[0,1]
    v_pk_mul_f32 v[114:115], v[112:113], v[120:121] op_sel:[0,0] op_sel_hi:[0,1]
    v_pk_mul_f32 v[118:119], v[116:117], v[120:121] op_sel:[0,0] op_sel_hi:[0,1]
    v_pk_fma_f32 v[160:161], v[150:151], v[58:59], v[160:161] op_sel:[1,1,0] op_sel_hi:[1,0,1] neg_lo:[1,0,0]
    v_pk_fma_f32 v[114:115], v[112:113], v[120:121], v[114:115] op_sel:[1,1,0] op_sel_hi:[1,0,1] neg_lo:[1,0,0]
    v_cvt_pk_bf16_f32 v186, v158, v160
    v_pk_fma_f32 v[118:119], v[116:117], v[120:121], v[118:119] op_sel:[1,1,0] op_sel_hi:[1,0,1] neg_lo:[1,0,0]
    v_cvt_pk_bf16_f32 v129, v114, v118
    v_cvt_pk_bf16_f32 v198, v159, v161
    v_cvt_pk_bf16_f32 v137, v115, v119
    v_pk_mul_f32 v[164:165], v[158:159], v[58:59] op_sel:[0,0] op_sel_hi:[0,1]
    v_pk_mul_f32 v[112:113], v[114:115], v[120:121] op_sel:[0,0] op_sel_hi:[0,1]
    v_pk_mul_f32 v[116:117], v[118:119], v[120:121] op_sel:[0,0] op_sel_hi:[0,1]
    v_pk_fma_f32 v[164:165], v[158:159], v[58:59], v[164:165] op_sel:[1,1,0] op_sel_hi:[1,0,1] neg_lo:[1,0,0]
    v_pk_fma_f32 v[112:113], v[114:115], v[120:121], v[112:113] op_sel:[1,1,0] op_sel_hi:[1,0,1] neg_lo:[1,0,0]
    v_cvt_pk_bf16_f32 v185, v162, v164
    v_pk_fma_f32 v[116:117], v[118:119], v[120:121], v[116:117] op_sel:[1,1,0] op_sel_hi:[1,0,1] neg_lo:[1,0,0]
    v_cvt_pk_bf16_f32 v197, v163, v165
    v_cvt_pk_bf16_f32 v130, v112, v116
    v_cvt_pk_bf16_f32 v138, v113, v117
    v_pk_mul_f32 v[168:169], v[164:165], v[58:59] op_sel:[0,0] op_sel_hi:[0,1]
    v_pk_mul_f32 v[114:115], v[112:113], v[120:121] op_sel:[0,0] op_sel_hi:[0,1]
    v_pk_fma_f32 v[168:169], v[164:165], v[58:59], v[168:169] op_sel:[1,1,0] op_sel_hi:[1,0,1] neg_lo:[1,0,0]
    v_pk_mul_f32 v[118:119], v[116:117], v[120:121] op_sel:[0,0] op_sel_hi:[0,1]
    v_pk_fma_f32 v[114:115], v[112:113], v[120:121], v[114:115] op_sel:[1,1,0] op_sel_hi:[1,0,1] neg_lo:[1,0,0]
    v_cvt_pk_bf16_f32 v187, v166, v168
    v_pk_fma_f32 v[118:119], v[116:117], v[120:121], v[118:119] op_sel:[1,1,0] op_sel_hi:[1,0,1] neg_lo:[1,0,0]
    v_cvt_pk_bf16_f32 v199, v167, v169
    v_cvt_pk_bf16_f32 v131, v114, v118
    v_cvt_pk_bf16_f32 v139, v115, v119
    ds_write_b128 v50, v[184:187] offset:144
    ds_write_b128 v50, v[128:131] offset:48
    ds_write_b128 v50, v[196:199] offset:192
    ds_write_b128 v50, v[136:139] offset:112
    v_lshlrev_b32 v96, 16, v10
    v_lshlrev_b32 v97, 16, v14
    v_lshlrev_b32 v98, 16, v18
    v_lshlrev_b32 v99, 16, v22
    v_mul_f32 v96, 0x3fb8aa3b, v96
    v_mul_f32 v97, v7, v97
    v_exp_f32 v96, v96
    v_mul_f32 v100, 0xc1000000, v97
    v_mul_f32 v101, 0x43800000, v97
    v_cvt_pk_bf16_f32 v96, v96, v96
    v_fract_f32 v97, v97
    v_fract_f32 v100, v100
    v_fract_f32 v101, v101
    s_waitcnt vmcnt(0)
    ds_read_b64_tr_b16 v[112:113], v51 offset:0
    ds_read_b64_tr_b16 v[116:117], v52 offset:0
    ds_read_b64_tr_b16 v[114:115], v51 offset:480
    ds_read_b64_tr_b16 v[118:119], v52 offset:480
    ds_read_b64_tr_b16 v[120:121], v51 offset:960
    ds_read_b64_tr_b16 v[124:125], v52 offset:960
    ds_read_b64_tr_b16 v[122:123], v51 offset:1440
    ds_read_b64_tr_b16 v[126:127], v52 offset:1440
    v_and_b32 v96, 0xffff0000, v96
    v_mul_f32 v96, v6, v96
    v_cos_f32 v54, v97
    v_sin_f32_e64 v55, v97
    v_mul_f32 v102, 0x41000000, v96
    v_mul_f32 v103, 0x43800000, v96
    v_cos_f32 v56, v100
    s_waitcnt lgkmcnt(4)
    v_mfma_f32_32x32x16_bf16 v[64:79], v[112:115], v[116:119], v[64:79]
    ds_read_b64_tr_b16 v[128:129], v51 offset:3840
    ds_read_b64_tr_b16 v[132:133], v52 offset:3840
    ds_read_b64_tr_b16 v[130:131], v51 offset:4320
    ds_read_b64_tr_b16 v[134:135], v52 offset:4320
    v_sin_f32 v57, v100
    s_waitcnt lgkmcnt(4)
    v_mfma_f32_32x32x16_bf16 v[64:79], v[120:123], v[124:127], v[64:79]
    ds_read_b64_tr_b16 v[136:137], v51 offset:4800
    ds_read_b64_tr_b16 v[140:141], v52 offset:4800
    ds_read_b64_tr_b16 v[138:139], v51 offset:5280
    ds_read_b64_tr_b16 v[142:143], v52 offset:5280
    v_cos_f32 v58, v101
    s_waitcnt lgkmcnt(4)
    v_mfma_f32_32x32x16_bf16 v[64:79], v[128:131], v[132:135], v[64:79]
    ds_read_b64_tr_b16 v[144:145], v51 offset:7680
    ds_read_b64_tr_b16 v[148:149], v52 offset:7680
    ds_read_b64_tr_b16 v[146:147], v51 offset:8160
    ds_read_b64_tr_b16 v[150:151], v52 offset:8160
    v_sin_f32 v59, v101
    s_waitcnt lgkmcnt(4)
    v_mfma_f32_32x32x16_bf16 v[64:79], v[136:139], v[140:143], v[64:79]
    ds_read_b64_tr_b16 v[152:153], v51 offset:8640
    ds_read_b64_tr_b16 v[156:157], v52 offset:8640
    ds_read_b64_tr_b16 v[154:155], v51 offset:9120
    ds_read_b64_tr_b16 v[158:159], v52 offset:9120
    v_exp_f32 v96, v96
    s_waitcnt lgkmcnt(4)
    v_mfma_f32_32x32x16_bf16 v[80:95], v[144:147], v[148:151], v[80:95]
    ds_read_b64_tr_b16 v[160:161], v51 offset:11520
    ds_read_b64_tr_b16 v[164:165], v52 offset:11520
    ds_read_b64_tr_b16 v[162:163], v51 offset:12000
    ds_read_b64_tr_b16 v[166:167], v52 offset:12000
    v_exp_f32 v102, v102
    s_waitcnt lgkmcnt(4)
    v_mfma_f32_32x32x16_bf16 v[80:95], v[152:155], v[156:159], v[80:95]
    ds_read_b64_tr_b16 v[168:169], v51 offset:12480
    ds_read_b64_tr_b16 v[172:173], v52 offset:12480
    ds_read_b64_tr_b16 v[170:171], v51 offset:12960
    ds_read_b64_tr_b16 v[174:175], v52 offset:12960
    v_exp_f32 v103, v103
    s_waitcnt lgkmcnt(4)
    v_mfma_f32_32x32x16_bf16 v[80:95], v[160:163], v[164:167], v[80:95]
    v_mul_f32 v60, v11, v98
    v_mul_f32 v61, v11, v99
    v_mul_f32 v54, v96, v54
    v_mul_f32 v55, v96, v55
    v_mul_f32 v56, v102, v56
    s_waitcnt lgkmcnt(0)
    v_mfma_f32_32x32x16_bf16 v[80:95], v[168:171], v[172:175], v[80:95]
    v_mul_f32 v57, v102, v57
    v_mul_f32 v58, v103, v58
    v_mul_f32_e64 v59, v103, v59
    v_add_u32_sdwa v24, s48, v216 dst_sel:DWORD dst_unused:UNUSED_PAD src0_sel:DWORD src1_sel:WORD_0
    v_add_u32_sdwa v25, s54, v216 dst_sel:DWORD dst_unused:UNUSED_PAD src0_sel:DWORD src1_sel:WORD_1
    v_add_u32_sdwa v26, s55, v217 dst_sel:DWORD dst_unused:UNUSED_PAD src0_sel:DWORD src1_sel:WORD_0
    v_add_u32_sdwa v27, s56, v217 dst_sel:DWORD dst_unused:UNUSED_PAD src0_sel:DWORD src1_sel:WORD_1
    v_mov_b32 v104, 0
    v_mov_b32 v105, 0
    v_mov_b32 v106, 0
    v_mov_b32 v107, 0
    v_pk_mul_f32 v[120:121], v[56:57], v[56:57] op_sel:[0,0] op_sel_hi:[0,1]
    v_pk_mul_f32 v[140:141], v[60:61], v[54:55] op_sel:[0,0] op_sel_hi:[0,1]
    v_pk_fma_f32 v[120:121], v[56:57], v[56:57], v[120:121] op_sel:[1,1,0] op_sel_hi:[1,0,1] neg_lo:[1,0,0]
    v_pk_mul_f32 v[154:155], v[60:61], v[58:59] op_sel:[0,0] op_sel_hi:[0,1]
    v_cvt_pk_bf16_f32 v124, 1.0, v56
    v_cvt_pk_bf16_f32 v132, 0, v57
    v_pk_fma_f32 v[140:141], v[60:61], v[54:55], v[140:141] op_sel:[1,1,0] op_sel_hi:[1,0,1] neg_lo:[1,0,0]
    v_pk_mul_f32 v[118:119], v[56:57], v[120:121] op_sel:[0,0] op_sel_hi:[0,1]
    v_pk_fma_f32 v[154:155], v[60:61], v[58:59], v[154:155] op_sel:[1,1,0] op_sel_hi:[1,0,1] neg_lo:[1,0,0]
    v_pk_fma_f32 v[118:119], v[56:57], v[120:121], v[118:119] op_sel:[1,1,0] op_sel_hi:[1,0,1] neg_lo:[1,0,0]
    v_cvt_pk_bf16_f32 v125, v120, v118
    v_cvt_pk_bf16_f32 v180, v60, v140
    v_cvt_pk_bf16_f32 v133, v121, v119
    v_cvt_pk_bf16_f32 v192, v61, v141
    v_pk_mul_f32 v[112:113], v[120:121], v[120:121] op_sel:[0,0] op_sel_hi:[0,1]
    v_pk_mul_f32 v[116:117], v[118:119], v[120:121] op_sel:[0,0] op_sel_hi:[0,1]
    v_pk_mul_f32 v[142:143], v[140:141], v[54:55] op_sel:[0,0] op_sel_hi:[0,1]
    v_pk_fma_f32 v[112:113], v[120:121], v[120:121], v[112:113] op_sel:[1,1,0] op_sel_hi:[1,0,1] neg_lo:[1,0,0]
    v_pk_mul_f32 v[162:163], v[154:155], v[58:59] op_sel:[0,0] op_sel_hi:[0,1]
    v_pk_fma_f32 v[116:117], v[118:119], v[120:121], v[116:117] op_sel:[1,1,0] op_sel_hi:[1,0,1] neg_lo:[1,0,0]
    v_cvt_pk_bf16_f32 v126, v112, v116
    v_pk_fma_f32 v[142:143], v[140:141], v[54:55], v[142:143] op_sel:[1,1,0] op_sel_hi:[1,0,1] neg_lo:[1,0,0]
    v_cvt_pk_bf16_f32 v134, v113, v117
    v_pk_fma_f32 v[162:163], v[154:155], v[58:59], v[162:163] op_sel:[1,1,0] op_sel_hi:[1,0,1] neg_lo:[1,0,0]
    v_pk_mul_f32 v[114:115], v[112:113], v[120:121] op_sel:[0,0] op_sel_hi:[0,1]
    v_pk_mul_f32 v[144:145], v[142:143], v[54:55] op_sel:[0,0] op_sel_hi:[0,1]
    v_pk_mul_f32 v[118:119], v[116:117], v[120:121] op_sel:[0,0] op_sel_hi:[0,1]
    v_pk_fma_f32 v[114:115], v[112:113], v[120:121], v[114:115] op_sel:[1,1,0] op_sel_hi:[1,0,1] neg_lo:[1,0,0]
    v_pk_mul_f32 v[166:167], v[162:163], v[58:59] op_sel:[0,0] op_sel_hi:[0,1]
    v_pk_fma_f32 v[118:119], v[116:117], v[120:121], v[118:119] op_sel:[1,1,0] op_sel_hi:[1,0,1] neg_lo:[1,0,0]
    v_pk_fma_f32 v[144:145], v[142:143], v[54:55], v[144:145] op_sel:[1,1,0] op_sel_hi:[1,0,1] neg_lo:[1,0,0]
    v_cvt_pk_bf16_f32 v127, v114, v118
    v_cvt_pk_bf16_f32 v135, v115, v119
    v_pk_fma_f32 v[166:167], v[162:163], v[58:59], v[166:167] op_sel:[1,1,0] op_sel_hi:[1,0,1] neg_lo:[1,0,0]
    v_cvt_pk_bf16_f32 v181, v142, v144
    ds_write_b128 v50, v[124:127] offset:0
    ds_write_b128 v50, v[132:135] offset:64
    ds_write_b128 v26, v[104:107]
    v_pk_mul_f32 v[112:113], v[114:115], v[120:121] op_sel:[0,0] op_sel_hi:[0,1]
    v_cvt_pk_bf16_f32 v193, v143, v145
    v_pk_mul_f32 v[116:117], v[118:119], v[120:121] op_sel:[0,0] op_sel_hi:[0,1]
    v_pk_mul_f32 v[146:147], v[144:145], v[54:55] op_sel:[0,0] op_sel_hi:[0,1]
    v_pk_fma_f32 v[112:113], v[114:115], v[120:121], v[112:113] op_sel:[1,1,0] op_sel_hi:[1,0,1] neg_lo:[1,0,0]
    v_pk_fma_f32 v[116:117], v[118:119], v[120:121], v[116:117] op_sel:[1,1,0] op_sel_hi:[1,0,1] neg_lo:[1,0,0]
    v_pk_mul_f32 v[170:171], v[166:167], v[58:59] op_sel:[0,0] op_sel_hi:[0,1]
    v_cvt_pk_bf16_f32 v128, v112, v116
    v_pk_fma_f32 v[146:147], v[144:145], v[54:55], v[146:147] op_sel:[1,1,0] op_sel_hi:[1,0,1] neg_lo:[1,0,0]
    v_cvt_pk_bf16_f32 v136, v113, v117
    v_pk_mul_f32 v[114:115], v[112:113], v[120:121] op_sel:[0,0] op_sel_hi:[0,1]
    v_pk_fma_f32 v[170:171], v[166:167], v[58:59], v[170:171] op_sel:[1,1,0] op_sel_hi:[1,0,1] neg_lo:[1,0,0]
    v_pk_mul_f32 v[118:119], v[116:117], v[120:121] op_sel:[0,0] op_sel_hi:[0,1]
    v_pk_mul_f32 v[148:149], v[146:147], v[54:55] op_sel:[0,0] op_sel_hi:[0,1]
    v_pk_fma_f32 v[114:115], v[112:113], v[120:121], v[114:115] op_sel:[1,1,0] op_sel_hi:[1,0,1] neg_lo:[1,0,0]
    v_pk_fma_f32 v[118:119], v[116:117], v[120:121], v[118:119] op_sel:[1,1,0] op_sel_hi:[1,0,1] neg_lo:[1,0,0]
    v_pk_mul_f32 v[172:173], v[170:171], v[58:59] op_sel:[0,0] op_sel_hi:[0,1]
    v_cvt_pk_bf16_f32 v129, v114, v118
    v_pk_fma_f32 v[148:149], v[146:147], v[54:55], v[148:149] op_sel:[1,1,0] op_sel_hi:[1,0,1] neg_lo:[1,0,0]
    v_cvt_pk_bf16_f32 v137, v115, v119
    v_pk_mul_f32 v[112:113], v[114:115], v[120:121] op_sel:[0,0] op_sel_hi:[0,1]
    v_pk_fma_f32 v[172:173], v[170:171], v[58:59], v[172:173] op_sel:[1,1,0] op_sel_hi:[1,0,1] neg_lo:[1,0,0]
    v_pk_mul_f32 v[116:117], v[118:119], v[120:121] op_sel:[0,0] op_sel_hi:[0,1]
    v_cvt_pk_bf16_f32 v182, v146, v148
    v_pk_fma_f32 v[112:113], v[114:115], v[120:121], v[112:113] op_sel:[1,1,0] op_sel_hi:[1,0,1] neg_lo:[1,0,0]
    v_pk_fma_f32 v[116:117], v[118:119], v[120:121], v[116:117] op_sel:[1,1,0] op_sel_hi:[1,0,1] neg_lo:[1,0,0]
    v_cvt_pk_bf16_f32 v194, v147, v149
    v_cvt_pk_bf16_f32 v130, v112, v116
    v_cvt_pk_bf16_f32 v188, v170, v172
    v_cvt_pk_bf16_f32 v138, v113, v117
    v_cvt_pk_bf16_f32 v200, v171, v173
    v_pk_mul_f32 v[114:115], v[112:113], v[120:121] op_sel:[0,0] op_sel_hi:[0,1]
    v_pk_mul_f32 v[118:119], v[116:117], v[120:121] op_sel:[0,0] op_sel_hi:[0,1]
    v_pk_mul_f32 v[150:151], v[148:149], v[54:55] op_sel:[0,0] op_sel_hi:[0,1]
    v_pk_fma_f32 v[114:115], v[112:113], v[120:121], v[114:115] op_sel:[1,1,0] op_sel_hi:[1,0,1] neg_lo:[1,0,0]
    v_pk_mul_f32 v[174:175], v[172:173], v[58:59] op_sel:[0,0] op_sel_hi:[0,1]
    v_pk_fma_f32 v[118:119], v[116:117], v[120:121], v[118:119] op_sel:[1,1,0] op_sel_hi:[1,0,1] neg_lo:[1,0,0]
    v_cvt_pk_bf16_f32 v131, v114, v118
    v_pk_fma_f32 v[150:151], v[148:149], v[54:55], v[150:151] op_sel:[1,1,0] op_sel_hi:[1,0,1] neg_lo:[1,0,0]
    v_cvt_pk_bf16_f32 v139, v115, v119
    v_pk_fma_f32 v[174:175], v[172:173], v[58:59], v[174:175] op_sel:[1,1,0] op_sel_hi:[1,0,1] neg_lo:[1,0,0]
    ds_write_b128 v50, v[128:131] offset:16
    ds_write_b128 v50, v[136:139] offset:80
    ds_write_b32 v27, v104
    v_pk_mul_f32 v[152:153], v[150:151], v[54:55] op_sel:[0,0] op_sel_hi:[0,1]
WB_P2:
    s_cbranch_execz WB_R
    s_nop 0
    v_pk_mul_f32 v[112:113], v[114:115], v[120:121] op_sel:[0,0] op_sel_hi:[0,1]
    v_pk_mul_f32 v[176:177], v[174:175], v[58:59] op_sel:[0,0] op_sel_hi:[0,1]
    v_pk_mul_f32 v[116:117], v[118:119], v[120:121] op_sel:[0,0] op_sel_hi:[0,1]
    v_pk_fma_f32 v[112:113], v[114:115], v[120:121], v[112:113] op_sel:[1,1,0] op_sel_hi:[1,0,1] neg_lo:[1,0,0]
    v_pk_fma_f32 v[152:153], v[150:151], v[54:55], v[152:153] op_sel:[1,1,0] op_sel_hi:[1,0,1] neg_lo:[1,0,0]
    v_pk_fma_f32 v[116:117], v[118:119], v[120:121], v[116:117] op_sel:[1,1,0] op_sel_hi:[1,0,1] neg_lo:[1,0,0]
    v_pk_fma_f32 v[176:177], v[174:175], v[58:59], v[176:177] op_sel:[1,1,0] op_sel_hi:[1,0,1] neg_lo:[1,0,0]
    v_cvt_pk_bf16_f32 v124, v112, v116
    v_cvt_pk_bf16_f32 v132, v113, v117
    v_cvt_pk_bf16_f32 v183, v150, v152
    v_pk_mul_f32 v[114:115], v[112:113], v[120:121] op_sel:[0,0] op_sel_hi:[0,1]
    v_cvt_pk_bf16_f32 v195, v151, v153
    v_pk_mul_f32 v[118:119], v[116:117], v[120:121] op_sel:[0,0] op_sel_hi:[0,1]
    v_pk_fma_f32 v[114:115], v[112:113], v[120:121], v[114:115] op_sel:[1,1,0] op_sel_hi:[1,0,1] neg_lo:[1,0,0]
    v_pk_fma_f32 v[118:119], v[116:117], v[120:121], v[118:119] op_sel:[1,1,0] op_sel_hi:[1,0,1] neg_lo:[1,0,0]
    ds_write_b128 v50, v[180:183] offset:128
    ds_write_b128 v50, v[192:195] offset:176
    s_add_u32 s37, s49, 0
    s_and_b32 s37, s37, 3
    s_mul_i32 s51, s37, 327680
    s_lshl_b32 s37, s37, 10
    s_add_u32 m0, s48, s37
    s_nop 0
    s_nop 0
    buffer_load_dwordx4 v23, s[64:67], s51 offen lds
    v_cvt_pk_bf16_f32 v125, v114, v118
    v_cvt_pk_bf16_f32 v133, v115, v119
    v_cvt_pk_bf16_f32 v190, v174, v176
    v_pk_mul_f32 v[112:113], v[114:115], v[120:121] op_sel:[0,0] op_sel_hi:[0,1]
    v_cvt_pk_bf16_f32 v202, v175, v177
    v_pk_mul_f32 v[116:117], v[118:119], v[120:121] op_sel:[0,0] op_sel_hi:[0,1]
    v_pk_fma_f32 v[112:113], v[114:115], v[120:121], v[112:113] op_sel:[1,1,0] op_sel_hi:[1,0,1] neg_lo:[1,0,0]
    v_pk_mul_f32 v[156:157], v[142:143], v[58:59] op_sel:[0,0] op_sel_hi:[0,1]
    v_pk_fma_f32 v[116:117], v[118:119], v[120:121], v[116:117] op_sel:[1,1,0] op_sel_hi:[1,0,1] neg_lo:[1,0,0]
    v_pk_mul_f32 v[178:179], v[176:177], v[58:59] op_sel:[0,0] op_sel_hi:[0,1]
    v_cvt_pk_bf16_f32 v126, v112, v116
    v_pk_fma_f32 v[156:157], v[142:143], v[58:59], v[156:157] op_sel:[1,1,0] op_sel_hi:[1,0,1] neg_lo:[1,0,0]
    v_cvt_pk_bf16_f32 v134, v113, v117
    v_pk_mul_f32 v[114:115], v[112:113], v[120:121] op_sel:[0,0] op_sel_hi:[0,1]
    v_pk_fma_f32 v[178:179], v[176:177], v[58:59], v[178:179] op_sel:[1,1,0] op_sel_hi:[1,0,1] neg_lo:[1,0,0]
    v_pk_mul_f32 v[118:119], v[116:117], v[120:121] op_sel:[0,0] op_sel_hi:[0,1]
    v_cvt_pk_bf16_f32 v184, v154, v156
    v_pk_fma_f32 v[114:115], v[112:113], v[120:121], v[114:115] op_sel:[1,1,0] op_sel_hi:[1,0,1] neg_lo:[1,0,0]
    v_pk_fma_f32 v[118:119], v[116:117], v[120:121], v[118:119] op_sel:[1,1,0] op_sel_hi:[1,0,1] neg_lo:[1,0,0]
    v_cvt_pk_bf16_f32 v196, v155, v157
    v_cvt_pk_bf16_f32 v127, v114, v118
    v_cvt_pk_bf16_f32 v189, v178, v178
    v_cvt_pk_bf16_f32 v135, v115, v119
    v_cvt_pk_bf16_f32 v201, v179, v179
    ds_write_b128 v50, v[124:127] offset:32
    ds_write_b128 v50, v[132:135] offset:96
    v_pk_mul_f32 v[112:113], v[114:115], v[120:121] op_sel:[0,0] op_sel_hi:[0,1]
    v_pk_mul_f32 v[116:117], v[118:119], v[120:121] op_sel:[0,0] op_sel_hi:[0,1]
    ds_write_b128 v50, v[188:191] offset:160
    ds_write_b128 v50, v[200:203] offset:208
    v_pk_fma_f32 v[112:113], v[114:115], v[120:121], v[112:113] op_sel:[1,1,0] op_sel_hi:[1,0,1] neg_lo:[1,0,0]
    v_pk_mul_f32 v[158:159], v[146:147], v[58:59] op_sel:[0,0] op_sel_hi:[0,1]
    v_pk_fma_f32 v[116:117], v[118:119], v[120:121], v[116:117] op_sel:[1,1,0] op_sel_hi:[1,0,1] neg_lo:[1,0,0]
    v_cvt_pk_bf16_f32 v128, v112, v116
    v_pk_fma_f32 v[158:159], v[146:147], v[58:59], v[158:159] op_sel:[1,1,0] op_sel_hi:[1,0,1] neg_lo:[1,0,0]
    v_cvt_pk_bf16_f32 v136, v113, v117
    v_pk_mul_f32 v[160:161], v[150:151], v[58:59] op_sel:[0,0] op_sel_hi:[0,1]
    v_pk_mul_f32 v[114:115], v[112:113], v[120:121] op_sel:[0,0] op_sel_hi:[0,1]
    v_pk_mul_f32 v[118:119], v[116:117], v[120:121] op_sel:[0,0] op_sel_hi:[0,1]
    v_pk_fma_f32 v[160:161], v[150:151], v[58:59], v[160:161] op_sel:[1,1,0] op_sel_hi:[1,0,1] neg_lo:[1,0,0]
    v_pk_fma_f32 v[114:115], v[112:113], v[120:121], v[114:115] op_sel:[1,1,0] op_sel_hi:[1,0,1] neg_lo:[1,0,0]
    v_cvt_pk_bf16_f32 v186, v158, v160
    v_pk_fma_f32 v[118:119], v[116:117], v[120:121], v[118:119] op_sel:[1,1,0] op_sel_hi:[1,0,1] neg_lo:[1,0,0]
    v_cvt_pk_bf16_f32 v129, v114, v118
    v_cvt_pk_bf16_f32 v198, v159, v161
    v_cvt_pk_bf16_f32 v137, v115, v119
    v_pk_mul_f32 v[164:165], v[158:159], v[58:59] op_sel:[0,0] op_sel_hi:[0,1]
    v_pk_mul_f32 v[112:113], v[114:115], v[120:121] op_sel:[0,0] op_sel_hi:[0,1]
    v_pk_mul_f32 v[116:117], v[118:119], v[120:121] op_sel:[0,0] op_sel_hi:[0,1]
    v_pk_fma_f32 v[164:165], v[158:159], v[58:59], v[164:165] op_sel:[1,1,0] op_sel_hi:[1,0,1] neg_lo:[1,0,0]
    v_pk_fma_f32 v[112:113], v[114:115], v[120:121], v[112:113] op_sel:[1,1,0] op_sel_hi:[1,0,1] neg_lo:[1,0,0]
    v_cvt_pk_bf16_f32 v185, v162, v164
    v_pk_fma_f32 v[116:117], v[118:119], v[120:121], v[116:117] op_sel:[1,1,0] op_sel_hi:[1,0,1] neg_lo:[1,0,0]
    v_cvt_pk_bf16_f32 v197, v163, v165
    v_cvt_pk_bf16_f32 v130, v112, v116
    v_cvt_pk_bf16_f32 v138, v113, v117
    v_pk_mul_f32 v[168:169], v[164:165], v[58:59] op_sel:[0,0] op_sel_hi:[0,1]
    v_pk_mul_f32 v[114:115], v[112:113], v[120:121] op_sel:[0,0] op_sel_hi:[0,1]
    v_pk_fma_f32 v[168:169], v[164:165], v[58:59], v[168:169] op_sel:[1,1,0] op_sel_hi:[1,0,1] neg_lo:[1,0,0]
    v_pk_mul_f32 v[118:119], v[116:117], v[120:121] op_sel:[0,0] op_sel_hi:[0,1]
    v_pk_fma_f32 v[114:115], v[112:113], v[120:121], v[114:115] op_sel:[1,1,0] op_sel_hi:[1,0,1] neg_lo:[1,0,0]
    v_cvt_pk_bf16_f32 v187, v166, v168
    v_pk_fma_f32 v[118:119], v[116:117], v[120:121], v[118:119] op_sel:[1,1,0] op_sel_hi:[1,0,1] neg_lo:[1,0,0]
    v_cvt_pk_bf16_f32 v199, v167, v169
    v_cvt_pk_bf16_f32 v131, v114, v118
    v_cvt_pk_bf16_f32 v139, v115, v119
    ds_write_b128 v50, v[184:187] offset:144
    ds_write_b128 v50, v[128:131] offset:48
    ds_write_b128 v50, v[196:199] offset:192
    ds_write_b128 v50, v[136:139] offset:112
    v_and_b32 v96, 0xffff0000, v10
    v_and_b32 v97, 0xffff0000, v14
    v_and_b32 v98, 0xffff0000, v18
    v_and_b32 v99, 0xffff0000, v22
    v_mul_f32 v96, 0x3fb8aa3b, v96
    v_mul_f32 v97, v7, v97
    v_exp_f32 v96, v96
    v_mul_f32 v100, 0xc1000000, v97
    v_mul_f32 v101, 0x43800000, v97
    v_cvt_pk_bf16_f32 v96, v96, v96
    v_fract_f32 v97, v97
    v_fract_f32 v100, v100
    v_fract_f32_e64 v101, v101
    ds_read_b64_tr_b16 v[112:113], v51 offset:0
    ds_read_b64_tr_b16 v[116:117], v52 offset:0
    ds_read_b64_tr_b16 v[114:115], v51 offset:480
    ds_read_b64_tr_b16 v[118:119], v52 offset:480
    ds_read_b64_tr_b16 v[120:121], v51 offset:960
    ds_read_b64_tr_b16 v[124:125], v52 offset:960
    ds_read_b64_tr_b16 v[122:123], v51 offset:1440
    ds_read_b64_tr_b16 v[126:127], v52 offset:1440
    v_and_b32 v96, 0xffff0000, v96
    v_mul_f32 v96, v6, v96
    v_cos_f32 v54, v97
    v_sin_f32_e64 v55, v97
    v_mul_f32 v102, 0x41000000, v96
    v_mul_f32 v103, 0x43800000, v96
    v_cos_f32 v56, v100
    s_waitcnt lgkmcnt(4)
    v_mfma_f32_32x32x16_bf16 v[64:79], v[112:115], v[116:119], v[64:79]
    ds_read_b64_tr_b16 v[128:129], v51 offset:3840
    ds_read_b64_tr_b16 v[132:133], v52 offset:3840
    ds_read_b64_tr_b16 v[130:131], v51 offset:4320
    ds_read_b64_tr_b16 v[134:135], v52 offset:4320
    v_sin_f32 v57, v100
    s_waitcnt lgkmcnt(4)
    v_mfma_f32_32x32x16_bf16 v[64:79], v[120:123], v[124:127], v[64:79]
    ds_read_b64_tr_b16 v[136:137], v51 offset:4800
    ds_read_b64_tr_b16 v[140:141], v52 offset:4800
    ds_read_b64_tr_b16 v[138:139], v51 offset:5280
    ds_read_b64_tr_b16 v[142:143], v52 offset:5280
    v_cos_f32 v58, v101
    s_waitcnt lgkmcnt(4)
    v_mfma_f32_32x32x16_bf16 v[64:79], v[128:131], v[132:135], v[64:79]
    ds_read_b64_tr_b16 v[144:145], v51 offset:7680
    ds_read_b64_tr_b16 v[148:149], v52 offset:7680
    ds_read_b64_tr_b16 v[146:147], v51 offset:8160
    ds_read_b64_tr_b16 v[150:151], v52 offset:8160
    v_sin_f32 v59, v101
    s_waitcnt lgkmcnt(4)
    v_mfma_f32_32x32x16_bf16 v[64:79], v[136:139], v[140:143], v[64:79]
    ds_read_b64_tr_b16 v[152:153], v51 offset:8640
    ds_read_b64_tr_b16 v[156:157], v52 offset:8640
    ds_read_b64_tr_b16 v[154:155], v51 offset:9120
    ds_read_b64_tr_b16 v[158:159], v52 offset:9120
    v_exp_f32 v96, v96
    s_waitcnt lgkmcnt(4)
    v_mfma_f32_32x32x16_bf16 v[80:95], v[144:147], v[148:151], v[80:95]
    ds_read_b64_tr_b16 v[160:161], v51 offset:11520
    ds_read_b64_tr_b16 v[164:165], v52 offset:11520
    ds_read_b64_tr_b16 v[162:163], v51 offset:12000
    ds_read_b64_tr_b16 v[166:167], v52 offset:12000
    v_exp_f32 v102, v102
    s_waitcnt lgkmcnt(4)
    v_mfma_f32_32x32x16_bf16 v[80:95], v[152:155], v[156:159], v[80:95]
    ds_read_b64_tr_b16 v[168:169], v51 offset:12480
    ds_read_b64_tr_b16 v[172:173], v52 offset:12480
    ds_read_b64_tr_b16 v[170:171], v51 offset:12960
    ds_read_b64_tr_b16 v[174:175], v52 offset:12960
    v_exp_f32 v103, v103
    s_waitcnt lgkmcnt(4)
    v_mfma_f32_32x32x16_bf16 v[80:95], v[160:163], v[164:167], v[80:95]
    v_mul_f32 v60, v11, v98
    v_mul_f32 v61, v11, v99
    v_mul_f32 v54, v96, v54
    v_mul_f32 v55, v96, v55
    v_mul_f32 v56, v102, v56
    s_waitcnt lgkmcnt(0)
    v_mfma_f32_32x32x16_bf16 v[80:95], v[168:171], v[172:175], v[80:95]
    v_mul_f32 v57, v102, v57
    v_mul_f32 v58, v103, v58
    v_mul_f32 v59, v103, v59
    s_add_u32 s37, s49, 1
    s_and_b32 s37, s37, 3
    s_mul_i32 s51, s37, 327680
    s_lshl_b32 s37, s37, 10
    s_add_u32 m0, s48, s37
    s_nop 0
    buffer_load_dwordx4 v23, s[64:67], s51 offen lds
    s_add_u32 s37, s49, 2
    s_and_b32 s37, s37, 3
    s_mul_i32 s51, s37, 327680
    s_lshl_b32 s37, s37, 10
    s_add_u32 m0, s48, s37
    s_nop 0
    s_nop 0
    buffer_load_dwordx4 v23, s[64:67], s51 offen lds
    v_pk_mul_f32 v[120:121], v[56:57], v[56:57] op_sel:[0,0] op_sel_hi:[0,1]
    v_pk_mul_f32 v[140:141], v[60:61], v[54:55] op_sel:[0,0] op_sel_hi:[0,1]
    v_pk_fma_f32 v[120:121], v[56:57], v[56:57], v[120:121] op_sel:[1,1,0] op_sel_hi:[1,0,1] neg_lo:[1,0,0]
    v_pk_mul_f32 v[154:155], v[60:61], v[58:59] op_sel:[0,0] op_sel_hi:[0,1]
    v_cvt_pk_bf16_f32 v124, 1.0, v56
    v_cvt_pk_bf16_f32 v132, 0, v57
    v_pk_fma_f32 v[140:141], v[60:61], v[54:55], v[140:141] op_sel:[1,1,0] op_sel_hi:[1,0,1] neg_lo:[1,0,0]
    v_pk_mul_f32 v[118:119], v[56:57], v[120:121] op_sel:[0,0] op_sel_hi:[0,1]
    v_pk_fma_f32 v[154:155], v[60:61], v[58:59], v[154:155] op_sel:[1,1,0] op_sel_hi:[1,0,1] neg_lo:[1,0,0]
    v_pk_fma_f32 v[118:119], v[56:57], v[120:121], v[118:119] op_sel:[1,1,0] op_sel_hi:[1,0,1] neg_lo:[1,0,0]
    v_cvt_pk_bf16_f32 v125, v120, v118
    v_cvt_pk_bf16_f32 v180, v60, v140
    v_cvt_pk_bf16_f32 v133, v121, v119
    v_cvt_pk_bf16_f32 v192, v61, v141
    v_pk_mul_f32 v[112:113], v[120:121], v[120:121] op_sel:[0,0] op_sel_hi:[0,1]
    v_pk_mul_f32 v[116:117], v[118:119], v[120:121] op_sel:[0,0] op_sel_hi:[0,1]
    v_pk_mul_f32 v[142:143], v[140:141], v[54:55] op_sel:[0,0] op_sel_hi:[0,1]
    v_pk_fma_f32 v[112:113], v[120:121], v[120:121], v[112:113] op_sel:[1,1,0] op_sel_hi:[1,0,1] neg_lo:[1,0,0]
    v_pk_mul_f32 v[162:163], v[154:155], v[58:59] op_sel:[0,0] op_sel_hi:[0,1]
    v_pk_fma_f32 v[116:117], v[118:119], v[120:121], v[116:117] op_sel:[1,1,0] op_sel_hi:[1,0,1] neg_lo:[1,0,0]
    v_cvt_pk_bf16_f32 v126, v112, v116
    v_pk_fma_f32 v[142:143], v[140:141], v[54:55], v[142:143] op_sel:[1,1,0] op_sel_hi:[1,0,1] neg_lo:[1,0,0]
    v_cvt_pk_bf16_f32 v134, v113, v117
    v_pk_fma_f32 v[162:163], v[154:155], v[58:59], v[162:163] op_sel:[1,1,0] op_sel_hi:[1,0,1] neg_lo:[1,0,0]
    v_pk_mul_f32 v[114:115], v[112:113], v[120:121] op_sel:[0,0] op_sel_hi:[0,1]
    v_pk_mul_f32 v[144:145], v[142:143], v[54:55] op_sel:[0,0] op_sel_hi:[0,1]
    v_pk_mul_f32 v[118:119], v[116:117], v[120:121] op_sel:[0,0] op_sel_hi:[0,1]
    v_pk_fma_f32 v[114:115], v[112:113], v[120:121], v[114:115] op_sel:[1,1,0] op_sel_hi:[1,0,1] neg_lo:[1,0,0]
    v_pk_mul_f32 v[166:167], v[162:163], v[58:59] op_sel:[0,0] op_sel_hi:[0,1]
    v_pk_fma_f32 v[118:119], v[116:117], v[120:121], v[118:119] op_sel:[1,1,0] op_sel_hi:[1,0,1] neg_lo:[1,0,0]
    v_pk_fma_f32 v[144:145], v[142:143], v[54:55], v[144:145] op_sel:[1,1,0] op_sel_hi:[1,0,1] neg_lo:[1,0,0]
    v_cvt_pk_bf16_f32 v127, v114, v118
    v_cvt_pk_bf16_f32 v135, v115, v119
    v_pk_fma_f32 v[166:167], v[162:163], v[58:59], v[166:167] op_sel:[1,1,0] op_sel_hi:[1,0,1] neg_lo:[1,0,0]
    v_cvt_pk_bf16_f32 v181, v142, v144
    ds_write_b128 v50, v[124:127] offset:0
    ds_write_b128 v50, v[132:135] offset:64
    v_pk_mul_f32 v[112:113], v[114:115], v[120:121] op_sel:[0,0] op_sel_hi:[0,1]
    v_cvt_pk_bf16_f32 v193, v143, v145
    v_pk_mul_f32 v[116:117], v[118:119], v[120:121] op_sel:[0,0] op_sel_hi:[0,1]
    v_pk_mul_f32 v[146:147], v[144:145], v[54:55] op_sel:[0,0] op_sel_hi:[0,1]
    v_pk_fma_f32 v[112:113], v[114:115], v[120:121], v[112:113] op_sel:[1,1,0] op_sel_hi:[1,0,1] neg_lo:[1,0,0]
    v_pk_fma_f32 v[116:117], v[118:119], v[120:121], v[116:117] op_sel:[1,1,0] op_sel_hi:[1,0,1] neg_lo:[1,0,0]
    v_pk_mul_f32 v[170:171], v[166:167], v[58:59] op_sel:[0,0] op_sel_hi:[0,1]
    v_cvt_pk_bf16_f32 v128, v112, v116
    v_pk_fma_f32 v[146:147], v[144:145], v[54:55], v[146:147] op_sel:[1,1,0] op_sel_hi:[1,0,1] neg_lo:[1,0,0]
    v_cvt_pk_bf16_f32 v136, v113, v117
    v_pk_mul_f32 v[114:115], v[112:113], v[120:121] op_sel:[0,0] op_sel_hi:[0,1]
    v_pk_fma_f32 v[170:171], v[166:167], v[58:59], v[170:171] op_sel:[1,1,0] op_sel_hi:[1,0,1] neg_lo:[1,0,0]
    v_pk_mul_f32 v[118:119], v[116:117], v[120:121] op_sel:[0,0] op_sel_hi:[0,1]
    v_pk_mul_f32 v[148:149], v[146:147], v[54:55] op_sel:[0,0] op_sel_hi:[0,1]
    v_pk_fma_f32 v[114:115], v[112:113], v[120:121], v[114:115] op_sel:[1,1,0] op_sel_hi:[1,0,1] neg_lo:[1,0,0]
    v_pk_fma_f32 v[118:119], v[116:117], v[120:121], v[118:119] op_sel:[1,1,0] op_sel_hi:[1,0,1] neg_lo:[1,0,0]
    v_pk_mul_f32 v[172:173], v[170:171], v[58:59] op_sel:[0,0] op_sel_hi:[0,1]
    v_cvt_pk_bf16_f32 v129, v114, v118
    v_pk_fma_f32 v[148:149], v[146:147], v[54:55], v[148:149] op_sel:[1,1,0] op_sel_hi:[1,0,1] neg_lo:[1,0,0]
    v_cvt_pk_bf16_f32 v137, v115, v119
    v_pk_mul_f32 v[112:113], v[114:115], v[120:121] op_sel:[0,0] op_sel_hi:[0,1]
    v_pk_fma_f32 v[172:173], v[170:171], v[58:59], v[172:173] op_sel:[1,1,0] op_sel_hi:[1,0,1] neg_lo:[1,0,0]
    v_pk_mul_f32 v[116:117], v[118:119], v[120:121] op_sel:[0,0] op_sel_hi:[0,1]
    v_cvt_pk_bf16_f32 v182, v146, v148
    v_pk_fma_f32 v[112:113], v[114:115], v[120:121], v[112:113] op_sel:[1,1,0] op_sel_hi:[1,0,1] neg_lo:[1,0,0]
    v_pk_fma_f32 v[116:117], v[118:119], v[120:121], v[116:117] op_sel:[1,1,0] op_sel_hi:[1,0,1] neg_lo:[1,0,0]
    v_cvt_pk_bf16_f32 v194, v147, v149
    v_cvt_pk_bf16_f32 v130, v112, v116
    v_cvt_pk_bf16_f32 v188, v170, v172
    v_cvt_pk_bf16_f32 v138, v113, v117
    v_cvt_pk_bf16_f32 v200, v171, v173
    v_pk_mul_f32 v[114:115], v[112:113], v[120:121] op_sel:[0,0] op_sel_hi:[0,1]
    v_pk_mul_f32 v[118:119], v[116:117], v[120:121] op_sel:[0,0] op_sel_hi:[0,1]
    v_pk_mul_f32 v[150:151], v[148:149], v[54:55] op_sel:[0,0] op_sel_hi:[0,1]
    v_pk_fma_f32 v[114:115], v[112:113], v[120:121], v[114:115] op_sel:[1,1,0] op_sel_hi:[1,0,1] neg_lo:[1,0,0]
    v_pk_mul_f32 v[174:175], v[172:173], v[58:59] op_sel:[0,0] op_sel_hi:[0,1]
    v_pk_fma_f32 v[118:119], v[116:117], v[120:121], v[118:119] op_sel:[1,1,0] op_sel_hi:[1,0,1] neg_lo:[1,0,0]
    v_cvt_pk_bf16_f32 v131, v114, v118
    v_pk_fma_f32 v[150:151], v[148:149], v[54:55], v[150:151] op_sel:[1,1,0] op_sel_hi:[1,0,1] neg_lo:[1,0,0]
    v_cvt_pk_bf16_f32 v139, v115, v119
    v_pk_fma_f32 v[174:175], v[172:173], v[58:59], v[174:175] op_sel:[1,1,0] op_sel_hi:[1,0,1] neg_lo:[1,0,0]
    ds_write_b128 v50, v[128:131] offset:16
    ds_write_b128 v50, v[136:139] offset:80
    v_pk_mul_f32 v[152:153], v[150:151], v[54:55] op_sel:[0,0] op_sel_hi:[0,1]
    v_pk_mul_f32 v[112:113], v[114:115], v[120:121] op_sel:[0,0] op_sel_hi:[0,1]
    v_pk_mul_f32 v[176:177], v[174:175], v[58:59] op_sel:[0,0] op_sel_hi:[0,1]
    v_pk_mul_f32 v[116:117], v[118:119], v[120:121] op_sel:[0,0] op_sel_hi:[0,1]
    v_pk_fma_f32 v[112:113], v[114:115], v[120:121], v[112:113] op_sel:[1,1,0] op_sel_hi:[1,0,1] neg_lo:[1,0,0]
    v_pk_fma_f32 v[152:153], v[150:151], v[54:55], v[152:153] op_sel:[1,1,0] op_sel_hi:[1,0,1] neg_lo:[1,0,0]
    v_pk_fma_f32 v[116:117], v[118:119], v[120:121], v[116:117] op_sel:[1,1,0] op_sel_hi:[1,0,1] neg_lo:[1,0,0]
    v_pk_fma_f32 v[176:177], v[174:175], v[58:59], v[176:177] op_sel:[1,1,0] op_sel_hi:[1,0,1] neg_lo:[1,0,0]
    v_cvt_pk_bf16_f32 v124, v112, v116
    v_cvt_pk_bf16_f32 v132, v113, v117
    v_cvt_pk_bf16_f32 v183, v150, v152
    v_pk_mul_f32 v[114:115], v[112:113], v[120:121] op_sel:[0,0] op_sel_hi:[0,1]
    v_cvt_pk_bf16_f32 v195, v151, v153
    v_pk_mul_f32 v[118:119], v[116:117], v[120:121] op_sel:[0,0] op_sel_hi:[0,1]
    v_pk_fma_f32 v[114:115], v[112:113], v[120:121], v[114:115] op_sel:[1,1,0] op_sel_hi:[1,0,1] neg_lo:[1,0,0]
    v_pk_fma_f32 v[118:119], v[116:117], v[120:121], v[118:119] op_sel:[1,1,0] op_sel_hi:[1,0,1] neg_lo:[1,0,0]
    ds_write_b128 v50, v[180:183] offset:128
    ds_write_b128 v50, v[192:195] offset:176
    s_add_u32 s37, s49, 3
    s_and_b32 s37, s37, 3
    s_mul_i32 s51, s37, 327680
    s_lshl_b32 s37, s37, 10
    s_add_u32 m0, s48, s37
    s_nop 0
    s_nop 0
    buffer_load_dwordx4 v23, s[64:67], s51 offen lds
    v_cvt_pk_bf16_f32 v125, v114, v118
    v_cvt_pk_bf16_f32 v133, v115, v119
    v_cvt_pk_bf16_f32 v190, v174, v176
    v_pk_mul_f32 v[112:113], v[114:115], v[120:121] op_sel:[0,0] op_sel_hi:[0,1]
    v_cvt_pk_bf16_f32 v202, v175, v177
    v_pk_mul_f32 v[116:117], v[118:119], v[120:121] op_sel:[0,0] op_sel_hi:[0,1]
    v_pk_fma_f32 v[112:113], v[114:115], v[120:121], v[112:113] op_sel:[1,1,0] op_sel_hi:[1,0,1] neg_lo:[1,0,0]
    v_pk_mul_f32 v[156:157], v[142:143], v[58:59] op_sel:[0,0] op_sel_hi:[0,1]
    v_pk_fma_f32 v[116:117], v[118:119], v[120:121], v[116:117] op_sel:[1,1,0] op_sel_hi:[1,0,1] neg_lo:[1,0,0]
    v_pk_mul_f32 v[178:179], v[176:177], v[58:59] op_sel:[0,0] op_sel_hi:[0,1]
    v_cvt_pk_bf16_f32 v126, v112, v116
    v_pk_fma_f32 v[156:157], v[142:143], v[58:59], v[156:157] op_sel:[1,1,0] op_sel_hi:[1,0,1] neg_lo:[1,0,0]
    v_cvt_pk_bf16_f32 v134, v113, v117
    v_pk_mul_f32 v[114:115], v[112:113], v[120:121] op_sel:[0,0] op_sel_hi:[0,1]
    v_pk_fma_f32 v[178:179], v[176:177], v[58:59], v[178:179] op_sel:[1,1,0] op_sel_hi:[1,0,1] neg_lo:[1,0,0]
    v_pk_mul_f32 v[118:119], v[116:117], v[120:121] op_sel:[0,0] op_sel_hi:[0,1]
    v_cvt_pk_bf16_f32 v184, v154, v156
    v_pk_fma_f32 v[114:115], v[112:113], v[120:121], v[114:115] op_sel:[1,1,0] op_sel_hi:[1,0,1] neg_lo:[1,0,0]
    v_pk_fma_f32 v[118:119], v[116:117], v[120:121], v[118:119] op_sel:[1,1,0] op_sel_hi:[1,0,1] neg_lo:[1,0,0]
    v_cvt_pk_bf16_f32 v196, v155, v157
    v_cvt_pk_bf16_f32 v127, v114, v118
    v_cvt_pk_bf16_f32 v189, v178, v178
    v_cvt_pk_bf16_f32 v135, v115, v119
    v_cvt_pk_bf16_f32 v201, v179, v179
    ds_write_b128 v50, v[124:127] offset:32
    ds_write_b128 v50, v[132:135] offset:96
    v_pk_mul_f32 v[112:113], v[114:115], v[120:121] op_sel:[0,0] op_sel_hi:[0,1]
    v_pk_mul_f32 v[116:117], v[118:119], v[120:121] op_sel:[0,0] op_sel_hi:[0,1]
    ds_write_b128 v50, v[188:191] offset:160
    ds_write_b128 v50, v[200:203] offset:208
    v_pk_fma_f32 v[112:113], v[114:115], v[120:121], v[112:113] op_sel:[1,1,0] op_sel_hi:[1,0,1] neg_lo:[1,0,0]
    v_pk_mul_f32 v[158:159], v[146:147], v[58:59] op_sel:[0,0] op_sel_hi:[0,1]
    v_pk_fma_f32 v[116:117], v[118:119], v[120:121], v[116:117] op_sel:[1,1,0] op_sel_hi:[1,0,1] neg_lo:[1,0,0]
    v_cvt_pk_bf16_f32 v128, v112, v116
    v_pk_fma_f32 v[158:159], v[146:147], v[58:59], v[158:159] op_sel:[1,1,0] op_sel_hi:[1,0,1] neg_lo:[1,0,0]
    v_cvt_pk_bf16_f32 v136, v113, v117
    v_pk_mul_f32 v[160:161], v[150:151], v[58:59] op_sel:[0,0] op_sel_hi:[0,1]
    v_pk_mul_f32 v[114:115], v[112:113], v[120:121] op_sel:[0,0] op_sel_hi:[0,1]
    v_pk_mul_f32 v[118:119], v[116:117], v[120:121] op_sel:[0,0] op_sel_hi:[0,1]
    v_pk_fma_f32 v[160:161], v[150:151], v[58:59], v[160:161] op_sel:[1,1,0] op_sel_hi:[1,0,1] neg_lo:[1,0,0]
    v_pk_fma_f32 v[114:115], v[112:113], v[120:121], v[114:115] op_sel:[1,1,0] op_sel_hi:[1,0,1] neg_lo:[1,0,0]
    v_cvt_pk_bf16_f32 v186, v158, v160
    v_pk_fma_f32 v[118:119], v[116:117], v[120:121], v[118:119] op_sel:[1,1,0] op_sel_hi:[1,0,1] neg_lo:[1,0,0]
    v_cvt_pk_bf16_f32 v129, v114, v118
    v_cvt_pk_bf16_f32 v198, v159, v161
    v_cvt_pk_bf16_f32 v137, v115, v119
    v_pk_mul_f32 v[164:165], v[158:159], v[58:59] op_sel:[0,0] op_sel_hi:[0,1]
    v_pk_mul_f32 v[112:113], v[114:115], v[120:121] op_sel:[0,0] op_sel_hi:[0,1]
    v_pk_mul_f32 v[116:117], v[118:119], v[120:121] op_sel:[0,0] op_sel_hi:[0,1]
    v_pk_fma_f32 v[164:165], v[158:159], v[58:59], v[164:165] op_sel:[1,1,0] op_sel_hi:[1,0,1] neg_lo:[1,0,0]
    v_pk_fma_f32 v[112:113], v[114:115], v[120:121], v[112:113] op_sel:[1,1,0] op_sel_hi:[1,0,1] neg_lo:[1,0,0]
    v_cvt_pk_bf16_f32 v185, v162, v164
    v_pk_fma_f32 v[116:117], v[118:119], v[120:121], v[116:117] op_sel:[1,1,0] op_sel_hi:[1,0,1] neg_lo:[1,0,0]
    v_cvt_pk_bf16_f32 v197, v163, v165
    v_cvt_pk_bf16_f32 v130, v112, v116
    v_cvt_pk_bf16_f32 v138, v113, v117
    v_pk_mul_f32 v[168:169], v[164:165], v[58:59] op_sel:[0,0] op_sel_hi:[0,1]
    v_pk_mul_f32 v[114:115], v[112:113], v[120:121] op_sel:[0,0] op_sel_hi:[0,1]
    v_pk_fma_f32 v[168:169], v[164:165], v[58:59], v[168:169] op_sel:[1,1,0] op_sel_hi:[1,0,1] neg_lo:[1,0,0]
    v_pk_mul_f32 v[118:119], v[116:117], v[120:121] op_sel:[0,0] op_sel_hi:[0,1]
    v_pk_fma_f32 v[114:115], v[112:113], v[120:121], v[114:115] op_sel:[1,1,0] op_sel_hi:[1,0,1] neg_lo:[1,0,0]
    v_cvt_pk_bf16_f32 v187, v166, v168
    v_pk_fma_f32 v[118:119], v[116:117], v[120:121], v[118:119] op_sel:[1,1,0] op_sel_hi:[1,0,1] neg_lo:[1,0,0]
    v_cvt_pk_bf16_f32 v199, v167, v169
    v_cvt_pk_bf16_f32 v131, v114, v118
    v_cvt_pk_bf16_f32 v139, v115, v119
    ds_write_b128 v50, v[184:187] offset:144
    ds_write_b128 v50, v[128:131] offset:48
    ds_write_b128 v50, v[196:199] offset:192
    ds_write_b128 v50, v[136:139] offset:112
    v_add_u32_sdwa v28, s56, v218 dst_sel:DWORD dst_unused:UNUSED_PAD src0_sel:DWORD src1_sel:WORD_0
    v_add_u32_sdwa v29, s56, v218 dst_sel:DWORD dst_unused:UNUSED_PAD src0_sel:DWORD src1_sel:WORD_1
    v_add_u32_sdwa v30, s56, v219 dst_sel:DWORD dst_unused:UNUSED_PAD src0_sel:DWORD src1_sel:WORD_0
    v_add_u32_sdwa v31, s56, v219 dst_sel:DWORD dst_unused:UNUSED_PAD src0_sel:DWORD src1_sel:WORD_1
    v_add_u32_sdwa v32, s55, v220 dst_sel:DWORD dst_unused:UNUSED_PAD src0_sel:DWORD src1_sel:WORD_0
    v_add_u32_sdwa v33, s56, v220 dst_sel:DWORD dst_unused:UNUSED_PAD src0_sel:DWORD src1_sel:WORD_1
    v_add_u32_sdwa v34, s56, v221 dst_sel:DWORD dst_unused:UNUSED_PAD src0_sel:DWORD src1_sel:WORD_0
    v_add_u32_sdwa v35, s56, v221 dst_sel:DWORD dst_unused:UNUSED_PAD src0_sel:DWORD src1_sel:WORD_1
    v_add_u32_sdwa v36, s56, v222 dst_sel:DWORD dst_unused:UNUSED_PAD src0_sel:DWORD src1_sel:WORD_0
    v_add_u32_sdwa v37, s56, v222 dst_sel:DWORD dst_unused:UNUSED_PAD src0_sel:DWORD src1_sel:WORD_1
    v_add_u32_sdwa v38, s56, v223 dst_sel:DWORD dst_unused:UNUSED_PAD src0_sel:DWORD src1_sel:WORD_0
    v_add_u32_sdwa v39, s56, v223 dst_sel:DWORD dst_unused:UNUSED_PAD src0_sel:DWORD src1_sel:WORD_1
    v_add_u32_sdwa v40, s56, v224 dst_sel:DWORD dst_unused:UNUSED_PAD src0_sel:DWORD src1_sel:WORD_0
    s_waitcnt vmcnt(0)
    s_nop 0
    ds_read_b64_tr_b16 a[0:1], v24 offset:0
    ds_read_b64_tr_b16 a[2:3], v24 offset:64
    ds_read_b64_tr_b16 a[4:5], v24 offset:1024
    ds_read_b64_tr_b16 a[6:7], v24 offset:1088
    ds_read_b64_tr_b16 a[8:9], v24 offset:2048
    ds_read_b64_tr_b16 a[10:11], v24 offset:2112
    ds_read_b64_tr_b16 a[12:13], v24 offset:3072
    ds_read_b64_tr_b16 a[14:15], v24 offset:3136
    ds_read_b64_tr_b16 v[112:113], v51 offset:0
    ds_read_b64_tr_b16 v[116:117], v52 offset:0
    ds_read_b64_tr_b16 v[114:115], v51 offset:480
    ds_read_b64_tr_b16 v[118:119], v52 offset:480
    ds_read_b64_tr_b16 v[120:121], v51 offset:960
    ds_read_b64_tr_b16 v[124:125], v52 offset:960
    ds_read_b64_tr_b16 v[122:123], v51 offset:1440
    ds_read_b64_tr_b16 v[126:127], v52 offset:1440
    v_add_u32_sdwa v41, s56, v224 dst_sel:DWORD dst_unused:UNUSED_PAD src0_sel:DWORD src1_sel:WORD_1
    v_add_u32_sdwa v42, s56, v225 dst_sel:DWORD dst_unused:UNUSED_PAD src0_sel:DWORD src1_sel:WORD_0
    v_add_u32_sdwa v43, s56, v225 dst_sel:DWORD dst_unused:UNUSED_PAD src0_sel:DWORD src1_sel:WORD_1
    v_add_u32_sdwa v44, s56, v226 dst_sel:DWORD dst_unused:UNUSED_PAD src0_sel:DWORD src1_sel:WORD_0
    v_add_u32_sdwa v45, s56, v226 dst_sel:DWORD dst_unused:UNUSED_PAD src0_sel:DWORD src1_sel:WORD_1
    v_add_u32_sdwa v46, s56, v227 dst_sel:DWORD dst_unused:UNUSED_PAD src0_sel:DWORD src1_sel:WORD_0
    v_add_u32_sdwa v47, s56, v227 dst_sel:DWORD dst_unused:UNUSED_PAD src0_sel:DWORD src1_sel:WORD_1
    s_waitcnt lgkmcnt(4)
    v_mfma_f32_32x32x16_bf16 v[64:79], v[112:115], v[116:119], v[64:79]
    ds_read_b64_tr_b16 v[128:129], v51 offset:3840
    ds_read_b64_tr_b16 v[132:133], v52 offset:3840
    ds_read_b64_tr_b16 v[130:131], v51 offset:4320
    ds_read_b64_tr_b16 v[134:135], v52 offset:4320
    v_add_u32_sdwa v48, s56, v228 dst_sel:DWORD dst_unused:UNUSED_PAD src0_sel:DWORD src1_sel:WORD_0
    s_waitcnt lgkmcnt(4)
    v_mfma_f32_32x32x16_bf16 v[64:79], v[120:123], v[124:127], v[64:79]
    ds_read_b64_tr_b16 v[136:137], v51 offset:4800
    ds_read_b64_tr_b16 v[140:141], v52 offset:4800
    ds_read_b64_tr_b16 v[138:139], v51 offset:5280
    ds_read_b64_tr_b16 v[142:143], v52 offset:5280
    v_add_u32_sdwa v49, s56, v228 dst_sel:DWORD dst_unused:UNUSED_PAD src0_sel:DWORD src1_sel:WORD_1
    s_waitcnt lgkmcnt(4)
    v_mfma_f32_32x32x16_bf16 v[64:79], v[128:131], v[132:135], v[64:79]
    ds_read_b64_tr_b16 v[144:145], v51 offset:7680
    ds_read_b64_tr_b16 v[148:149], v52 offset:7680
    ds_read_b64_tr_b16 v[146:147], v51 offset:8160
    ds_read_b64_tr_b16 v[150:151], v52 offset:8160
    v_add_u32_sdwa v236, s56, v229 dst_sel:DWORD dst_unused:UNUSED_PAD src0_sel:DWORD src1_sel:WORD_0
    s_waitcnt lgkmcnt(4)
    v_mfma_f32_32x32x16_bf16 v[64:79], v[136:139], v[140:143], v[64:79]
    ds_read_b64_tr_b16 v[152:153], v51 offset:8640
    ds_read_b64_tr_b16 v[156:157], v52 offset:8640
    ds_read_b64_tr_b16 v[154:155], v51 offset:9120
    ds_read_b64_tr_b16 v[158:159], v52 offset:9120
    v_add_u32_sdwa v237, s56, v229 dst_sel:DWORD dst_unused:UNUSED_PAD src0_sel:DWORD src1_sel:WORD_1
    s_waitcnt lgkmcnt(4)
    v_mfma_f32_32x32x16_bf16 v[80:95], v[144:147], v[148:151], v[80:95]
    ds_read_b64_tr_b16 v[160:161], v51 offset:11520
    ds_read_b64_tr_b16 v[164:165], v52 offset:11520
    ds_read_b64_tr_b16 v[162:163], v51 offset:12000
    ds_read_b64_tr_b16 v[166:167], v52 offset:12000
    v_add_u32_sdwa v238, s56, v230 dst_sel:DWORD dst_unused:UNUSED_PAD src0_sel:DWORD src1_sel:WORD_0
    s_waitcnt lgkmcnt(4)
    v_mfma_f32_32x32x16_bf16 v[80:95], v[152:155], v[156:159], v[80:95]
    ds_read_b64_tr_b16 v[168:169], v51 offset:12480
    ds_read_b64_tr_b16 v[172:173], v52 offset:12480
    ds_read_b64_tr_b16 v[170:171], v51 offset:12960
    ds_read_b64_tr_b16 v[174:175], v52 offset:12960
    v_add_u32_sdwa v239, s56, v230 dst_sel:DWORD dst_unused:UNUSED_PAD src0_sel:DWORD src1_sel:WORD_1
    s_waitcnt lgkmcnt(4)
    v_mfma_f32_32x32x16_bf16 v[80:95], v[160:163], v[164:167], v[80:95]
    v_add_u32_sdwa v240, s56, v231 dst_sel:DWORD dst_unused:UNUSED_PAD src0_sel:DWORD src1_sel:WORD_0
    v_add_u32_sdwa v241, s56, v231 dst_sel:DWORD dst_unused:UNUSED_PAD src0_sel:DWORD src1_sel:WORD_1
    v_add_u32_sdwa v242, s56, v232 dst_sel:DWORD dst_unused:UNUSED_PAD src0_sel:DWORD src1_sel:WORD_0
    v_add_u32_sdwa v243, s56, v232 dst_sel:DWORD dst_unused:UNUSED_PAD src0_sel:DWORD src1_sel:WORD_1
    v_add_u32_sdwa v244, s56, v233 dst_sel:DWORD dst_unused:UNUSED_PAD src0_sel:DWORD src1_sel:WORD_0
    s_waitcnt lgkmcnt(0)
    v_mfma_f32_32x32x16_bf16 v[80:95], v[168:171], v[172:175], v[80:95]
    v_add_u32_sdwa v245, s57, v233 dst_sel:DWORD dst_unused:UNUSED_PAD src0_sel:DWORD src1_sel:WORD_1
    v_add_u32_sdwa v246, s58, v234 dst_sel:DWORD dst_unused:UNUSED_PAD src0_sel:DWORD src1_sel:WORD_0
    s_add_u32 s37, s49, 4
    s_and_b32 s37, s37, 3
    s_add_u32 s37, s37, 4
    s_mul_i32 s51, s37, 327680
    s_lshl_b32 s37, s37, 10
    s_add_u32 m0, s48, s37
    s_nop 0
    buffer_load_dwordx4 v23, s[64:67], s51 offen lds
    v_xor_b32 v2, s32, v1
    v_and_b32 v2, 3, v2
    v_lshl_add_u32 v246, v2, 3, v246
    v_add_f32_e64 v64, v15, v64
    v_cvt_pk_bf16_f32 v112, v65, v64
    v_cvt_pk_bf16_f32 v113, v66, v65
    v_cvt_pk_bf16_f32 v114, v67, v66
    v_cvt_pk_bf16_f32 v115, v67, v67
    v_cvt_pk_bf16_f32 v116, v68, v68
    v_cvt_pk_bf16_f32 v117, v69, v69
    v_cvt_pk_bf16_f32 v118, v69, v68
    v_cvt_pk_bf16_f32 v119, v69, v69
    v_cvt_pk_bf16_f32 v120, v70, v70
    v_cvt_pk_bf16_f32 v121, v71, v71
    v_cvt_pk_bf16_f32 v122, v71, v70
    v_cvt_pk_bf16_f32 v123, v71, v71
    v_cvt_pk_bf16_f32 v124, v72, v72
    v_cvt_pk_bf16_f32 v125, v73, v73
    v_cvt_pk_bf16_f32 v126, v74, v74
    v_add_f32_e64 v80, v19, v80
    ds_write_b128 v25, a[0:3] offset:0
    ds_write_b128 v25, a[4:7] offset:512
    ds_write_b128 v25, a[8:11] offset:1024
    ds_write_b128 v25, a[12:15] offset:1536
    ds_write_b128 v28, v[112:115] offset:64
    ds_write_b64 v29, v[116:117] offset:2688
    ds_write_b64 v29, v[118:119] offset:1088
    ds_write_b64 v30, v[120:121] offset:3200
    ds_write_b64 v30, v[122:123] offset:1600
    ds_write_b32 v31, v124 offset:2112
    ds_write_b32 v31, v125 offset:2240
    ds_write_b16_d16_hi v28, v112 offset:60
    ds_write_b16 v29, v116 offset:1084
    ds_write_b16 v30, v120 offset:1596
    ds_write_b16 v31, v124 offset:2108
    ds_write_b16 v31, v125 offset:2236
    s_mov_b64 exec, 1
    ds_write_b32 v31, v124 offset:3712
    ds_write_b16 v31, v124 offset:2
    ds_write_b16 v31, v126 offset:2620
    s_mov_b64 exec, -1
    v_cvt_pk_bf16_f32 v64, v81, v80
    v_cvt_pk_bf16_f32 v65, v82, v81
    v_cvt_pk_bf16_f32 v66, v83, v82
    v_cvt_pk_bf16_f32 v67, v83, v83
    v_cvt_pk_bf16_f32 v68, v84, v84
    v_cvt_pk_bf16_f32 v69, v85, v85
    v_cvt_pk_bf16_f32 v70, v85, v84
    v_cvt_pk_bf16_f32 v71, v85, v85
    v_cvt_pk_bf16_f32 v72, v86, v86
    v_cvt_pk_bf16_f32 v73, v87, v87
    v_cvt_pk_bf16_f32 v74, v87, v86
    v_cvt_pk_bf16_f32 v75, v87, v87
    v_cvt_pk_bf16_f32 v76, v88, v88
    v_cvt_pk_bf16_f32 v77, v89, v89
    v_cvt_pk_bf16_f32 v78, v90, v90
    s_waitcnt lgkmcnt(0)
    s_barrier
    ds_read2_b32 v[202:203], v47 offset0:58 offset1:56
    ds_read2_b32 v[218:219], v47 offset0:66 offset1:64
    ds_read2_b32 v[216:217], v47 offset0:2 offset1:0
    ds_read_b128 a[0:3], v32 offset:448
    ds_read_b32 v168, v39 offset:0
    ds_read_b32 v169, v40 offset:0
    ds_read_b32 v170, v41 offset:0
    ds_read_b32 v171, v42 offset:0
    ds_read_b128 a[4:7], v32 offset:960
    ds_read_b32 v164, v35 offset:0
    ds_read_b32 v165, v36 offset:0
    ds_read_b32 v166, v37 offset:0
    ds_read_b32 v167, v38 offset:0
    ds_read_b128 a[8:11], v32 offset:1472
    ds_read2_b32 v[160:161], v33 offset0:6 offset1:4
    ds_read2_b32 v[162:163], v33 offset0:2 offset1:0
    ds_read_b128 a[12:15], v32 offset:1984
    s_waitcnt lgkmcnt(14)
    v_perm_b32 v172, v203, v202, v212
    v_perm_b32 v173, v203, v202, v213
    v_perm_b32 v174, v203, v202, v214
    v_perm_b32 v175, v203, v202, v215
    s_waitcnt lgkmcnt(0)
    s_nop 0
    v_mfma_f32_16x16x32_bf16 v[108:111], v[172:175], a[0:3], 0
WB_P3:
    s_cbranch_execz WB_R
    s_nop 0
    ds_read2_b32 v[202:203], v47 offset0:74 offset1:72
    ds_read2_b32 v[200:201], v47 offset0:10 offset1:8
    v_perm_b32 v192, v219, v218, v212
    v_mfma_f32_16x16x32_bf16 v[104:107], v[168:171], a[0:3], 0
    ds_read_b128 a[32:35], v32 offset:384
    v_perm_b32 v193, v219, v218, v213
    v_mfma_f32_16x16x32_bf16 v[108:111], v[168:171], a[4:7], v[108:111]
    ds_read_b128 a[36:39], v32 offset:896
    v_perm_b32 v194, v219, v218, v214
    v_mfma_f32_16x16x32_bf16 v[100:103], v[164:167], a[0:3], 0
    ds_read_b32 v184, v49 offset:0
    v_perm_b32 v195, v219, v218, v215
    v_mfma_f32_16x16x32_bf16 v[104:107], v[164:167], a[4:7], v[104:107]
    ds_read_b32 v185, v236 offset:0
    v_perm_b32 v188, v217, v216, v212
    v_mfma_f32_16x16x32_bf16 v[108:111], v[164:167], a[8:11], v[108:111]
    ds_read_b32 v186, v237 offset:0
    ds_read_b32 v187, v238 offset:0
    v_mfma_f32_16x16x32_bf16 v[96:99], v[160:163], a[0:3], 0
    ds_read_b128 a[40:43], v32 offset:1408
    v_perm_b32 v189, v217, v216, v213
    v_mfma_f32_16x16x32_bf16 v[100:103], v[160:163], a[4:7], v[100:103]
    ds_read2_b32 v[180:181], v33 offset0:38 offset1:36
    v_perm_b32 v190, v217, v216, v214
    v_mfma_f32_16x16x32_bf16 v[104:107], v[160:163], a[8:11], v[104:107]
    ds_read2_b32 v[182:183], v33 offset0:34 offset1:32
    v_perm_b32 v191, v217, v216, v215
    v_mfma_f32_16x16x32_bf16 v[108:111], v[160:163], a[12:15], v[108:111]
    ds_read_b128 a[44:47], v32 offset:1920
    s_waitcnt lgkmcnt(8)
    v_mfma_f32_16x16x32_bf16 v[108:111], v[192:195], a[32:35], v[108:111]
    ds_read2_b32 v[218:219], v47 offset0:82 offset1:80
    ds_read2_b32 v[216:217], v47 offset0:18 offset1:16
    v_perm_b32 v172, v203, v202, v212
    v_mfma_f32_16x16x32_bf16 v[104:107], v[188:191], a[32:35], v[104:107]
    ds_read_b128 a[0:3], v32 offset:320
    v_perm_b32 v173, v203, v202, v213
    v_perm_b32 v174, v203, v202, v214
    v_mfma_f32_16x16x32_bf16 v[108:111], v[188:191], a[36:39], v[108:111]
    ds_read_b128 a[4:7], v32 offset:832
    ds_read_b32 v164, v49 offset:64
    s_waitcnt lgkmcnt(8)
    v_mfma_f32_16x16x32_bf16 v[100:103], v[184:187], a[32:35], v[100:103]
    ds_read_b32 v165, v236 offset:64
    v_perm_b32 v175, v203, v202, v215
    v_perm_b32 v168, v201, v200, v212
    v_mfma_f32_16x16x32_bf16 v[104:107], v[184:187], a[36:39], v[104:107]
    ds_read_b32 v166, v237 offset:64
    ds_read_b32 v167, v238 offset:64
    v_perm_b32 v169, v201, v200, v213
    v_mfma_f32_16x16x32_bf16 v[108:111], v[184:187], a[40:43], v[108:111]
    ds_read_b128 a[8:11], v32 offset:1344
    v_perm_b32 v170, v201, v200, v214
    s_waitcnt lgkmcnt(9)
    v_mfma_f32_16x16x32_bf16 v[96:99], v[180:183], a[32:35], v[96:99]
    ds_read2_b32 v[160:161], v33 offset0:70 offset1:68
    ds_read2_b32 v[162:163], v33 offset0:66 offset1:64
    v_perm_b32 v171, v201, v200, v215
    v_mfma_f32_16x16x32_bf16 v[100:103], v[180:183], a[36:39], v[100:103]
    ds_read_b128 a[12:15], v32 offset:1856
    v_mfma_f32_16x16x32_bf16 v[104:107], v[180:183], a[40:43], v[104:107]
    ds_write_b128 v28, v[64:67] offset:3904
    ds_write_b64 v29, v[68:69] offset:6528
    ds_write_b64 v29, v[70:71] offset:4928
    ds_write_b64 v30, v[72:73] offset:7040
    v_mfma_f32_16x16x32_bf16 v[108:111], v[180:183], a[44:47], v[108:111]
    ds_write_b64 v30, v[74:75] offset:5440
    ds_write_b32 v31, v76 offset:5952
    ds_write_b32 v31, v77 offset:6080
    s_waitcnt lgkmcnt(14)
    v_mfma_f32_16x16x32_bf16 v[108:111], v[172:175], a[0:3], v[108:111]
    ds_read2_b32 v[202:203], v47 offset0:90 offset1:88
    ds_read2_b32 v[200:201], v47 offset0:26 offset1:24
    v_perm_b32 v192, v219, v218, v212
    v_mfma_f32_16x16x32_bf16 v[104:107], v[168:171], a[0:3], v[104:107]
    ds_read_b128 a[32:35], v32 offset:256
    v_perm_b32 v193, v219, v218, v213
    v_perm_b32 v194, v219, v218, v214
    v_mfma_f32_16x16x32_bf16 v[108:111], v[168:171], a[4:7], v[108:111]
    ds_read_b128 a[36:39], v32 offset:768
    v_perm_b32 v195, v219, v218, v215
    s_waitcnt lgkmcnt(12)
    v_mfma_f32_16x16x32_bf16 v[100:103], v[164:167], a[0:3], v[100:103]
    ds_read_b32 v184, v49 offset:128
    s_add_u32 s37, s49, 5
    v_perm_b32 v188, v217, v216, v212
    v_mfma_f32_16x16x32_bf16 v[104:107], v[164:167], a[4:7], v[104:107]
    ds_read_b32 v185, v236 offset:128
    s_and_b32 s37, s37, 3
    s_add_u32 s37, s37, 4
    v_mfma_f32_16x16x32_bf16 v[108:111], v[164:167], a[8:11], v[108:111]
    ds_read_b32 v186, v237 offset:128
    ds_read_b32 v187, v238 offset:128
    v_perm_b32 v189, v217, v216, v213
    v_mfma_f32_16x16x32_bf16 v[96:99], v[160:163], a[0:3], v[96:99]
    ds_read_b128 a[40:43], v32 offset:1280
    s_mul_i32 s51, s37, 327680
    v_perm_b32 v190, v217, v216, v214
    v_mfma_f32_16x16x32_bf16 v[100:103], v[160:163], a[4:7], v[100:103]
    ds_read2_b32 v[180:181], v33 offset0:102 offset1:100
    s_lshl_b32 s37, s37, 10
    s_add_u32 m0, s48, s37
    v_mfma_f32_16x16x32_bf16 v[104:107], v[160:163], a[8:11], v[104:107]
    ds_read2_b32 v[182:183], v33 offset0:98 offset1:96
    v_perm_b32 v191, v217, v216, v215
    s_waitcnt lgkmcnt(14)
    v_mfma_f32_16x16x32_bf16 v[108:111], v[160:163], a[12:15], v[108:111]
    buffer_load_dwordx4 v23, s[64:67], s51 offen lds
    ds_read_b128 a[44:47], v32 offset:1792
    s_waitcnt lgkmcnt(8)
    v_mfma_f32_16x16x32_bf16 v[108:111], v[192:195], a[32:35], v[108:111]
    ds_read2_b32 v[218:219], v47 offset0:98 offset1:96
    ds_read2_b32 v[216:217], v47 offset0:34 offset1:32
    v_perm_b32 v172, v203, v202, v212
    v_mfma_f32_16x16x32_bf16 v[104:107], v[188:191], a[32:35], v[104:107]
    ds_read_b128 a[0:3], v32 offset:192
    v_perm_b32 v173, v203, v202, v213
    v_perm_b32 v174, v203, v202, v214
    v_mfma_f32_16x16x32_bf16 v[108:111], v[188:191], a[36:39], v[108:111]
    ds_read_b128 a[4:7], v32 offset:704
    ds_read_b32 v164, v49 offset:192
    s_waitcnt lgkmcnt(8)
    v_mfma_f32_16x16x32_bf16 v[100:103], v[184:187], a[32:35], v[100:103]
    ds_read_b32 v165, v236 offset:192
    v_perm_b32 v175, v203, v202, v215
    v_perm_b32 v168, v201, v200, v212
    v_mfma_f32_16x16x32_bf16 v[104:107], v[184:187], a[36:39], v[104:107]
    ds_read_b32 v166, v237 offset:192
    ds_read_b32 v167, v238 offset:192
    v_perm_b32 v169, v201, v200, v213
    v_mfma_f32_16x16x32_bf16 v[108:111], v[184:187], a[40:43], v[108:111]
    ds_read_b128 a[8:11], v32 offset:1216
    v_perm_b32 v170, v201, v200, v214
    s_waitcnt lgkmcnt(9)
    v_mfma_f32_16x16x32_bf16 v[96:99], v[180:183], a[32:35], v[96:99]
    ds_read2_b32 v[160:161], v33 offset0:134 offset1:132
    ds_read2_b32 v[162:163], v33 offset0:130 offset1:128
    v_perm_b32 v171, v201, v200, v215
    v_mfma_f32_16x16x32_bf16 v[100:103], v[180:183], a[36:39], v[100:103]
    ds_read_b128 a[12:15], v32 offset:1728
    v_mfma_f32_16x16x32_bf16 v[104:107], v[180:183], a[40:43], v[104:107]
    ds_write_b16_d16_hi v28, v64 offset:3900
    ds_write_b16 v29, v68 offset:4924
    ds_write_b16 v30, v72 offset:5436
    v_mfma_f32_16x16x32_bf16 v[108:111], v[180:183], a[44:47], v[108:111]
    ds_write_b16 v31, v76 offset:5948
    ds_write_b16 v31, v77 offset:6076
    s_mov_b64 exec, 1
    ds_write_b32 v31, v76 offset:7552
    ds_write_b16 v31, v76 offset:3842
    ds_write_b16 v31, v78 offset:6460
    s_mov_b64 exec, -1
    s_waitcnt lgkmcnt(14)
    v_mfma_f32_16x16x32_bf16 v[108:111], v[172:175], a[0:3], v[108:111]
    ds_read2_b32 v[202:203], v47 offset0:106 offset1:104
    ds_read2_b32 v[200:201], v47 offset0:42 offset1:40
    v_perm_b32 v192, v219, v218, v212
    v_mfma_f32_16x16x32_bf16 v[104:107], v[168:171], a[0:3], v[104:107]
    ds_read_b128 a[32:35], v32 offset:128
    v_perm_b32 v193, v219, v218, v213
    v_perm_b32 v194, v219, v218, v214
    v_mfma_f32_16x16x32_bf16 v[108:111], v[168:171], a[4:7], v[108:111]
    ds_read_b128 a[36:39], v32 offset:640
    v_perm_b32 v195, v219, v218, v215
    s_waitcnt lgkmcnt(13)
    v_mfma_f32_16x16x32_bf16 v[100:103], v[164:167], a[0:3], v[100:103]
    ds_read_b32 v184, v49 offset:256
    s_add_u32 s37, s49, 6
    v_perm_b32 v188, v217, v216, v212
    v_mfma_f32_16x16x32_bf16 v[104:107], v[164:167], a[4:7], v[104:107]
    ds_read_b32 v185, v236 offset:256
    s_and_b32 s37, s37, 3
    s_add_u32 s37, s37, 4
    v_mfma_f32_16x16x32_bf16 v[108:111], v[164:167], a[8:11], v[108:111]
    ds_read_b32 v186, v237 offset:256
    ds_read_b32 v187, v238 offset:256
    v_perm_b32 v189, v217, v216, v213
    v_mfma_f32_16x16x32_bf16 v[96:99], v[160:163], a[0:3], v[96:99]
    ds_read_b128 a[40:43], v32 offset:1152
    s_mul_i32 s51, s37, 327680
    v_perm_b32 v190, v217, v216, v214
    v_mfma_f32_16x16x32_bf16 v[100:103], v[160:163], a[4:7], v[100:103]
    ds_read2_b32 v[180:181], v33 offset0:166 offset1:164
    s_lshl_b32 s37, s37, 10
    s_add_u32 m0, s48, s37
    v_mfma_f32_16x16x32_bf16 v[104:107], v[160:163], a[8:11], v[104:107]
    ds_read2_b32 v[182:183], v33 offset0:162 offset1:160
    v_perm_b32 v191, v217, v216, v215
    s_waitcnt lgkmcnt(14)
    v_mfma_f32_16x16x32_bf16 v[108:111], v[160:163], a[12:15], v[108:111]
    buffer_load_dwordx4 v23, s[64:67], s51 offen lds
    ds_read_b128 a[44:47], v32 offset:1664
    s_waitcnt lgkmcnt(8)
    v_mfma_f32_16x16x32_bf16 v[108:111], v[192:195], a[32:35], v[108:111]
    ds_read2_b32 v[218:219], v47 offset0:114 offset1:112
    ds_read2_b32 v[216:217], v47 offset0:50 offset1:48
    v_perm_b32 v172, v203, v202, v212
    v_mfma_f32_16x16x32_bf16 v[104:107], v[188:191], a[32:35], v[104:107]
    ds_read_b128 a[0:3], v32 offset:64
    v_perm_b32 v173, v203, v202, v213
    v_perm_b32 v174, v203, v202, v214
    v_mfma_f32_16x16x32_bf16 v[108:111], v[188:191], a[36:39], v[108:111]
    ds_read_b128 a[4:7], v32 offset:576
    v_perm_b32 v175, v203, v202, v215
    s_waitcnt lgkmcnt(7)
    v_mfma_f32_16x16x32_bf16 v[100:103], v[184:187], a[32:35], v[100:103]
    ds_read_b32 v164, v49 offset:320
    s_add_u32 s37, s49, 7
    v_perm_b32 v168, v201, v200, v212
    v_mfma_f32_16x16x32_bf16 v[104:107], v[184:187], a[36:39], v[104:107]
    ds_read_b32 v165, v236 offset:320
    s_and_b32 s37, s37, 3
    s_add_u32 s37, s37, 4
    v_mfma_f32_16x16x32_bf16 v[108:111], v[184:187], a[40:43], v[108:111]
    ds_read_b32 v166, v237 offset:320
    ds_read_b32 v167, v238 offset:320
    s_waitcnt lgkmcnt(8)
    v_mfma_f32_16x16x32_bf16 v[96:99], v[180:183], a[32:35], v[96:99]
    ds_read_b128 a[8:11], v32 offset:1088
    v_perm_b32 v169, v201, v200, v213
    s_mul_i32 s51, s37, 327680
    v_mfma_f32_16x16x32_bf16 v[100:103], v[180:183], a[36:39], v[100:103]
    ds_read2_b32 v[160:161], v33 offset0:198 offset1:196
    v_perm_b32 v170, v201, v200, v214
    s_lshl_b32 s37, s37, 10
    v_mfma_f32_16x16x32_bf16 v[104:107], v[180:183], a[40:43], v[104:107]
    ds_read2_b32 v[162:163], v33 offset0:194 offset1:192
    s_add_u32 m0, s48, s37
    v_perm_b32 v171, v201, v200, v215
    v_mfma_f32_16x16x32_bf16 v[108:111], v[180:183], a[44:47], v[108:111]
    buffer_load_dwordx4 v23, s[64:67], s51 offen lds
    ds_read_b128 a[12:15], v32 offset:1600
    s_waitcnt lgkmcnt(8)
    v_mfma_f32_16x16x32_bf16 v[108:111], v[172:175], a[0:3], v[108:111]
    ds_read2_b32 v[202:203], v48 offset0:58 offset1:56
    ds_read_b128 a[32:35], v32 offset:0
    v_mfma_f32_16x16x32_bf16 v[104:107], v[168:171], a[0:3], v[104:107]
    ds_read_b128 a[36:39], v32 offset:512
    v_perm_b32 v192, v219, v218, v212
    v_mfma_f32_16x16x32_bf16 v[108:111], v[168:171], a[4:7], v[108:111]
    ds_read_b32 v184, v49 offset:384
    v_perm_b32 v193, v219, v218, v213
    s_waitcnt lgkmcnt(7)
    v_mfma_f32_16x16x32_bf16 v[100:103], v[164:167], a[0:3], v[100:103]
    ds_read_b32 v185, v236 offset:384
    v_perm_b32 v194, v219, v218, v214
    v_mfma_f32_16x16x32_bf16 v[104:107], v[164:167], a[4:7], v[104:107]
    ds_read_b32 v186, v237 offset:384
    v_perm_b32 v195, v219, v218, v215
    v_mfma_f32_16x16x32_bf16 v[108:111], v[164:167], a[8:11], v[108:111]
    ds_read_b32 v187, v238 offset:384
    v_perm_b32 v188, v217, v216, v212
    s_waitcnt lgkmcnt(7)
    v_mfma_f32_16x16x32_bf16 v[96:99], v[160:163], a[0:3], v[96:99]
    ds_read_b128 a[40:43], v32 offset:1024
    v_perm_b32 v189, v217, v216, v213
    v_mfma_f32_16x16x32_bf16 v[100:103], v[160:163], a[4:7], v[100:103]
    ds_read2_b32 v[180:181], v33 offset0:230 offset1:228
    v_perm_b32 v190, v217, v216, v214
    v_mfma_f32_16x16x32_bf16 v[104:107], v[160:163], a[8:11], v[104:107]
    ds_read2_b32 v[182:183], v33 offset0:226 offset1:224
    v_perm_b32 v191, v217, v216, v215
    v_mfma_f32_16x16x32_bf16 v[108:111], v[160:163], a[12:15], v[108:111]
    ds_read_b128 a[44:47], v32 offset:1536
    s_waitcnt lgkmcnt(8)
    v_mfma_f32_16x16x32_bf16 v[108:111], v[192:195], a[32:35], v[108:111]
    ds_read2_b32 v[218:219], v48 offset0:66 offset1:64
    ds_read2_b32 v[216:217], v48 offset0:2 offset1:0
    v_perm_b32 v64, v203, v202, v212
    v_mfma_f32_16x16x32_bf16 v[104:107], v[188:191], a[32:35], v[104:107]
    ds_read_b128 a[0:3], v32 offset:5040
    ds_read_b32 a160, v39 offset:3840
    v_mfma_f32_16x16x32_bf16 v[108:111], v[188:191], a[36:39], v[108:111]
    ds_read_b32 a161, v40 offset:3840
    v_perm_b32 v65, v203, v202, v213
    s_waitcnt lgkmcnt(8)
    v_mfma_f32_16x16x32_bf16 v[100:103], v[184:187], a[32:35], v[100:103]
    ds_read_b32 a162, v41 offset:3840
    ds_read_b32 a163, v42 offset:3840
    v_mfma_f32_16x16x32_bf16 v[104:107], v[184:187], a[36:39], v[104:107]
    ds_read_b128 a[4:7], v32 offset:5552
    v_perm_b32 v66, v203, v202, v214
    v_mfma_f32_16x16x32_bf16 v[108:111], v[184:187], a[40:43], v[108:111]
    ds_read_b32 a164, v35 offset:3840
    ds_read_b32 a165, v36 offset:3840
    s_waitcnt lgkmcnt(10)
    v_mfma_f32_16x16x32_bf16 v[96:99], v[180:183], a[32:35], v[96:99]
    ds_read_b32 a166, v37 offset:3840
    ds_read_b32 a167, v38 offset:3840
    v_mfma_f32_16x16x32_bf16 v[100:103], v[180:183], a[36:39], v[100:103]
    ds_read_b128 a[8:11], v32 offset:6064
    v_perm_b32 v67, v203, v202, v215
    v_mfma_f32_16x16x32_bf16 v[104:107], v[180:183], a[40:43], v[104:107]
    ds_read2_b32 a[168:169], v34 offset0:6 offset1:4
    ds_read2_b32 a[170:171], v34 offset0:2 offset1:0
    v_mfma_f32_16x16x32_bf16 v[108:111], v[180:183], a[44:47], v[108:111]
    ds_read_b128 a[12:15], v32 offset:6576
    s_waitcnt lgkmcnt(9)
    v_mfma_f32_16x16x32_bf16 v[140:143], v[64:67], a[0:3], 0
    ds_read2_b32 v[202:203], v48 offset0:74 offset1:72
    ds_read2_b32 v[200:201], v48 offset0:10 offset1:8
    v_perm_b32 v68, v219, v218, v212
    v_mfma_f32_16x16x32_bf16 v[136:139], a[160:163], a[0:3], 0
    ds_read_b128 a[32:35], v32 offset:4976
    v_perm_b32 v69, v219, v218, v213
    s_waitcnt lgkmcnt(11)
    v_mfma_f32_16x16x32_bf16 v[140:143], a[160:163], a[4:7], v[140:143]
    ds_read_b128 a[36:39], v32 offset:5488
    v_perm_b32 v70, v219, v218, v214
    s_waitcnt lgkmcnt(8)
    v_mfma_f32_16x16x32_bf16 v[132:135], a[164:167], a[0:3], 0
    ds_read_b32 a172, v49 offset:3840
    v_perm_b32 v71, v219, v218, v215
    v_perm_b32 v72, v217, v216, v212
    v_mfma_f32_16x16x32_bf16 v[136:139], a[164:167], a[4:7], v[136:139]
    ds_read_b32 a173, v236 offset:3840
    v_cvt_pk_bf16_f32 v54, v96, v97
    s_waitcnt lgkmcnt(7)
    v_mfma_f32_16x16x32_bf16 v[140:143], a[164:167], a[8:11], v[140:143]
    ds_read_b32 a174, v237 offset:3840
    ds_read_b32 a175, v238 offset:3840
    v_perm_b32 v73, v217, v216, v213
    v_mfma_f32_16x16x32_bf16 v[128:131], a[168:171], a[0:3], 0
    ds_read_b128 a[40:43], v32 offset:6000
    v_cvt_pk_bf16_f32 v55, v98, v99
    v_perm_b32 v74, v217, v216, v214
    v_mfma_f32_16x16x32_bf16 v[132:135], a[168:171], a[4:7], v[132:135]
    ds_read2_b32 a[176:177], v34 offset0:38 offset1:36
    v_cvt_pk_bf16_f32 v56, v100, v101
    v_perm_b32 v75, v217, v216, v215
    v_mfma_f32_16x16x32_bf16 v[136:139], a[168:171], a[8:11], v[136:139]
    ds_read2_b32 a[178:179], v34 offset0:34 offset1:32
    v_cvt_pk_bf16_f32 v57, v102, v103
    s_waitcnt lgkmcnt(11)
    v_mfma_f32_16x16x32_bf16 v[140:143], a[168:171], a[12:15], v[140:143]
    ds_read_b128 a[44:47], v32 offset:6512
    s_waitcnt lgkmcnt(8)
    v_mfma_f32_16x16x32_bf16 v[140:143], v[68:71], a[32:35], v[140:143]
    ds_read2_b32 v[218:219], v48 offset0:82 offset1:80
    ds_read2_b32 v[216:217], v48 offset0:18 offset1:16
    v_perm_b32 v76, v203, v202, v212
    v_perm_b32 v77, v203, v202, v213
    v_mfma_f32_16x16x32_bf16 v[136:139], v[72:75], a[32:35], v[136:139]
    ds_read_b128 a[0:3], v32 offset:4912
    v_perm_b32 v78, v203, v202, v214
    v_perm_b32 v79, v203, v202, v215
    v_mfma_f32_16x16x32_bf16 v[140:143], v[72:75], a[36:39], v[140:143]
    ds_read_b128 a[4:7], v32 offset:5424
    ds_read_b32 a180, v49 offset:3904
    v_perm_b32 v80, v201, v200, v212
    s_waitcnt lgkmcnt(8)
    v_mfma_f32_16x16x32_bf16 v[132:135], a[172:175], a[32:35], v[132:135]
    ds_read_b32 a181, v236 offset:3904
    v_cvt_pk_bf16_f32 v58, v104, v105
    v_perm_b32 v81, v201, v200, v213
    v_mfma_f32_16x16x32_bf16 v[136:139], a[172:175], a[36:39], v[136:139]
    ds_read_b32 a182, v237 offset:3904
    ds_read_b32 a183, v238 offset:3904
    v_cvt_pk_bf16_f32 v59, v106, v107
    v_mfma_f32_16x16x32_bf16 v[140:143], a[172:175], a[40:43], v[140:143]
    ds_read_b128 a[8:11], v32 offset:5936
    v_perm_b32 v82, v201, v200, v214
    v_cvt_pk_bf16_f32 v60, v108, v109
    s_waitcnt lgkmcnt(9)
    v_mfma_f32_16x16x32_bf16 v[128:131], a[176:179], a[32:35], v[128:131]
    ds_read2_b32 a[184:185], v34 offset0:70 offset1:68
    ds_read2_b32 a[186:187], v34 offset0:66 offset1:64
    v_perm_b32 v83, v201, v200, v215
    v_mfma_f32_16x16x32_bf16 v[132:135], a[176:179], a[36:39], v[132:135]
    ds_read_b128 a[12:15], v32 offset:6448
    v_cvt_pk_bf16_f32 v61, v110, v111
    v_mfma_f32_16x16x32_bf16 v[136:139], a[176:179], a[40:43], v[136:139]
    ds_write_b64 v245, v[54:55] offset:0
    ds_write_b64 v245, v[56:57] offset:512
    v_mfma_f32_16x16x32_bf16 v[140:143], a[176:179], a[44:47], v[140:143]
    ds_write_b64 v245, v[58:59] offset:1024
    ds_write_b64 v245, v[60:61] offset:1536
    s_waitcnt lgkmcnt(12)
    v_mfma_f32_16x16x32_bf16 v[140:143], v[76:79], a[0:3], v[140:143]
    ds_read2_b32 v[202:203], v48 offset0:90 offset1:88
    ds_read2_b32 v[200:201], v48 offset0:26 offset1:24
    v_perm_b32 v84, v219, v218, v212
    v_mfma_f32_16x16x32_bf16 v[136:139], v[80:83], a[0:3], v[136:139]
    ds_read_b128 a[32:35], v32 offset:4848
    v_perm_b32 v85, v219, v218, v213
    v_mfma_f32_16x16x32_bf16 v[140:143], v[80:83], a[4:7], v[140:143]
    ds_read_b128 a[36:39], v32 offset:5360
    v_perm_b32 v86, v219, v218, v214
    s_waitcnt lgkmcnt(9)
    v_mfma_f32_16x16x32_bf16 v[132:135], a[180:183], a[0:3], v[132:135]
    ds_read_b32 a188, v49 offset:3968
    v_perm_b32 v87, v219, v218, v215
    v_mfma_f32_16x16x32_bf16 v[136:139], a[180:183], a[4:7], v[136:139]
    ds_read_b32 a189, v236 offset:3968
    v_perm_b32 v88, v217, v216, v212
    v_mfma_f32_16x16x32_bf16 v[140:143], a[180:183], a[8:11], v[140:143]
    ds_read_b32 a190, v237 offset:3968
    ds_read_b32 a191, v238 offset:3968
    v_mfma_f32_16x16x32_bf16 v[128:131], a[184:187], a[0:3], v[128:131]
    ds_read_b128 a[40:43], v32 offset:5872
    v_perm_b32 v89, v217, v216, v213
    v_mfma_f32_16x16x32_bf16 v[132:135], a[184:187], a[4:7], v[132:135]
    ds_read2_b32 a[192:193], v34 offset0:102 offset1:100
    v_perm_b32 v90, v217, v216, v214
    v_mfma_f32_16x16x32_bf16 v[136:139], a[184:187], a[8:11], v[136:139]
    ds_read2_b32 a[194:195], v34 offset0:98 offset1:96
    v_perm_b32 v91, v217, v216, v215
    s_waitcnt lgkmcnt(14)
    v_mfma_f32_16x16x32_bf16 v[140:143], a[184:187], a[12:15], v[140:143]
    ds_read_b128 a[44:47], v32 offset:6384
    s_waitcnt lgkmcnt(8)
    v_mfma_f32_16x16x32_bf16 v[140:143], v[84:87], a[32:35], v[140:143]
    ds_read2_b32 v[218:219], v48 offset0:98 offset1:96
    ds_read2_b32 v[216:217], v48 offset0:34 offset1:32
    v_perm_b32 v92, v203, v202, v212
    v_mfma_f32_16x16x32_bf16 v[136:139], v[88:91], a[32:35], v[136:139]
    ds_read_b128 a[0:3], v32 offset:4784
    v_perm_b32 v93, v203, v202, v213
    v_mfma_f32_16x16x32_bf16 v[140:143], v[88:91], a[36:39], v[140:143]
    ds_read_b128 a[4:7], v32 offset:5296
    v_perm_b32 v94, v203, v202, v214
    s_waitcnt lgkmcnt(7)
    v_mfma_f32_16x16x32_bf16 v[132:135], a[188:191], a[32:35], v[132:135]
    ds_read_b32 a196, v49 offset:4032
    v_perm_b32 v95, v203, v202, v215
    v_mfma_f32_16x16x32_bf16 v[136:139], a[188:191], a[36:39], v[136:139]
    ds_read_b32 a197, v236 offset:4032
    v_perm_b32 v248, v201, v200, v212
    v_mfma_f32_16x16x32_bf16 v[140:143], a[188:191], a[40:43], v[140:143]
    ds_read_b32 a198, v237 offset:4032
    ds_read_b32 a199, v238 offset:4032
    s_waitcnt lgkmcnt(8)
    v_mfma_f32_16x16x32_bf16 v[128:131], a[192:195], a[32:35], v[128:131]
    ds_read_b128 a[8:11], v32 offset:5808
    v_perm_b32 v249, v201, v200, v213
    v_mfma_f32_16x16x32_bf16 v[132:135], a[192:195], a[36:39], v[132:135]
    ds_read2_b32 a[200:201], v34 offset0:134 offset1:132
    v_perm_b32 v250, v201, v200, v214
    v_mfma_f32_16x16x32_bf16 v[136:139], a[192:195], a[40:43], v[136:139]
    ds_read2_b32 a[202:203], v34 offset0:130 offset1:128
    v_perm_b32 v251, v201, v200, v215
    v_mfma_f32_16x16x32_bf16 v[140:143], a[192:195], a[44:47], v[140:143]
    ds_read_b128 a[12:15], v32 offset:6320
    s_waitcnt vmcnt(0)
    s_waitcnt lgkmcnt(8)
    v_mfma_f32_16x16x32_bf16 v[140:143], v[92:95], a[0:3], v[140:143]
    ds_read_b64_tr_b16 a[232:233], v24 offset:4096
    ds_read_b64_tr_b16 a[234:235], v24 offset:4160
    v_perm_b32 v252, v219, v218, v212
    v_mfma_f32_16x16x32_bf16 v[136:139], v[248:251], a[0:3], v[136:139]
    ds_read_b64_tr_b16 a[236:237], v24 offset:5120
    ds_read_b64_tr_b16 a[238:239], v24 offset:5184
    v_perm_b32 v253, v219, v218, v213
    v_mfma_f32_16x16x32_bf16 v[140:143], v[248:251], a[4:7], v[140:143]
    ds_read2_b32 v[202:203], v48 offset0:106 offset1:104
    v_perm_b32 v254, v219, v218, v214
    s_waitcnt lgkmcnt(8)
    v_mfma_f32_16x16x32_bf16 v[132:135], a[196:199], a[0:3], v[132:135]
    ds_read2_b32 v[200:201], v48 offset0:42 offset1:40
    ds_read_b128 a[32:35], v32 offset:4720
    v_perm_b32 v255, v219, v218, v215
    v_mfma_f32_16x16x32_bf16 v[136:139], a[196:199], a[4:7], v[136:139]
    ds_read_b128 a[36:39], v32 offset:5232
    v_perm_b32 v4, v217, v216, v212
    v_mfma_f32_16x16x32_bf16 v[140:143], a[196:199], a[8:11], v[140:143]
    ds_read_b32 a204, v49 offset:4096
    ds_read_b32 a205, v236 offset:4096
    s_waitcnt lgkmcnt(10)
    v_mfma_f32_16x16x32_bf16 v[128:131], a[200:203], a[0:3], v[128:131]
    ds_read_b32 a206, v237 offset:4096
    ds_read_b32 a207, v238 offset:4096
    v_perm_b32 v5, v217, v216, v213
    v_mfma_f32_16x16x32_bf16 v[132:135], a[200:203], a[4:7], v[132:135]
    ds_read_b128 a[40:43], v32 offset:5744
    v_perm_b32 v6, v217, v216, v214
    v_perm_b32 v7, v217, v216, v215
    v_mfma_f32_16x16x32_bf16 v[136:139], a[200:203], a[8:11], v[136:139]
    ds_read2_b32 a[208:209], v34 offset0:166 offset1:164
    ds_read2_b32 a[210:211], v34 offset0:162 offset1:160
    v_mfma_f32_16x16x32_bf16 v[140:143], a[200:203], a[12:15], v[140:143]
    ds_read_b128 a[44:47], v32 offset:6256
    s_waitcnt lgkmcnt(9)
    v_mfma_f32_16x16x32_bf16 v[140:143], v[252:255], a[32:35], v[140:143]
    ds_read_b64_tr_b16 a[240:241], v24 offset:6144
    ds_read_b64_tr_b16 a[242:243], v24 offset:6208
    v_perm_b32 v96, v203, v202, v212
    v_perm_b32 v97, v203, v202, v213
    v_mfma_f32_16x16x32_bf16 v[136:139], v[4:7], a[32:35], v[136:139]
    ds_read_b64_tr_b16 a[244:245], v24 offset:7168
    ds_read_b64_tr_b16 a[246:247], v24 offset:7232
    v_perm_b32 v98, v203, v202, v214
    s_waitcnt lgkmcnt(12)
    v_mfma_f32_16x16x32_bf16 v[140:143], v[4:7], a[36:39], v[140:143]
    ds_read2_b32 v[218:219], v48 offset0:114 offset1:112
    ds_read2_b32 v[216:217], v48 offset0:50 offset1:48
    v_perm_b32 v99, v203, v202, v215
    s_waitcnt lgkmcnt(10)
    v_mfma_f32_16x16x32_bf16 v[132:135], a[204:207], a[32:35], v[132:135]
    ds_read_b128 a[0:3], v32 offset:4656
    ds_read_b128 a[4:7], v32 offset:5168
    v_perm_b32 v100, v201, v200, v212
    v_mfma_f32_16x16x32_bf16 v[136:139], a[204:207], a[36:39], v[136:139]
    ds_read_b32 a212, v49 offset:4160
    ds_read_b32 a213, v236 offset:4160
    v_perm_b32 v101, v201, v200, v213
    s_waitcnt lgkmcnt(11)
    v_mfma_f32_16x16x32_bf16 v[140:143], a[204:207], a[40:43], v[140:143]
    ds_read_b32 a214, v237 offset:4160
    ds_read_b32 a215, v238 offset:4160
    v_perm_b32 v102, v201, v200, v214
    v_mfma_f32_16x16x32_bf16 v[128:131], a[208:211], a[32:35], v[128:131]
    ds_read_b128 a[8:11], v32 offset:5680
    ds_read2_b32 a[216:217], v34 offset0:198 offset1:196
    v_perm_b32 v103, v201, v200, v215
    v_mfma_f32_16x16x32_bf16 v[132:135], a[208:211], a[36:39], v[132:135]
    ds_read2_b32 a[218:219], v34 offset0:194 offset1:192
    ds_read_b128 a[12:15], v32 offset:6192
    v_mfma_f32_16x16x32_bf16 v[136:139], a[208:211], a[40:43], v[136:139]
    ds_write_b128 v25, a[232:235] offset:2048
    s_waitcnt lgkmcnt(14)
    v_mfma_f32_16x16x32_bf16 v[140:143], a[208:211], a[44:47], v[140:143]
    ds_write_b128 v25, a[236:239] offset:2560
    s_waitcnt lgkmcnt(10)
    v_mfma_f32_16x16x32_bf16 v[140:143], v[96:99], a[0:3], v[140:143]
    ds_read2_b32 v[202:203], v47 offset0:58 offset1:56
    ds_read_b128 a[32:35], v32 offset:4592
    v_perm_b32 v104, v219, v218, v212
    v_mfma_f32_16x16x32_bf16 v[136:139], v[100:103], a[0:3], v[136:139]
    ds_read_b128 a[36:39], v32 offset:5104
    v_perm_b32 v105, v219, v218, v213
    v_perm_b32 v106, v219, v218, v214
    v_mfma_f32_16x16x32_bf16 v[140:143], v[100:103], a[4:7], v[140:143]
    ds_read_b32 a220, v49 offset:4224
    ds_read_b32 a221, v236 offset:4224
    s_waitcnt lgkmcnt(10)
    v_mfma_f32_16x16x32_bf16 v[132:135], a[212:215], a[0:3], v[132:135]
    ds_read_b32 a222, v237 offset:4224
    v_perm_b32 v107, v219, v218, v215
    v_perm_b32 v108, v217, v216, v212
    v_mfma_f32_16x16x32_bf16 v[136:139], a[212:215], a[4:7], v[136:139]
    ds_read_b32 a223, v238 offset:4224
    v_perm_b32 v109, v217, v216, v213
WB_P4:
    s_cbranch_execz WB_R
    s_nop 0
    v_mfma_f32_16x16x32_bf16 v[140:143], a[212:215], a[8:11], v[140:143]
    ds_read_b128 a[40:43], v32 offset:5616
    ds_read2_b32 a[224:225], v34 offset0:230 offset1:228
    s_waitcnt lgkmcnt(11)
    v_mfma_f32_16x16x32_bf16 v[128:131], a[216:219], a[0:3], v[128:131]
    ds_read2_b32 a[226:227], v34 offset0:226 offset1:224
    v_perm_b32 v110, v217, v216, v214
    v_perm_b32 v111, v217, v216, v215
    v_mfma_f32_16x16x32_bf16 v[132:135], a[216:219], a[4:7], v[132:135]
    ds_read_b128 a[44:47], v32 offset:6128
    v_mfma_f32_16x16x32_bf16 v[136:139], a[216:219], a[8:11], v[136:139]
    ds_write_b128 v25, a[240:243] offset:3072
    v_mfma_f32_16x16x32_bf16 v[140:143], a[216:219], a[12:15], v[140:143]
    ds_write_b128 v25, a[244:247] offset:3584
    s_waitcnt lgkmcnt(0)
    s_barrier
    v_mfma_f32_16x16x32_bf16 v[140:143], v[104:107], a[32:35], v[140:143]
    ds_read2_b32 v[218:219], v47 offset0:66 offset1:64
    ds_read2_b32 v[216:217], v47 offset0:2 offset1:0
    v_perm_b32 v172, v203, v202, v212
    v_mfma_f32_16x16x32_bf16 v[136:139], v[108:111], a[32:35], v[136:139]
    ds_read_b128 a[0:3], v32 offset:448
    ds_read_b32 v176, v43 offset:0
    v_perm_b32 v173, v203, v202, v213
    v_mfma_f32_16x16x32_bf16 v[140:143], v[108:111], a[36:39], v[140:143]
    ds_read_b32 v177, v44 offset:0
    ds_read_b32 v178, v45 offset:0
    v_mfma_f32_16x16x32_bf16 v[132:135], a[220:223], a[32:35], v[132:135]
    ds_read_b32 v179, v46 offset:0
    ds_read_b128 a[4:7], v32 offset:960
    v_mfma_f32_16x16x32_bf16 v[136:139], a[220:223], a[36:39], v[136:139]
    ds_read_b128 a[8:11], v32 offset:1472
    ds_read_b128 a[12:15], v32 offset:1984
    v_perm_b32 v174, v203, v202, v214
    v_mfma_f32_16x16x32_bf16 v[140:143], a[220:223], a[40:43], v[140:143]
    ds_read_b128 a[16:19], v32 offset:2496
    ds_read_b32 v168, v39 offset:0
    v_mfma_f32_16x16x32_bf16 v[128:131], a[224:227], a[32:35], v[128:131]
    ds_read_b32 v169, v40 offset:0
    ds_read_b32 v170, v41 offset:0
    v_perm_b32 v175, v203, v202, v215
    v_mfma_f32_16x16x32_bf16 v[132:135], a[224:227], a[36:39], v[132:135]
    ds_read_b32 v171, v42 offset:0
    ds_read_b128 a[20:23], v32 offset:3008
    v_mfma_f32_16x16x32_bf16 v[136:139], a[224:227], a[40:43], v[136:139]
    ds_read_b32 v164, v35 offset:0
    ds_read_b32 v165, v36 offset:0
    v_mfma_f32_16x16x32_bf16 v[140:143], a[224:227], a[44:47], v[140:143]
    s_nop 0
    ds_read_b32 v166, v37 offset:0
    ds_read_b32 v167, v38 offset:0
    ds_read_b128 a[24:27], v32 offset:3520
    ds_read2_b32 v[160:161], v33 offset0:6 offset1:4
    ds_read2_b32 v[162:163], v33 offset0:2 offset1:0
    ds_read_b128 a[28:31], v32 offset:4032
    s_waitcnt lgkmcnt(14)
    v_mfma_f32_16x16x32_bf16 v[112:115], v[176:179], a[0:3], 0
    ds_read_b128 a[64:67], v32 offset:432
    ds_read_b128 a[68:71], v32 offset:448
    v_perm_b32 v192, v219, v218, v212
    v_mfma_f32_16x16x32_bf16 v[116:119], v[176:179], a[4:7], 0
    ds_read_b128 a[72:75], v32 offset:944
    v_perm_b32 v193, v219, v218, v213
    v_perm_b32 v194, v219, v218, v214
    v_mfma_f32_16x16x32_bf16 v[120:123], v[176:179], a[8:11], 0
    ds_read_b128 a[76:79], v32 offset:960
    v_perm_b32 v195, v219, v218, v215
    v_mfma_f32_16x16x32_bf16 v[124:127], v[176:179], a[12:15], 0
    ds_read2_b32 v[202:203], v47 offset0:74 offset1:72
    v_cvt_pk_bf16_f32 v54, v128, v129
    v_mfma_f32_16x16x32_bf16 v[112:115], v[172:175], a[4:7], v[112:115]
    ds_read2_b32 v[200:201], v47 offset0:10 offset1:8
    v_perm_b32 v188, v217, v216, v212
    v_mfma_f32_16x16x32_bf16 v[116:119], v[172:175], a[8:11], v[116:119]
    ds_read_b128 a[36:39], v32 offset:896
    ds_read_b128 a[40:43], v32 offset:1408
    v_cvt_pk_bf16_f32 v55, v130, v131
    v_mfma_f32_16x16x32_bf16 v[120:123], v[172:175], a[12:15], v[120:123]
    ds_read_b128 a[44:47], v32 offset:1920
    v_cvt_pk_bf16_f32 v56, v132, v133
    s_waitcnt lgkmcnt(9)
    v_mfma_f32_16x16x32_bf16 v[124:127], v[172:175], a[16:19], v[124:127]
    ds_read_b128 a[48:51], v32 offset:2432
    v_perm_b32 v189, v217, v216, v213
    v_mfma_f32_16x16x32_bf16 v[112:115], v[168:171], a[8:11], v[112:115]
    ds_read_b128 a[52:55], v32 offset:2944
    v_cvt_pk_bf16_f32 v57, v134, v135
    v_mfma_f32_16x16x32_bf16 v[116:119], v[168:171], a[12:15], v[116:119]
    ds_read_b32 v184, v49 offset:0
    v_cvt_pk_bf16_f32 v58, v136, v137
    v_mfma_f32_16x16x32_bf16 v[120:123], v[168:171], a[16:19], v[120:123]
    ds_read_b32 v185, v236 offset:0
    ds_read_b32 v186, v237 offset:0
    v_perm_b32 v190, v217, v216, v214
    v_mfma_f32_16x16x32_bf16 v[124:127], v[168:171], a[20:23], v[124:127]
    ds_read_b32 v187, v238 offset:0
    v_cvt_pk_bf16_f32 v59, v138, v139
    v_mfma_f32_16x16x32_bf16 v[112:115], v[164:167], a[12:15], v[112:115]
    ds_read_b128 a[56:59], v32 offset:3456
    v_cvt_pk_bf16_f32 v60, v140, v141
    v_mfma_f32_16x16x32_bf16 v[116:119], v[164:167], a[16:19], v[116:119]
    ds_read2_b32 v[180:181], v33 offset0:38 offset1:36
    v_perm_b32 v191, v217, v216, v215
    v_mfma_f32_16x16x32_bf16 v[120:123], v[164:167], a[20:23], v[120:123]
    ds_read2_b32 v[182:183], v33 offset0:34 offset1:32
    v_cvt_pk_bf16_f32 v61, v142, v143
    v_mfma_f32_16x16x32_bf16 v[124:127], v[164:167], a[24:27], v[124:127]
    ds_read_b128 a[60:63], v32 offset:3968
    v_mfma_f32_16x16x32_bf16 v[112:115], v[160:163], a[16:19], v[112:115]
    ds_write_b64 v245, v[54:55] offset:4112
    v_mfma_f32_16x16x32_bf16 v[116:119], v[160:163], a[20:23], v[116:119]
    ds_write_b64 v245, v[56:57] offset:4624
    v_mfma_f32_16x16x32_bf16 v[120:123], v[160:163], a[24:27], v[120:123]
    ds_write_b64 v245, v[58:59] offset:5136
    v_mfma_f32_16x16x32_bf16 v[124:127], v[160:163], a[28:31], v[124:127]
    ds_write_b64 v245, v[60:61] offset:5648
    s_waitcnt lgkmcnt(0)
    s_barrier
    v_mfma_f32_16x16x32_bf16 v[112:115], v[192:195], a[36:39], v[112:115]
    ds_read_b64_tr_b16 a[128:129], v246 offset:0
    ds_read_b64_tr_b16 a[130:131], v246 offset:16448
    v_mfma_f32_16x16x32_bf16 v[116:119], v[192:195], a[40:43], v[116:119]
    ds_read_b128 a[80:83], v32 offset:1456
    v_perm_b32 v172, v203, v202, v212
    v_mfma_f32_16x16x32_bf16 v[120:123], v[192:195], a[44:47], v[120:123]
    ds_read_b128 a[84:87], v32 offset:1472
    v_perm_b32 v173, v203, v202, v213
    v_mfma_f32_16x16x32_bf16 v[124:127], v[192:195], a[48:51], v[124:127]
    ds_read_b128 a[88:91], v32 offset:1968
    v_perm_b32 v174, v203, v202, v214
    v_mfma_f32_16x16x32_bf16 v[112:115], v[188:191], a[40:43], v[112:115]
    ds_read_b128 a[92:95], v32 offset:1984
    v_mfma_f32_16x16x32_bf16 v[116:119], v[188:191], a[44:47], v[116:119]
    ds_read2_b32 v[218:219], v47 offset0:82 offset1:80
    v_perm_b32 v175, v203, v202, v215
    v_mfma_f32_16x16x32_bf16 v[120:123], v[188:191], a[48:51], v[120:123]
    ds_read2_b32 v[216:217], v47 offset0:18 offset1:16
    ds_read_b128 a[4:7], v32 offset:832
    v_mfma_f32_16x16x32_bf16 v[124:127], v[188:191], a[52:55], v[124:127]
    ds_read_b128 a[8:11], v32 offset:1344
    v_mfma_f32_16x16x32_bf16 v[112:115], v[184:187], a[44:47], v[112:115]
    ds_read_b128 a[12:15], v32 offset:1856
    v_perm_b32 v168, v201, v200, v212
    v_mfma_f32_16x16x32_bf16 v[116:119], v[184:187], a[48:51], v[116:119]
    ds_read_b128 a[16:19], v32 offset:2368
    v_mfma_f32_16x16x32_bf16 v[120:123], v[184:187], a[52:55], v[120:123]
    ds_read_b128 a[20:23], v32 offset:2880
    v_perm_b32 v169, v201, v200, v213
    v_mfma_f32_16x16x32_bf16 v[124:127], v[184:187], a[56:59], v[124:127]
    ds_read_b32 v164, v49 offset:64
    v_mfma_f32_16x16x32_bf16 v[112:115], v[180:183], a[48:51], v[112:115]
    ds_read_b32 v165, v236 offset:64
    ds_read_b32 v166, v237 offset:64
    v_mfma_f32_16x16x32_bf16 v[116:119], v[180:183], a[52:55], v[116:119]
    ds_read_b32 v167, v238 offset:64
    v_perm_b32 v170, v201, v200, v214
    v_mfma_f32_16x16x32_bf16 v[120:123], v[180:183], a[56:59], v[120:123]
    ds_read_b128 a[24:27], v32 offset:3392
    v_perm_b32 v171, v201, v200, v215
    v_mfma_f32_16x16x32_bf16 v[124:127], v[180:183], a[60:63], v[124:127]
    ds_read2_b32 v[160:161], v33 offset0:70 offset1:68
    v_mfma_f32_16x16x32_bf16 v[220:223], a[64:67], v[204:207], 0
    ds_read2_b32 v[162:163], v33 offset0:66 offset1:64
    v_mfma_f32_16x16x32_bf16 v[224:227], a[68:71], v[208:211], 0
    ds_read_b128 a[28:31], v32 offset:3904
    s_waitcnt lgkmcnt(8)
    v_mfma_f32_16x16x32_bf16 v[112:115], v[172:175], a[4:7], v[112:115]
    ds_read_b32 a96, v239 offset:0
    ds_read_b32 a97, v240 offset:0
    v_mfma_f32_16x16x32_bf16 v[116:119], v[172:175], a[8:11], v[116:119]
    ds_read_b32 a98, v241 offset:0
    v_perm_b32 v192, v219, v218, v212
    v_mfma_f32_16x16x32_bf16 v[120:123], v[172:175], a[12:15], v[120:123]
    ds_read_b32 a99, v242 offset:0
    v_perm_b32 v193, v219, v218, v213
    v_mfma_f32_16x16x32_bf16 v[124:127], v[172:175], a[16:19], v[124:127]
    ds_read2_b32 v[202:203], v47 offset0:90 offset1:88
    v_perm_b32 v194, v219, v218, v214
    v_mfma_f32_16x16x32_bf16 v[112:115], v[168:171], a[8:11], v[112:115]
    ds_read2_b32 v[200:201], v47 offset0:26 offset1:24
    v_perm_b32 v195, v219, v218, v215
    v_mfma_f32_16x16x32_bf16 v[116:119], v[168:171], a[12:15], v[116:119]
    ds_read_b128 a[36:39], v32 offset:768
    s_mov_b32 s50, 0
    v_mfma_f32_16x16x32_bf16 v[120:123], v[168:171], a[16:19], v[120:123]
    ds_read_b128 a[40:43], v32 offset:1280
    v_perm_b32 v188, v217, v216, v212
    v_mfma_f32_16x16x32_bf16 v[124:127], v[168:171], a[20:23], v[124:127]
    buffer_store_dwordx4 a[128:131], v53, s[68:71], s50 offen
    ds_read_b128 a[44:47], v32 offset:1792
    s_waitcnt lgkmcnt(9)
    v_mfma_f32_16x16x32_bf16 v[112:115], v[164:167], a[12:15], v[112:115]
    ds_read_b128 a[48:51], v32 offset:2304
    v_perm_b32 v189, v217, v216, v213
    v_mfma_f32_16x16x32_bf16 v[116:119], v[164:167], a[16:19], v[116:119]
    ds_read_b128 a[52:55], v32 offset:2816
    v_cvt_pk_bf16_f32 v8, v220, v224
    v_mfma_f32_16x16x32_bf16 v[120:123], v[164:167], a[20:23], v[120:123]
    ds_read_b32 v184, v49 offset:128
    v_cvt_pk_bf16_f32 v9, v221, v225
    v_mfma_f32_16x16x32_bf16 v[124:127], v[164:167], a[24:27], v[124:127]
    ds_read_b32 v185, v236 offset:128
    v_perm_b32 v190, v217, v216, v214
    v_mfma_f32_16x16x32_bf16 v[112:115], v[160:163], a[16:19], v[112:115]
    ds_read_b32 v186, v237 offset:128
    v_mfma_f32_16x16x32_bf16 v[116:119], v[160:163], a[20:23], v[116:119]
    ds_read_b32 v187, v238 offset:128
    v_cvt_pk_bf16_f32 v10, v222, v226
    v_mfma_f32_16x16x32_bf16 v[120:123], v[160:163], a[24:27], v[120:123]
    ds_read_b128 a[56:59], v32 offset:3328
    v_perm_b32 v191, v217, v216, v215
    v_mfma_f32_16x16x32_bf16 v[124:127], v[160:163], a[28:31], v[124:127]
    ds_read2_b32 v[180:181], v33 offset0:102 offset1:100
    v_cvt_pk_bf16_f32 v11, v223, v227
    v_mfma_f32_16x16x32_bf16 v[228:231], a[72:75], v[204:207], 0
    ds_read2_b32 v[182:183], v33 offset0:98 offset1:96
    v_mfma_f32_16x16x32_bf16 v[232:235], a[76:79], v[208:211], 0
    ds_read_b128 a[60:63], v32 offset:3840
    s_waitcnt lgkmcnt(8)
    v_mfma_f32_16x16x32_bf16 v[112:115], v[192:195], a[36:39], v[112:115]
    ds_read_b64_tr_b16 a[132:133], v246 offset:512
    ds_read_b64_tr_b16 a[134:135], v246 offset:16960
    v_mfma_f32_16x16x32_bf16 v[116:119], v[192:195], a[40:43], v[116:119]
    ds_read2_b32 a[100:101], v243 offset0:6 offset1:4
    v_perm_b32 v172, v203, v202, v212
    v_mfma_f32_16x16x32_bf16 v[120:123], v[192:195], a[44:47], v[120:123]
    ds_read2_b32 a[102:103], v243 offset0:2 offset1:0
    v_perm_b32 v173, v203, v202, v213
    v_mfma_f32_16x16x32_bf16 v[124:127], v[192:195], a[48:51], v[124:127]
    ds_read2_b32 v[218:219], v47 offset0:98 offset1:96
    v_perm_b32 v174, v203, v202, v214
    v_mfma_f32_16x16x32_bf16 v[112:115], v[188:191], a[40:43], v[112:115]
    ds_read2_b32 v[216:217], v47 offset0:34 offset1:32
    v_perm_b32 v175, v203, v202, v215
    v_mfma_f32_16x16x32_bf16 v[116:119], v[188:191], a[44:47], v[116:119]
    ds_read_b128 a[4:7], v32 offset:704
    v_perm_b32 v168, v201, v200, v212
    v_mfma_f32_16x16x32_bf16 v[120:123], v[188:191], a[48:51], v[120:123]
    ds_read_b128 a[8:11], v32 offset:1216
    v_cvt_pk_bf16_f32 v12, v228, v232
    v_mfma_f32_16x16x32_bf16 v[124:127], v[188:191], a[52:55], v[124:127]
    ds_read_b128 a[12:15], v32 offset:1728
    s_waitcnt lgkmcnt(9)
    v_mfma_f32_16x16x32_bf16 v[112:115], v[184:187], a[44:47], v[112:115]
    ds_read_b128 a[16:19], v32 offset:2240
    v_perm_b32 v169, v201, v200, v213
    v_mfma_f32_16x16x32_bf16 v[116:119], v[184:187], a[48:51], v[116:119]
    ds_read_b128 a[20:23], v32 offset:2752
    v_cvt_pk_bf16_f32 v13, v229, v233
    v_mfma_f32_16x16x32_bf16 v[120:123], v[184:187], a[52:55], v[120:123]
    ds_read_b32 v164, v49 offset:192
    v_mfma_f32_16x16x32_bf16 v[124:127], v[184:187], a[56:59], v[124:127]
    ds_read_b32 v165, v236 offset:192
    v_perm_b32 v170, v201, v200, v214
    v_mfma_f32_16x16x32_bf16 v[112:115], v[180:183], a[48:51], v[112:115]
    ds_read_b32 v166, v237 offset:192
    v_cvt_pk_bf16_f32 v14, v230, v234
    v_mfma_f32_16x16x32_bf16 v[116:119], v[180:183], a[52:55], v[116:119]
    ds_read_b32 v167, v238 offset:192
    v_mfma_f32_16x16x32_bf16 v[120:123], v[180:183], a[56:59], v[120:123]
    ds_read_b128 a[24:27], v32 offset:3264
    v_perm_b32 v171, v201, v200, v215
    v_mfma_f32_16x16x32_bf16 v[124:127], v[180:183], a[60:63], v[124:127]
    ds_read2_b32 v[160:161], v33 offset0:134 offset1:132
    v_cvt_pk_bf16_f32 v15, v231, v235
    v_mfma_f32_16x16x32_bf16 v[220:223], a[80:83], v[204:207], 0
    ds_read2_b32 v[162:163], v33 offset0:130 offset1:128
    v_mfma_f32_16x16x32_bf16 v[224:227], a[84:87], v[208:211], 0
    ds_read_b128 a[28:31], v32 offset:3776
    s_waitcnt lgkmcnt(8)
    v_mfma_f32_16x16x32_bf16 v[112:115], v[172:175], a[4:7], v[112:115]
    ds_read2_b32 a[104:105], v243 offset0:38 offset1:36
    ds_read2_b32 a[106:107], v243 offset0:34 offset1:32
    v_mfma_f32_16x16x32_bf16 v[116:119], v[172:175], a[8:11], v[116:119]
    ds_read2_b32 a[108:109], v243 offset0:70 offset1:68
    v_perm_b32 v192, v219, v218, v212
    v_mfma_f32_16x16x32_bf16 v[120:123], v[172:175], a[12:15], v[120:123]
    ds_read2_b32 a[110:111], v243 offset0:66 offset1:64
    v_perm_b32 v193, v219, v218, v213
    v_mfma_f32_16x16x32_bf16 v[124:127], v[172:175], a[16:19], v[124:127]
    ds_read2_b32 v[202:203], v47 offset0:106 offset1:104
    v_perm_b32 v194, v219, v218, v214
    v_mfma_f32_16x16x32_bf16 v[112:115], v[168:171], a[8:11], v[112:115]
    ds_read2_b32 v[200:201], v47 offset0:42 offset1:40
    v_perm_b32 v195, v219, v218, v215
    v_mfma_f32_16x16x32_bf16 v[116:119], v[168:171], a[12:15], v[116:119]
    ds_read_b128 a[36:39], v32 offset:640
    s_mov_b32 s50, 655360
    v_mfma_f32_16x16x32_bf16 v[120:123], v[168:171], a[16:19], v[120:123]
    ds_read_b128 a[40:43], v32 offset:1152
    v_perm_b32 v188, v217, v216, v212
    v_mfma_f32_16x16x32_bf16 v[124:127], v[168:171], a[20:23], v[124:127]
    buffer_store_dwordx4 a[132:135], v53, s[68:71], s50 offen
    ds_read_b128 a[44:47], v32 offset:1664
    s_waitcnt lgkmcnt(9)
    v_mfma_f32_16x16x32_bf16 v[112:115], v[164:167], a[12:15], v[112:115]
    ds_read_b128 a[48:51], v32 offset:2176
    v_perm_b32 v189, v217, v216, v213
    v_mfma_f32_16x16x32_bf16 v[116:119], v[164:167], a[16:19], v[116:119]
    ds_read_b128 a[52:55], v32 offset:2688
    v_cvt_pk_bf16_f32 v16, v220, v224
    v_mfma_f32_16x16x32_bf16 v[120:123], v[164:167], a[20:23], v[120:123]
    ds_read_b32 v184, v49 offset:256
    v_cvt_pk_bf16_f32 v17, v221, v225
    v_mfma_f32_16x16x32_bf16 v[124:127], v[164:167], a[24:27], v[124:127]
    ds_read_b32 v185, v236 offset:256
    v_perm_b32 v190, v217, v216, v214
    v_mfma_f32_16x16x32_bf16 v[112:115], v[160:163], a[16:19], v[112:115]
    ds_read_b32 v186, v237 offset:256
    v_mfma_f32_16x16x32_bf16 v[116:119], v[160:163], a[20:23], v[116:119]
    ds_read_b32 v187, v238 offset:256
    v_cvt_pk_bf16_f32 v18, v222, v226
    v_mfma_f32_16x16x32_bf16 v[120:123], v[160:163], a[24:27], v[120:123]
    ds_read_b128 a[56:59], v32 offset:3200
    v_perm_b32 v191, v217, v216, v215
    v_mfma_f32_16x16x32_bf16 v[124:127], v[160:163], a[28:31], v[124:127]
    ds_read2_b32 v[180:181], v33 offset0:166 offset1:164
    v_cvt_pk_bf16_f32 v19, v223, v227
    v_mfma_f32_16x16x32_bf16 v[228:231], a[88:91], v[204:207], 0
    ds_read2_b32 v[182:183], v33 offset0:162 offset1:160
    v_mfma_f32_16x16x32_bf16 v[232:235], a[92:95], v[208:211], 0
    ds_read_b128 a[60:63], v32 offset:3712
    s_waitcnt lgkmcnt(8)
    v_mfma_f32_16x16x32_bf16 v[112:115], v[192:195], a[36:39], v[112:115]
    ds_read_b64_tr_b16 a[136:137], v246 offset:1024
    ds_read_b64_tr_b16 a[138:139], v246 offset:17472
    v_mfma_f32_16x16x32_bf16 v[116:119], v[192:195], a[40:43], v[116:119]
    ds_read2_b32 v[218:219], v47 offset0:114 offset1:112
    v_perm_b32 v172, v203, v202, v212
    v_mfma_f32_16x16x32_bf16 v[120:123], v[192:195], a[44:47], v[120:123]
    ds_read2_b32 v[216:217], v47 offset0:50 offset1:48
    v_perm_b32 v173, v203, v202, v213
    v_mfma_f32_16x16x32_bf16 v[124:127], v[192:195], a[48:51], v[124:127]
    ds_read_b128 a[4:7], v32 offset:576
    v_perm_b32 v174, v203, v202, v214
    v_mfma_f32_16x16x32_bf16 v[112:115], v[188:191], a[40:43], v[112:115]
    ds_read_b128 a[8:11], v32 offset:1088
    v_perm_b32 v175, v203, v202, v215
    v_mfma_f32_16x16x32_bf16 v[116:119], v[188:191], a[44:47], v[116:119]
    ds_read_b128 a[12:15], v32 offset:1600
    v_perm_b32 v168, v201, v200, v212
    v_mfma_f32_16x16x32_bf16 v[120:123], v[188:191], a[48:51], v[120:123]
    ds_read_b128 a[16:19], v32 offset:2112
    v_cvt_pk_bf16_f32 v20, v228, v232
    v_mfma_f32_16x16x32_bf16 v[124:127], v[188:191], a[52:55], v[124:127]
    ds_read_b128 a[20:23], v32 offset:2624
    s_waitcnt lgkmcnt(9)
    v_mfma_f32_16x16x32_bf16 v[112:115], v[184:187], a[44:47], v[112:115]
    ds_read_b32 v164, v49 offset:320
    v_perm_b32 v169, v201, v200, v213
    v_mfma_f32_16x16x32_bf16 v[116:119], v[184:187], a[48:51], v[116:119]
    ds_read_b32 v165, v236 offset:320
    v_cvt_pk_bf16_f32 v21, v229, v233
    v_mfma_f32_16x16x32_bf16 v[120:123], v[184:187], a[52:55], v[120:123]
    ds_read_b32 v166, v237 offset:320
    v_perm_b32 v170, v201, v200, v214
    v_mfma_f32_16x16x32_bf16 v[124:127], v[184:187], a[56:59], v[124:127]
    ds_read_b32 v167, v238 offset:320
    v_cvt_pk_bf16_f32 v22, v230, v234
    v_mfma_f32_16x16x32_bf16 v[112:115], v[180:183], a[48:51], v[112:115]
    ds_read_b128 a[24:27], v32 offset:3136
    v_perm_b32 v171, v201, v200, v215
    v_mfma_f32_16x16x32_bf16 v[116:119], v[180:183], a[52:55], v[116:119]
    ds_read2_b32 v[160:161], v33 offset0:198 offset1:196
    v_cvt_pk_bf16_f32 v23, v231, v235
    v_mfma_f32_16x16x32_bf16 v[120:123], v[180:183], a[56:59], v[120:123]
    ds_read2_b32 v[162:163], v33 offset0:194 offset1:192
    v_mfma_f32_16x16x32_bf16 v[124:127], v[180:183], a[60:63], v[124:127]
    ds_read_b128 a[28:31], v32 offset:3648
    s_waitcnt lgkmcnt(8)
    v_mfma_f32_16x16x32_bf16 v[112:115], v[172:175], a[4:7], v[112:115]
    ds_read_b128 a[36:39], v32 offset:512
    v_perm_b32 v192, v219, v218, v212
    v_mfma_f32_16x16x32_bf16 v[116:119], v[172:175], a[8:11], v[116:119]
    ds_read_b128 a[40:43], v32 offset:1024
    v_perm_b32 v193, v219, v218, v213
    v_mfma_f32_16x16x32_bf16 v[120:123], v[172:175], a[12:15], v[120:123]
    ds_read_b128 a[44:47], v32 offset:1536
    v_mfma_f32_16x16x32_bf16 v[124:127], v[172:175], a[16:19], v[124:127]
    ds_read_b128 a[48:51], v32 offset:2048
    v_perm_b32 v194, v219, v218, v214
    v_mfma_f32_16x16x32_bf16 v[112:115], v[168:171], a[8:11], v[112:115]
    ds_read_b128 a[52:55], v32 offset:2560
    v_mfma_f32_16x16x32_bf16 v[116:119], v[168:171], a[12:15], v[116:119]
    ds_read_b32 v184, v49 offset:384
    v_perm_b32 v195, v219, v218, v215
    v_mfma_f32_16x16x32_bf16 v[120:123], v[168:171], a[16:19], v[120:123]
    ds_read_b32 v185, v236 offset:384
    v_mfma_f32_16x16x32_bf16 v[124:127], v[168:171], a[20:23], v[124:127]
    ds_read_b32 v186, v237 offset:384
    s_waitcnt lgkmcnt(8)
    v_mfma_f32_16x16x32_bf16 v[112:115], v[164:167], a[12:15], v[112:115]
    ds_read_b32 v187, v238 offset:384
    v_perm_b32 v188, v217, v216, v212
    v_mfma_f32_16x16x32_bf16 v[116:119], v[164:167], a[16:19], v[116:119]
    ds_read_b128 a[56:59], v32 offset:3072
    s_mov_b32 s50, 1310720
    v_mfma_f32_16x16x32_bf16 v[120:123], v[164:167], a[20:23], v[120:123]
    ds_read2_b32 v[180:181], v33 offset0:230 offset1:228
    v_mfma_f32_16x16x32_bf16 v[124:127], v[164:167], a[24:27], v[124:127]
    ds_read2_b32 v[182:183], v33 offset0:226 offset1:224
    v_perm_b32 v189, v217, v216, v213
    v_mfma_f32_16x16x32_bf16 v[112:115], v[160:163], a[16:19], v[112:115]
    ds_read_b128 a[60:63], v32 offset:3584
    v_mfma_f32_16x16x32_bf16 v[116:119], v[160:163], a[20:23], v[116:119]
    v_perm_b32 v190, v217, v216, v214
    v_mfma_f32_16x16x32_bf16 v[120:123], v[160:163], a[24:27], v[120:123]
    buffer_store_dwordx4 a[136:139], v53, s[68:71], s50 offen
    v_mfma_f32_16x16x32_bf16 v[124:127], v[160:163], a[28:31], v[124:127]
    v_mfma_f32_16x16x32_bf16 v[112:115], v[8:11], a[96:99], v[112:115]
    v_mfma_f32_16x16x32_bf16 v[116:119], v[8:11], a[100:103], v[116:119]
    v_perm_b32 v191, v217, v216, v215
    v_mfma_f32_16x16x32_bf16 v[120:123], v[8:11], a[104:107], v[120:123]
    v_mfma_f32_16x16x32_bf16 v[124:127], v[8:11], a[108:111], v[124:127]
    v_mfma_f32_16x16x32_bf16 v[116:119], v[12:15], a[96:99], v[116:119]
    s_waitcnt lgkmcnt(0)
    v_mfma_f32_16x16x32_bf16 v[112:115], v[192:195], a[36:39], v[112:115]
    ds_read_b64_tr_b16 a[140:141], v246 offset:1536
    v_mfma_f32_16x16x32_bf16 v[116:119], v[192:195], a[40:43], v[116:119]
    ds_read_b64_tr_b16 a[142:143], v246 offset:17984
    v_mfma_f32_16x16x32_bf16 v[120:123], v[192:195], a[44:47], v[120:123]
    ds_read_b128 a[0:3], v32 offset:5040
    v_mfma_f32_16x16x32_bf16 v[124:127], v[192:195], a[48:51], v[124:127]
    ds_read_b32 a228, v43 offset:3840
    v_mfma_f32_16x16x32_bf16 v[112:115], v[188:191], a[40:43], v[112:115]
    ds_read_b32 a229, v44 offset:3840
    v_mfma_f32_16x16x32_bf16 v[116:119], v[188:191], a[44:47], v[116:119]
    ds_read_b32 a230, v45 offset:3840
    v_mfma_f32_16x16x32_bf16 v[120:123], v[188:191], a[48:51], v[120:123]
    ds_read_b32 a231, v46 offset:3840
    v_mfma_f32_16x16x32_bf16 v[124:127], v[188:191], a[52:55], v[124:127]
    ds_read_b128 a[4:7], v32 offset:5552
    v_mfma_f32_16x16x32_bf16 v[112:115], v[184:187], a[44:47], v[112:115]
    ds_read_b128 a[8:11], v32 offset:6064
    v_mfma_f32_16x16x32_bf16 v[116:119], v[184:187], a[48:51], v[116:119]
    ds_read_b128 a[12:15], v32 offset:6576
    v_mfma_f32_16x16x32_bf16 v[120:123], v[184:187], a[52:55], v[120:123]
    ds_read_b128 a[16:19], v32 offset:7088
    v_mfma_f32_16x16x32_bf16 v[124:127], v[184:187], a[56:59], v[124:127]
    ds_read_b128 a[20:23], v32 offset:7600
    v_mfma_f32_16x16x32_bf16 v[112:115], v[180:183], a[48:51], v[112:115]
    v_mfma_f32_16x16x32_bf16 v[116:119], v[180:183], a[52:55], v[116:119]
    v_mfma_f32_16x16x32_bf16 v[120:123], v[180:183], a[56:59], v[120:123]
    v_mfma_f32_16x16x32_bf16 v[124:127], v[180:183], a[60:63], v[124:127]
    v_mfma_f32_16x16x32_bf16 v[120:123], v[12:15], a[100:103], v[120:123]
    v_mfma_f32_16x16x32_bf16 v[124:127], v[12:15], a[104:107], v[124:127]
    v_mfma_f32_16x16x32_bf16 v[120:123], v[16:19], a[96:99], v[120:123]
    v_mfma_f32_16x16x32_bf16 v[124:127], v[16:19], a[100:103], v[124:127]
    v_mfma_f32_16x16x32_bf16 v[124:127], v[20:23], a[96:99], v[124:127]
    s_waitcnt lgkmcnt(0)
    v_mfma_f32_16x16x32_bf16 v[144:147], a[228:231], a[0:3], 0
    ds_read_b128 a[64:67], v32 offset:5024
    s_mov_b32 s50, 1966080
    v_mfma_f32_16x16x32_bf16 v[148:151], a[228:231], a[4:7], 0
    buffer_store_dwordx4 a[140:143], v53, s[68:71], s50 offen
    ds_read_b128 a[68:71], v32 offset:5040
    v_mfma_f32_16x16x32_bf16 v[144:147], v[64:67], a[4:7], v[144:147]
    ds_read_b128 a[72:75], v32 offset:5536
    v_cvt_pk_bf16_f32 v54, v112, v113
    v_mfma_f32_16x16x32_bf16 v[148:151], v[64:67], a[8:11], v[148:151]
    ds_read_b128 a[76:79], v32 offset:5552
    v_mfma_f32_16x16x32_bf16 v[144:147], a[160:163], a[8:11], v[144:147]
    ds_read_b128 a[36:39], v32 offset:5488
    v_cvt_pk_bf16_f32 v55, v114, v115
    v_mfma_f32_16x16x32_bf16 v[148:151], a[160:163], a[12:15], v[148:151]
    ds_read_b128 a[40:43], v32 offset:6000
    v_cvt_pk_bf16_f32 v56, v116, v117
    v_mfma_f32_16x16x32_bf16 v[144:147], a[164:167], a[12:15], v[144:147]
    ds_read_b128 a[44:47], v32 offset:6512
    v_mfma_f32_16x16x32_bf16 v[148:151], a[164:167], a[16:19], v[148:151]
    ds_read_b128 a[48:51], v32 offset:7024
    v_cvt_pk_bf16_f32 v57, v118, v119
    v_mfma_f32_16x16x32_bf16 v[144:147], a[168:171], a[16:19], v[144:147]
    ds_read_b128 a[52:55], v32 offset:7536
    v_mfma_f32_16x16x32_bf16 v[148:151], a[168:171], a[20:23], v[148:151]
    s_waitcnt lgkmcnt(4)
    v_mfma_f32_16x16x32_bf16 v[144:147], v[68:71], a[36:39], v[144:147]
    ds_read_b128 a[80:83], v32 offset:6048
    ds_read_b128 a[84:87], v32 offset:6064
    s_waitcnt lgkmcnt(5)
    v_mfma_f32_16x16x32_bf16 v[148:151], v[68:71], a[40:43], v[148:151]
    ds_read_b128 a[88:91], v32 offset:6560
    v_cvt_pk_bf16_f32 v58, v120, v121
    v_mfma_f32_16x16x32_bf16 v[144:147], v[72:75], a[40:43], v[144:147]
    ds_read_b128 a[92:95], v32 offset:6576
    s_waitcnt lgkmcnt(6)
    v_mfma_f32_16x16x32_bf16 v[148:151], v[72:75], a[44:47], v[148:151]
    ds_read_b128 a[4:7], v32 offset:5424
    v_cvt_pk_bf16_f32 v59, v122, v123
    v_mfma_f32_16x16x32_bf16 v[144:147], a[172:175], a[44:47], v[144:147]
    ds_read_b128 a[8:11], v32 offset:5936
    s_waitcnt lgkmcnt(6)
    v_mfma_f32_16x16x32_bf16 v[148:151], a[172:175], a[48:51], v[148:151]
    ds_read_b128 a[12:15], v32 offset:6448
    v_cvt_pk_bf16_f32 v60, v124, v125
    v_mfma_f32_16x16x32_bf16 v[144:147], a[176:179], a[48:51], v[144:147]
    ds_read_b128 a[16:19], v32 offset:6960
    v_cvt_pk_bf16_f32 v61, v126, v127
    v_mfma_f32_16x16x32_bf16 v[148:151], a[176:179], a[52:55], v[148:151]
    ds_read_b128 a[20:23], v32 offset:7472
    v_mfma_f32_16x16x32_bf16 v[220:223], a[64:67], v[204:207], 0
    ds_write_b64 v245, v[54:55] offset:2048
    ds_write_b64 v245, v[56:57] offset:2560
    v_mfma_f32_16x16x32_bf16 v[224:227], a[68:71], v[208:211], 0
    ds_write_b64 v245, v[58:59] offset:3072
    ds_write_b64 v245, v[60:61] offset:3584
    s_waitcnt lgkmcnt(8)
    v_mfma_f32_16x16x32_bf16 v[144:147], v[76:79], a[4:7], v[144:147]
    ds_read_b32 a96, v239 offset:3840
    s_waitcnt lgkmcnt(8)
    v_mfma_f32_16x16x32_bf16 v[148:151], v[76:79], a[8:11], v[148:151]
    ds_read_b32 a97, v240 offset:3840
    v_cvt_pk_bf16_f32 v8, v220, v224
    v_mfma_f32_16x16x32_bf16 v[144:147], v[80:83], a[8:11], v[144:147]
    ds_read_b32 a98, v241 offset:3840
    s_waitcnt lgkmcnt(8)
    v_mfma_f32_16x16x32_bf16 v[148:151], v[80:83], a[12:15], v[148:151]
    ds_read_b32 a99, v242 offset:3840
    v_cvt_pk_bf16_f32 v9, v221, v225
    v_mfma_f32_16x16x32_bf16 v[144:147], a[180:183], a[12:15], v[144:147]
    ds_read_b128 a[36:39], v32 offset:5360
    v_cvt_pk_bf16_f32 v10, v222, v226
    v_mfma_f32_16x16x32_bf16 v[148:151], a[180:183], a[16:19], v[148:151]
    ds_read_b128 a[40:43], v32 offset:5872
    v_mfma_f32_16x16x32_bf16 v[144:147], a[184:187], a[16:19], v[144:147]
WB_P5:
    s_cbranch_execz WB_R
    s_nop 0
    ds_read_b128 a[44:47], v32 offset:6384
    s_waitcnt lgkmcnt(11)
    v_mfma_f32_16x16x32_bf16 v[148:151], a[184:187], a[20:23], v[148:151]
    ds_read_b128 a[48:51], v32 offset:6896
    v_cvt_pk_bf16_f32 v11, v223, v227
    v_mfma_f32_16x16x32_bf16 v[228:231], a[72:75], v[204:207], 0
    ds_read_b128 a[52:55], v32 offset:7408
    v_mfma_f32_16x16x32_bf16 v[232:235], a[76:79], v[208:211], 0
    s_waitcnt lgkmcnt(4)
    v_mfma_f32_16x16x32_bf16 v[144:147], v[84:87], a[36:39], v[144:147]
    ds_read2_b32 a[100:101], v244 offset0:6 offset1:4
    s_waitcnt lgkmcnt(4)
    v_mfma_f32_16x16x32_bf16 v[148:151], v[84:87], a[40:43], v[148:151]
    ds_read2_b32 a[102:103], v244 offset0:2 offset1:0
    s_nop 1
    v_cvt_pk_bf16_f32 v12, v228, v232
    v_mfma_f32_16x16x32_bf16 v[144:147], v[88:91], a[40:43], v[144:147]
    ds_read_b128 a[4:7], v32 offset:5296
    s_waitcnt lgkmcnt(5)
    v_mfma_f32_16x16x32_bf16 v[148:151], v[88:91], a[44:47], v[148:151]
    ds_read_b128 a[8:11], v32 offset:5808
    v_cvt_pk_bf16_f32 v13, v229, v233
    v_mfma_f32_16x16x32_bf16 v[144:147], a[188:191], a[44:47], v[144:147]
    ds_read_b128 a[12:15], v32 offset:6320
    s_waitcnt lgkmcnt(5)
    v_mfma_f32_16x16x32_bf16 v[148:151], a[188:191], a[48:51], v[148:151]
    ds_read_b128 a[16:19], v32 offset:6832
    v_cvt_pk_bf16_f32 v14, v230, v234
    v_mfma_f32_16x16x32_bf16 v[144:147], a[192:195], a[48:51], v[144:147]
    ds_read_b128 a[20:23], v32 offset:7344
    v_cvt_pk_bf16_f32 v15, v231, v235
    v_mfma_f32_16x16x32_bf16 v[148:151], a[192:195], a[52:55], v[148:151]
    v_mfma_f32_16x16x32_bf16 v[220:223], a[80:83], v[204:207], 0
    v_mfma_f32_16x16x32_bf16 v[224:227], a[84:87], v[208:211], 0
    s_waitcnt lgkmcnt(3)
    v_mfma_f32_16x16x32_bf16 v[144:147], v[92:95], a[4:7], v[144:147]
    ds_read2_b32 a[104:105], v244 offset0:38 offset1:36
    s_nop 4
    v_cvt_pk_bf16_f32 v16, v220, v224
    v_mfma_f32_16x16x32_bf16 v[148:151], v[92:95], a[8:11], v[148:151]
    ds_read2_b32 a[106:107], v244 offset0:34 offset1:32
    v_cvt_pk_bf16_f32 v17, v221, v225
    v_mfma_f32_16x16x32_bf16 v[144:147], v[248:251], a[8:11], v[144:147]
    ds_read2_b32 a[108:109], v244 offset0:70 offset1:68
    s_waitcnt lgkmcnt(3)
    v_mfma_f32_16x16x32_bf16 v[148:151], v[248:251], a[12:15], v[148:151]
    ds_read2_b32 a[110:111], v244 offset0:66 offset1:64
    v_mfma_f32_16x16x32_bf16 v[144:147], a[196:199], a[12:15], v[144:147]
    ds_read_b128 a[36:39], v32 offset:5232
    v_cvt_pk_bf16_f32 v18, v222, v226
    v_mfma_f32_16x16x32_bf16 v[148:151], a[196:199], a[16:19], v[148:151]
    ds_read_b128 a[40:43], v32 offset:5744
    v_mfma_f32_16x16x32_bf16 v[144:147], a[200:203], a[16:19], v[144:147]
    ds_read_b128 a[44:47], v32 offset:6256
    v_cvt_pk_bf16_f32 v19, v223, v227
    v_mfma_f32_16x16x32_bf16 v[148:151], a[200:203], a[20:23], v[148:151]
    ds_read_b128 a[48:51], v32 offset:6768
    v_mfma_f32_16x16x32_bf16 v[228:231], a[88:91], v[204:207], 0
    ds_read_b128 a[52:55], v32 offset:7280
    v_mfma_f32_16x16x32_bf16 v[232:235], a[92:95], v[208:211], 0
    s_waitcnt lgkmcnt(4)
    v_mfma_f32_16x16x32_bf16 v[144:147], v[252:255], a[36:39], v[144:147]
    ds_read_b128 a[4:7], v32 offset:5168
    s_waitcnt lgkmcnt(4)
    v_mfma_f32_16x16x32_bf16 v[148:151], v[252:255], a[40:43], v[148:151]
    ds_read_b128 a[8:11], v32 offset:5680
    s_nop 1
    v_cvt_pk_bf16_f32 v20, v228, v232
    v_mfma_f32_16x16x32_bf16 v[144:147], v[4:7], a[40:43], v[144:147]
    ds_read_b128 a[12:15], v32 offset:6192
    s_waitcnt lgkmcnt(5)
    v_mfma_f32_16x16x32_bf16 v[148:151], v[4:7], a[44:47], v[148:151]
    ds_read_b128 a[16:19], v32 offset:6704
    v_cvt_pk_bf16_f32 v21, v229, v233
    v_mfma_f32_16x16x32_bf16 v[144:147], a[204:207], a[44:47], v[144:147]
    ds_read_b128 a[20:23], v32 offset:7216
    s_waitcnt lgkmcnt(5)
    v_mfma_f32_16x16x32_bf16 v[148:151], a[204:207], a[48:51], v[148:151]
    v_cvt_pk_bf16_f32 v22, v230, v234
    v_cvt_pk_bf16_f32 v23, v231, v235
    v_mfma_f32_16x16x32_bf16 v[144:147], a[208:211], a[48:51], v[144:147]
    v_mfma_f32_16x16x32_bf16 v[148:151], a[208:211], a[52:55], v[148:151]
    s_waitcnt lgkmcnt(3)
    v_mfma_f32_16x16x32_bf16 v[144:147], v[96:99], a[4:7], v[144:147]
    ds_read_b128 a[36:39], v32 offset:5104
    v_mfma_f32_16x16x32_bf16 v[148:151], v[96:99], a[8:11], v[148:151]
    ds_read_b128 a[40:43], v32 offset:5616
    v_mfma_f32_16x16x32_bf16 v[144:147], v[100:103], a[8:11], v[144:147]
    ds_read_b128 a[44:47], v32 offset:6128
    s_waitcnt lgkmcnt(3)
    v_mfma_f32_16x16x32_bf16 v[148:151], v[100:103], a[12:15], v[148:151]
    ds_read_b128 a[48:51], v32 offset:6640
    v_mfma_f32_16x16x32_bf16 v[144:147], a[212:215], a[12:15], v[144:147]
    ds_read_b128 a[52:55], v32 offset:7152
    v_mfma_f32_16x16x32_bf16 v[148:151], a[212:215], a[16:19], v[148:151]
    v_mfma_f32_16x16x32_bf16 v[144:147], a[216:219], a[16:19], v[144:147]
    v_mfma_f32_16x16x32_bf16 v[148:151], a[216:219], a[20:23], v[148:151]
    v_mfma_f32_16x16x32_bf16 v[144:147], v[8:11], a[96:99], v[144:147]
    s_waitcnt lgkmcnt(2)
    v_mfma_f32_16x16x32_bf16 v[144:147], v[104:107], a[36:39], v[144:147]
    ds_read_b128 a[8:11], v32 offset:6064
    v_mfma_f32_16x16x32_bf16 v[148:151], v[104:107], a[40:43], v[148:151]
    ds_read_b128 a[12:15], v32 offset:6576
    v_mfma_f32_16x16x32_bf16 v[144:147], v[108:111], a[40:43], v[144:147]
    ds_read_b128 a[16:19], v32 offset:7088
    v_mfma_f32_16x16x32_bf16 v[148:151], v[108:111], a[44:47], v[148:151]
    ds_read_b128 a[20:23], v32 offset:7600
    v_mfma_f32_16x16x32_bf16 v[144:147], a[220:223], a[44:47], v[144:147]
    ds_read_b128 a[24:27], v32 offset:8112
    s_waitcnt lgkmcnt(5)
    v_mfma_f32_16x16x32_bf16 v[148:151], a[220:223], a[48:51], v[148:151]
    ds_read_b128 a[28:31], v32 offset:8624
    v_mfma_f32_16x16x32_bf16 v[144:147], a[224:227], a[48:51], v[144:147]
    v_mfma_f32_16x16x32_bf16 v[148:151], a[224:227], a[52:55], v[148:151]
    v_mfma_f32_16x16x32_bf16 v[148:151], v[8:11], a[100:103], v[148:151]
    v_mfma_f32_16x16x32_bf16 v[148:151], v[12:15], a[96:99], v[148:151]
    s_waitcnt lgkmcnt(2)
    v_mfma_f32_16x16x32_bf16 v[152:155], a[228:231], a[8:11], 0
    ds_read_b128 a[44:47], v32 offset:6512
    s_nop 1
    v_cvt_pk_bf16_f32 v54, v144, v145
    v_mfma_f32_16x16x32_bf16 v[156:159], a[228:231], a[12:15], 0
    ds_read_b128 a[48:51], v32 offset:7024
    v_cvt_pk_bf16_f32 v55, v146, v147
    v_mfma_f32_16x16x32_bf16 v[152:155], v[64:67], a[12:15], v[152:155]
    ds_read_b128 a[52:55], v32 offset:7536
    v_mfma_f32_16x16x32_bf16 v[156:159], v[64:67], a[16:19], v[156:159]
    ds_read_b128 a[56:59], v32 offset:8048
    v_cvt_pk_bf16_f32 v56, v148, v149
    v_mfma_f32_16x16x32_bf16 v[152:155], a[160:163], a[16:19], v[152:155]
    ds_read_b128 a[60:63], v32 offset:8560
    v_mfma_f32_16x16x32_bf16 v[156:159], a[160:163], a[20:23], v[156:159]
    v_cvt_pk_bf16_f32 v57, v150, v151
    v_mfma_f32_16x16x32_bf16 v[152:155], a[164:167], a[20:23], v[152:155]
    s_waitcnt lgkmcnt(5)
    v_mfma_f32_16x16x32_bf16 v[156:159], a[164:167], a[24:27], v[156:159]
    v_mfma_f32_16x16x32_bf16 v[152:155], a[168:171], a[24:27], v[152:155]
    ds_write_b64 v245, v[54:55] offset:6160
    v_mfma_f32_16x16x32_bf16 v[156:159], a[168:171], a[28:31], v[156:159]
    ds_write_b64 v245, v[56:57] offset:6672
    s_waitcnt lgkmcnt(0)
    s_barrier
    v_mfma_f32_16x16x32_bf16 v[152:155], v[68:71], a[44:47], v[152:155]
    ds_read_b64_tr_b16 a[144:145], v246 offset:2048
    v_mfma_f32_16x16x32_bf16 v[156:159], v[68:71], a[48:51], v[156:159]
    ds_read_b64_tr_b16 a[146:147], v246 offset:18496
    v_mfma_f32_16x16x32_bf16 v[152:155], v[72:75], a[48:51], v[152:155]
    ds_read_b128 a[12:15], v32 offset:6448
    v_mfma_f32_16x16x32_bf16 v[156:159], v[72:75], a[52:55], v[156:159]
    ds_read_b128 a[16:19], v32 offset:6960
    v_mfma_f32_16x16x32_bf16 v[152:155], a[172:175], a[52:55], v[152:155]
    ds_read_b128 a[20:23], v32 offset:7472
    v_mfma_f32_16x16x32_bf16 v[156:159], a[172:175], a[56:59], v[156:159]
    ds_read_b128 a[24:27], v32 offset:7984
    v_mfma_f32_16x16x32_bf16 v[152:155], a[176:179], a[56:59], v[152:155]
    ds_read_b128 a[28:31], v32 offset:8496
    v_mfma_f32_16x16x32_bf16 v[156:159], a[176:179], a[60:63], v[156:159]
    s_waitcnt lgkmcnt(4)
    v_mfma_f32_16x16x32_bf16 v[152:155], v[76:79], a[12:15], v[152:155]
    ds_read_b128 a[44:47], v32 offset:6384
    s_waitcnt lgkmcnt(4)
    v_mfma_f32_16x16x32_bf16 v[156:159], v[76:79], a[16:19], v[156:159]
    ds_read_b128 a[48:51], v32 offset:6896
    s_mov_b32 s50, 2621440
    v_mfma_f32_16x16x32_bf16 v[152:155], v[80:83], a[16:19], v[152:155]
    buffer_store_dwordx4 a[144:147], v53, s[68:71], s50 offen
    ds_read_b128 a[52:55], v32 offset:7408
    s_waitcnt lgkmcnt(5)
    v_mfma_f32_16x16x32_bf16 v[156:159], v[80:83], a[20:23], v[156:159]
    ds_read_b128 a[56:59], v32 offset:7920
    v_mfma_f32_16x16x32_bf16 v[152:155], a[180:183], a[20:23], v[152:155]
    ds_read_b128 a[60:63], v32 offset:8432
    s_waitcnt lgkmcnt(5)
    v_mfma_f32_16x16x32_bf16 v[156:159], a[180:183], a[24:27], v[156:159]
    v_mfma_f32_16x16x32_bf16 v[152:155], a[184:187], a[24:27], v[152:155]
    v_mfma_f32_16x16x32_bf16 v[156:159], a[184:187], a[28:31], v[156:159]
    s_waitcnt lgkmcnt(3)
    v_mfma_f32_16x16x32_bf16 v[152:155], v[84:87], a[44:47], v[152:155]
    ds_read_b64_tr_b16 a[148:149], v246 offset:2560
    v_mfma_f32_16x16x32_bf16 v[156:159], v[84:87], a[48:51], v[156:159]
    ds_read_b64_tr_b16 a[150:151], v246 offset:19008
    v_mfma_f32_16x16x32_bf16 v[152:155], v[88:91], a[48:51], v[152:155]
    ds_read_b128 a[12:15], v32 offset:6320
    s_waitcnt lgkmcnt(3)
    v_mfma_f32_16x16x32_bf16 v[156:159], v[88:91], a[52:55], v[156:159]
    ds_read_b128 a[16:19], v32 offset:6832
    v_mfma_f32_16x16x32_bf16 v[152:155], a[188:191], a[52:55], v[152:155]
    ds_read_b128 a[20:23], v32 offset:7344
    v_mfma_f32_16x16x32_bf16 v[156:159], a[188:191], a[56:59], v[156:159]
    ds_read_b128 a[24:27], v32 offset:7856
    v_mfma_f32_16x16x32_bf16 v[152:155], a[192:195], a[56:59], v[152:155]
    ds_read_b128 a[28:31], v32 offset:8368
    v_mfma_f32_16x16x32_bf16 v[156:159], a[192:195], a[60:63], v[156:159]
    s_waitcnt lgkmcnt(4)
    v_mfma_f32_16x16x32_bf16 v[152:155], v[92:95], a[12:15], v[152:155]
    ds_read_b128 a[44:47], v32 offset:6256
    s_waitcnt lgkmcnt(4)
    v_mfma_f32_16x16x32_bf16 v[156:159], v[92:95], a[16:19], v[156:159]
    ds_read_b128 a[48:51], v32 offset:6768
    s_mov_b32 s50, 3276800
    v_mfma_f32_16x16x32_bf16 v[152:155], v[248:251], a[16:19], v[152:155]
    buffer_store_dwordx4 a[148:151], v53, s[68:71], s50 offen
    ds_read_b128 a[52:55], v32 offset:7280
    s_waitcnt lgkmcnt(5)
    v_mfma_f32_16x16x32_bf16 v[156:159], v[248:251], a[20:23], v[156:159]
    ds_read_b128 a[56:59], v32 offset:7792
    v_mfma_f32_16x16x32_bf16 v[152:155], a[196:199], a[20:23], v[152:155]
    ds_read_b128 a[60:63], v32 offset:8304
    s_waitcnt lgkmcnt(5)
    v_mfma_f32_16x16x32_bf16 v[156:159], a[196:199], a[24:27], v[156:159]
    v_mfma_f32_16x16x32_bf16 v[152:155], a[200:203], a[24:27], v[152:155]
    v_mfma_f32_16x16x32_bf16 v[156:159], a[200:203], a[28:31], v[156:159]
    s_waitcnt lgkmcnt(3)
    v_mfma_f32_16x16x32_bf16 v[152:155], v[252:255], a[44:47], v[152:155]
    ds_read_b128 a[12:15], v32 offset:6192
    v_mfma_f32_16x16x32_bf16 v[156:159], v[252:255], a[48:51], v[156:159]
    ds_read_b128 a[16:19], v32 offset:6704
    v_mfma_f32_16x16x32_bf16 v[152:155], v[4:7], a[48:51], v[152:155]
    ds_read_b128 a[20:23], v32 offset:7216
    s_waitcnt lgkmcnt(3)
    v_mfma_f32_16x16x32_bf16 v[156:159], v[4:7], a[52:55], v[156:159]
    ds_read_b128 a[24:27], v32 offset:7728
    v_mfma_f32_16x16x32_bf16 v[152:155], a[204:207], a[52:55], v[152:155]
    ds_read_b128 a[28:31], v32 offset:8240
    v_mfma_f32_16x16x32_bf16 v[156:159], a[204:207], a[56:59], v[156:159]
    v_mfma_f32_16x16x32_bf16 v[152:155], a[208:211], a[56:59], v[152:155]
    v_mfma_f32_16x16x32_bf16 v[156:159], a[208:211], a[60:63], v[156:159]
    s_waitcnt lgkmcnt(3)
    v_mfma_f32_16x16x32_bf16 v[152:155], v[96:99], a[12:15], v[152:155]
    ds_read_b128 a[44:47], v32 offset:6128
    v_mfma_f32_16x16x32_bf16 v[156:159], v[96:99], a[16:19], v[156:159]
    ds_read_b128 a[48:51], v32 offset:6640
    v_mfma_f32_16x16x32_bf16 v[152:155], v[100:103], a[16:19], v[152:155]
    ds_read_b128 a[52:55], v32 offset:7152
    s_waitcnt lgkmcnt(3)
    v_mfma_f32_16x16x32_bf16 v[156:159], v[100:103], a[20:23], v[156:159]
    ds_read_b128 a[56:59], v32 offset:7664
    v_mfma_f32_16x16x32_bf16 v[152:155], a[212:215], a[20:23], v[152:155]
    ds_read_b128 a[60:63], v32 offset:8176
    v_mfma_f32_16x16x32_bf16 v[156:159], a[212:215], a[24:27], v[156:159]
    v_mfma_f32_16x16x32_bf16 v[152:155], a[216:219], a[24:27], v[152:155]
    v_mfma_f32_16x16x32_bf16 v[156:159], a[216:219], a[28:31], v[156:159]
    v_mfma_f32_16x16x32_bf16 v[152:155], v[8:11], a[104:107], v[152:155]
    v_mfma_f32_16x16x32_bf16 v[156:159], v[8:11], a[108:111], v[156:159]
    v_mfma_f32_16x16x32_bf16 v[152:155], v[12:15], a[100:103], v[152:155]
    s_waitcnt lgkmcnt(0)
    v_mfma_f32_16x16x32_bf16 v[152:155], v[104:107], a[44:47], v[152:155]
    v_mfma_f32_16x16x32_bf16 v[156:159], v[104:107], a[48:51], v[156:159]
    v_mfma_f32_16x16x32_bf16 v[152:155], v[108:111], a[48:51], v[152:155]
    v_mfma_f32_16x16x32_bf16 v[156:159], v[108:111], a[52:55], v[156:159]
    v_mfma_f32_16x16x32_bf16 v[152:155], a[220:223], a[52:55], v[152:155]
    v_mfma_f32_16x16x32_bf16 v[156:159], a[220:223], a[56:59], v[156:159]
    v_mfma_f32_16x16x32_bf16 v[152:155], a[224:227], a[56:59], v[152:155]
    v_mfma_f32_16x16x32_bf16 v[156:159], a[224:227], a[60:63], v[156:159]
    v_mfma_f32_16x16x32_bf16 v[156:159], v[12:15], a[104:107], v[156:159]
    v_mfma_f32_16x16x32_bf16 v[152:155], v[16:19], a[96:99], v[152:155]
    v_mfma_f32_16x16x32_bf16 v[156:159], v[16:19], a[100:103], v[156:159]
    v_mfma_f32_16x16x32_bf16 v[156:159], v[20:23], a[96:99], v[156:159]
    s_nop 5
    s_nop 0
    v_cvt_pk_bf16_f32 v58, v152, v153
    v_cvt_pk_bf16_f32 v59, v154, v155
    v_cvt_pk_bf16_f32 v60, v156, v157
    v_cvt_pk_bf16_f32 v61, v158, v159
    ds_write_b64 v245, v[58:59] offset:7184
    ds_write_b64 v245, v[60:61] offset:7696
    s_waitcnt lgkmcnt(0)
    s_barrier
    ds_read_b64_tr_b16 a[152:153], v246 offset:3072
    ds_read_b64_tr_b16 a[154:155], v246 offset:19520
    ds_read_b64_tr_b16 a[156:157], v246 offset:3584
    ds_read_b64_tr_b16 a[158:159], v246 offset:20032
    s_mov_b32 s50, 3932160
    s_waitcnt lgkmcnt(2)
    buffer_store_dwordx4 a[152:155], v53, s[68:71], s50 offen
    s_mov_b32 s50, 4587520
    s_waitcnt lgkmcnt(0)
    buffer_store_dwordx4 a[156:159], v53, s[68:71], s50 offen
    s_endpgm
    .p2align 7
.type L_tbl,@object
.size L_tbl, 8192
L_tbl:
.long 0x00000000, 0x00000000, 0x3f803f80, 0x3f803f80
.long 0x00000000, 0x00000000, 0x3f800000, 0x3f803f80
.long 0x00000000, 0x00000000, 0x00000000, 0x3f803f80
.long 0x00000000, 0x00000000, 0x00000000, 0x3f800000
.long 0x00000000, 0x00000000, 0x00000000, 0x00000000
.long 0x00000000, 0x00000000, 0x00000000, 0x00000000
.long 0x00000000, 0x00000000, 0x00000000, 0x00000000
.long 0x00000000, 0x00000000, 0x00000000, 0x00000000
.long 0x00000000, 0x00000000, 0x00000000, 0x00000000
.long 0x00000000, 0x00000000, 0x00000000, 0x00000000
.long 0x00000000, 0x00000000, 0x00000000, 0x00000000
.long 0x00000000, 0x00000000, 0x00000000, 0x00000000
.long 0x00000000, 0x00000000, 0x00000000, 0x00000000
.long 0x00000000, 0x00000000, 0x00000000, 0x00000000
.long 0x00000000, 0x00000000, 0x00000000, 0x00000000
.long 0x00000000, 0x00000000, 0x00000000, 0x00000000
.long 0x3f803f80, 0x3f803f80, 0x00003f80, 0x00000000
.long 0x3f803f80, 0x3f803f80, 0x3f803f80, 0x00000000
.long 0x3f803f80, 0x3f803f80, 0x3f803f80, 0x00003f80
.long 0x3f803f80, 0x3f803f80, 0x3f803f80, 0x3f803f80
.long 0x3f803f80, 0x3f803f80, 0x3f803f80, 0x3f803f80
.long 0x3f800000, 0x3f803f80, 0x3f803f80, 0x3f803f80
.long 0x00000000, 0x3f803f80, 0x3f803f80, 0x3f803f80
.long 0x00000000, 0x3f800000, 0x3f803f80, 0x3f803f80
.long 0x00000000, 0x00000000, 0x3f803f80, 0x3f803f80
.long 0x00000000, 0x00000000, 0x3f800000, 0x3f803f80
.long 0x00000000, 0x00000000, 0x00000000, 0x3f803f80
.long 0x00000000, 0x00000000, 0x00000000, 0x3f800000
.long 0x00000000, 0x00000000, 0x00000000, 0x00000000
.long 0x00000000, 0x00000000, 0x00000000, 0x00000000
.long 0x00000000, 0x00000000, 0x00000000, 0x00000000
.long 0x00000000, 0x00000000, 0x00000000, 0x00000000
.long 0x00000000, 0x00000000, 0x00000000, 0x00000000
.long 0x00000000, 0x00000000, 0x00000000, 0x00000000
.long 0x00000000, 0x00000000, 0x00000000, 0x00000000
.long 0x00000000, 0x00000000, 0x00000000, 0x00000000
.long 0x00003f80, 0x00000000, 0x00000000, 0x00000000
.long 0x3f803f80, 0x00000000, 0x00000000, 0x00000000
.long 0x3f803f80, 0x00003f80, 0x00000000, 0x00000000
.long 0x3f803f80, 0x3f803f80, 0x00000000, 0x00000000
.long 0x3f803f80, 0x3f803f80, 0x00003f80, 0x00000000
.long 0x3f803f80, 0x3f803f80, 0x3f803f80, 0x00000000
.long 0x3f803f80, 0x3f803f80, 0x3f803f80, 0x00003f80
.long 0x3f803f80, 0x3f803f80, 0x3f803f80, 0x3f803f80
.long 0x3f803f80, 0x3f803f80, 0x3f803f80, 0x3f803f80
.long 0x3f800000, 0x3f803f80, 0x3f803f80, 0x3f803f80
.long 0x00000000, 0x3f803f80, 0x3f803f80, 0x3f803f80
.long 0x00000000, 0x3f800000, 0x3f803f80, 0x3f803f80
.long 0x00000000, 0x00000000, 0x00000000, 0x00000000
.long 0x00000000, 0x00000000, 0x00000000, 0x00000000
.long 0x00000000, 0x00000000, 0x00000000, 0x00000000
.long 0x00000000, 0x00000000, 0x00000000, 0x00000000
.long 0x00000000, 0x00000000, 0x00000000, 0x00000000
.long 0x00000000, 0x00000000, 0x00000000, 0x00000000
.long 0x00000000, 0x00000000, 0x00000000, 0x00000000
.long 0x00000000, 0x00000000, 0x00000000, 0x00000000
.long 0x00000000, 0x00000000, 0x00000000, 0x00000000
.long 0x00000000, 0x00000000, 0x00000000, 0x00000000
.long 0x00000000, 0x00000000, 0x00000000, 0x00000000
.long 0x00000000, 0x00000000, 0x00000000, 0x00000000
.long 0x00003f80, 0x00000000, 0x00000000, 0x00000000
.long 0x3f803f80, 0x00000000, 0x00000000, 0x00000000
.long 0x3f803f80, 0x00003f80, 0x00000000, 0x00000000
.long 0x3f803f80, 0x3f803f80, 0x00000000, 0x00000000
.long 0x00000000, 0x00000000, 0x3f800000, 0x3f803f80
.long 0x00000000, 0x00000000, 0x00000000, 0x3f803f80
.long 0x00000000, 0x00000000, 0x00000000, 0x3f800000
.long 0x00000000, 0x00000000, 0x00000000, 0x00000000
.long 0x00000000, 0x00000000, 0x00000000, 0x00000000
.long 0x00000000, 0x00000000, 0x00000000, 0x00000000
.long 0x00000000, 0x00000000, 0x00000000, 0x00000000
.long 0x00000000, 0x00000000, 0x00000000, 0x00000000
.long 0x00000000, 0x00000000, 0x00000000, 0x00000000
.long 0x00000000, 0x00000000, 0x00000000, 0x00000000
.long 0x00000000, 0x00000000, 0x00000000, 0x00000000
.long 0x00000000, 0x00000000, 0x00000000, 0x00000000
.long 0x00000000, 0x00000000, 0x00000000, 0x00000000
.long 0x00000000, 0x00000000, 0x00000000, 0x00000000
.long 0x00000000, 0x00000000, 0x00000000, 0x00000000
.long 0x00000000, 0x00000000, 0x00000000, 0x00000000
.long 0x3f803f80, 0x3f803f80, 0x00000000, 0x00000000
.long 0x3f803f80, 0x3f803f80, 0x00003f80, 0x00000000
.long 0x3f803f80, 0x3f803f80, 0x3f803f80, 0x00000000
.long 0x3f803f80, 0x3f803f80, 0x3f803f80, 0x00003f80
.long 0x3f800000, 0x3f803f80, 0x3f803f80, 0x3f803f80
.long 0x00000000, 0x3f803f80, 0x3f803f80, 0x3f803f80
.long 0x00000000, 0x3f800000, 0x3f803f80, 0x3f803f80
.long 0x00000000, 0x00000000, 0x3f803f80, 0x3f803f80
.long 0x00000000, 0x00000000, 0x3f800000, 0x3f803f80
.long 0x00000000, 0x00000000, 0x00000000, 0x3f803f80
.long 0x00000000, 0x00000000, 0x00000000, 0x3f800000
.long 0x00000000, 0x00000000, 0x00000000, 0x00000000
.long 0x00000000, 0x00000000, 0x00000000, 0x00000000
.long 0x00000000, 0x00000000, 0x00000000, 0x00000000
.long 0x00000000, 0x00000000, 0x00000000, 0x00000000
.long 0x00000000, 0x00000000, 0x00000000, 0x00000000
.long 0x00000000, 0x00000000, 0x00000000, 0x00000000
.long 0x00000000, 0x00000000, 0x00000000, 0x00000000
.long 0x00000000, 0x00000000, 0x00000000, 0x00000000
.long 0x00000000, 0x00000000, 0x00000000, 0x00000000
.long 0x00000000, 0x00000000, 0x00000000, 0x00000000
.long 0x00003f80, 0x00000000, 0x00000000, 0x00000000
.long 0x3f803f80, 0x00000000, 0x00000000, 0x00000000
.long 0x3f803f80, 0x00003f80, 0x00000000, 0x00000000
.long 0x3f803f80, 0x3f803f80, 0x00000000, 0x00000000
.long 0x3f803f80, 0x3f803f80, 0x00003f80, 0x00000000
.long 0x3f803f80, 0x3f803f80, 0x3f803f80, 0x00000000
.long 0x3f803f80, 0x3f803f80, 0x3f803f80, 0x00003f80
.long 0x3f800000, 0x3f803f80, 0x3f803f80, 0x3f803f80
.long 0x00000000, 0x3f803f80, 0x3f803f80, 0x3f803f80
.long 0x00000000, 0x3f800000, 0x3f803f80, 0x3f803f80
.long 0x00000000, 0x00000000, 0x3f803f80, 0x3f803f80
.long 0x00000000, 0x00000000, 0x00000000, 0x00000000
.long 0x00000000, 0x00000000, 0x00000000, 0x00000000
.long 0x00000000, 0x00000000, 0x00000000, 0x00000000
.long 0x00000000, 0x00000000, 0x00000000, 0x00000000
.long 0x00000000, 0x00000000, 0x00000000, 0x00000000
.long 0x00000000, 0x00000000, 0x00000000, 0x00000000
.long 0x00000000, 0x00000000, 0x00000000, 0x00000000
.long 0x00000000, 0x00000000, 0x00000000, 0x00000000
.long 0x00000000, 0x00000000, 0x00000000, 0x00000000
.long 0x00000000, 0x00000000, 0x00000000, 0x00000000
.long 0x00000000, 0x00000000, 0x00000000, 0x00000000
.long 0x00000000, 0x00000000, 0x00000000, 0x00000000
.long 0x00000000, 0x00000000, 0x00000000, 0x00000000
.long 0x00003f80, 0x00000000, 0x00000000, 0x00000000
.long 0x3f803f80, 0x00000000, 0x00000000, 0x00000000
.long 0x3f803f80, 0x00003f80, 0x00000000, 0x00000000
.long 0x01000100, 0x03020100, 0x03020302, 0x05040504
.long 0x01000100, 0x01000100, 0x03020302, 0x05040302
.long 0x01000100, 0x01000100, 0x03020100, 0x03020302
.long 0x03020100, 0x03020302, 0x03020302, 0x05040504
.long 0x01000100, 0x03020302, 0x03020302, 0x05040302
.long 0x01000100, 0x03020100, 0x03020302, 0x03020302
.long 0x03020100, 0x03020302, 0x05040504, 0x05040504
.long 0x01000100, 0x03020302, 0x05040302, 0x05040504
.long 0x01000100, 0x03020100, 0x03020302, 0x05040504
.long 0x01000100, 0x01000100, 0x03020302, 0x05040302
.long 0x01000100, 0x01000100, 0x03020100, 0x03020302
.long 0x03020100, 0x03020302, 0x03020302, 0x05040504
.long 0x01000100, 0x03020302, 0x03020302, 0x05040302
.long 0x01000100, 0x03020100, 0x03020302, 0x03020302
.long 0x03020100, 0x03020302, 0x05040504, 0x05040504
.long 0x01000100, 0x03020302, 0x05040302, 0x05040504
.long 0x01000100, 0x03020100, 0x03020302, 0x05040504
.long 0x01000100, 0x01000100, 0x03020302, 0x05040302
.long 0x01000100, 0x01000100, 0x03020100, 0x03020302
.long 0x03020100, 0x03020302, 0x03020302, 0x05040504
.long 0x01000100, 0x03020302, 0x03020302, 0x05040302
.long 0x01000100, 0x03020100, 0x03020302, 0x03020302
.long 0x03020100, 0x03020302, 0x05040504, 0x05040504
.long 0x01000100, 0x03020302, 0x05040302, 0x05040504
.long 0x01000100, 0x03020100, 0x03020302, 0x05040504
.long 0x01000100, 0x01000100, 0x03020302, 0x05040302
.long 0x01000100, 0x01000100, 0x03020100, 0x03020302
.long 0x03020100, 0x03020302, 0x03020302, 0x05040504
.long 0x01000100, 0x03020302, 0x03020302, 0x05040302
.long 0x01000100, 0x03020100, 0x03020302, 0x03020302
.long 0x03020100, 0x03020302, 0x05040504, 0x05040504
.long 0x01000100, 0x03020302, 0x05040302, 0x05040504
.long 0x01000100, 0x03020100, 0x03020302, 0x05040504
.long 0x01000100, 0x01000100, 0x03020302, 0x05040302
.long 0x01000100, 0x01000100, 0x03020100, 0x03020302
.long 0x03020100, 0x03020302, 0x03020302, 0x05040504
.long 0x01000100, 0x03020302, 0x03020302, 0x05040302
.long 0x01000100, 0x03020100, 0x03020302, 0x03020302
.long 0x03020100, 0x03020302, 0x05040504, 0x05040504
.long 0x01000100, 0x03020302, 0x05040302, 0x05040504
.long 0x01000100, 0x03020100, 0x03020302, 0x05040504
.long 0x01000100, 0x01000100, 0x03020302, 0x05040302
.long 0x01000100, 0x01000100, 0x03020100, 0x03020302
.long 0x03020100, 0x03020302, 0x03020302, 0x05040504
.long 0x01000100, 0x03020302, 0x03020302, 0x05040302
.long 0x01000100, 0x03020100, 0x03020302, 0x03020302
.long 0x03020100, 0x03020302, 0x05040504, 0x05040504
.long 0x01000100, 0x03020302, 0x05040302, 0x05040504
.long 0x01000100, 0x03020100, 0x03020302, 0x05040504
.long 0x01000100, 0x01000100, 0x03020302, 0x05040302
.long 0x01000100, 0x01000100, 0x03020100, 0x03020302
.long 0x03020100, 0x03020302, 0x03020302, 0x05040504
.long 0x01000100, 0x03020302, 0x03020302, 0x05040302
.long 0x01000100, 0x03020100, 0x03020302, 0x03020302
.long 0x03020100, 0x03020302, 0x05040504, 0x05040504
.long 0x01000100, 0x03020302, 0x05040302, 0x05040504
.long 0x01000100, 0x03020100, 0x03020302, 0x05040504
.long 0x01000100, 0x01000100, 0x03020302, 0x05040302
.long 0x01000100, 0x01000100, 0x03020100, 0x03020302
.long 0x03020100, 0x03020302, 0x03020302, 0x05040504
.long 0x01000100, 0x03020302, 0x03020302, 0x05040302
.long 0x01000100, 0x03020100, 0x03020302, 0x03020302
.long 0x03020100, 0x03020302, 0x05040504, 0x05040504
.long 0x01000100, 0x03020302, 0x05040302, 0x05040504
.long 0x00000000, 0x00000000, 0x00000000, 0x00000000
.long 0x11f00008, 0x00040010, 0x00100020, 0x00040008
.long 0x23e00080, 0x00080020, 0x00200040, 0x00080010
.long 0x35d00088, 0x000c0030, 0x00300060, 0x000c0018
.long 0x47c00010, 0x00100040, 0x00400080, 0x00100020
.long 0x59b00018, 0x00140050, 0x005000a0, 0x00140028
.long 0x6ba00090, 0x00180060, 0x006000c0, 0x00180030
.long 0x7d900098, 0x001c0070, 0x007000e0, 0x001c0038
.long 0x00100020, 0x00200080, 0x00800100, 0x00200040
.long 0x12000028, 0x00240090, 0x00900120, 0x00240048
.long 0x23f000a0, 0x002800a0, 0x00a00140, 0x00280050
.long 0x35e000a8, 0x002c00b0, 0x00b00160, 0x002c0058
.long 0x47d00030, 0x003000c0, 0x00c00180, 0x00300060
.long 0x59c00038, 0x003400d0, 0x00d001a0, 0x00340068
.long 0x6bb000b0, 0x003800e0, 0x00e001c0, 0x00380070
.long 0x7da000b8, 0x003c00f0, 0x00f001e0, 0x003c0078
.long 0x00200100, 0x0f000100, 0x01000200, 0x00400080
.long 0x12100108, 0x0f040110, 0x01100220, 0x00440088
.long 0x24000180, 0x0f080120, 0x01200240, 0x00480090
.long 0x35f00188, 0x0f0c0130, 0x01300260, 0x004c0098
.long 0x47e00110, 0x0f100140, 0x01400280, 0x005000a0
.long 0x59d00118, 0x0f140150, 0x015002a0, 0x005400a8
.long 0x6bc00190, 0x0f180160, 0x016002c0, 0x005800b0
.long 0x7db00198, 0x0f1c0170, 0x017002e0, 0x005c00b8
.long 0x00300120, 0x0f200180, 0x01800300, 0x006000c0
.long 0x12200128, 0x0f240190, 0x01900320, 0x006400c8
.long 0x241001a0, 0x0f2801a0, 0x01a00340, 0x006800d0
.long 0x360001a8, 0x0f2c01b0, 0x01b00360, 0x006c00d8
.long 0x47f00130, 0x0f3001c0, 0x01c00380, 0x007000e0
.long 0x59e00138, 0x0f3401d0, 0x01d003a0, 0x007400e8
.long 0x6bd001b0, 0x0f3801e0, 0x01e003c0, 0x007800f0
.long 0x7dc001b8, 0x0f3c01e0, 0x01f003e0, 0x007c00f8
.long 0x00400200, 0x000011f0, 0x00080010, 0x01000100
.long 0x12300208, 0x00041200, 0x00180030, 0x01040108
.long 0x24200280, 0x00081210, 0x00280050, 0x01080110
.long 0x36100288, 0x000c1220, 0x00380070, 0x010c0118
.long 0x48000210, 0x00101230, 0x00480090, 0x01100120
.long 0x59f00218, 0x00141240, 0x005800b0, 0x01140128
.long 0x6be00290, 0x00181250, 0x006800d0, 0x01180130
.long 0x7dd00298, 0x001c1260, 0x007800f0, 0x011c0138
.long 0x00500220, 0x00201270, 0x00880110, 0x01200140
.long 0x12400228, 0x00241280, 0x00980130, 0x01240148
.long 0x243002a0, 0x00281290, 0x00a80150, 0x01280150
.long 0x362002a8, 0x002c12a0, 0x00b80170, 0x012c0158
.long 0x48100230, 0x003012b0, 0x00c80190, 0x01300160
.long 0x5a000238, 0x003412c0, 0x00d801b0, 0x01340168
.long 0x6bf002b0, 0x003812d0, 0x00e801d0, 0x01380170
.long 0x7de002b8, 0x003c12e0, 0x00f801f0, 0x013c0178
.long 0x00600300, 0x0f0012f0, 0x01080210, 0x01400180
.long 0x12500308, 0x0f041300, 0x01180230, 0x01440188
.long 0x24400380, 0x0f081310, 0x01280250, 0x01480190
.long 0x36300388, 0x0f0c1320, 0x01380270, 0x014c0198
.long 0x48200310, 0x0f101330, 0x01480290, 0x015001a0
.long 0x5a100318, 0x0f141340, 0x015802b0, 0x015401a8
.long 0x6c000390, 0x0f181350, 0x016802d0, 0x015801b0
.long 0x7df00398, 0x0f1c1360, 0x017802f0, 0x015c01b8
.long 0x00700320, 0x0f201370, 0x01880310, 0x016001c0
.long 0x12600328, 0x0f241380, 0x01980330, 0x016401c8
.long 0x245003a0, 0x0f281390, 0x01a80350, 0x016801d0
.long 0x364003a8, 0x0f2c13a0, 0x01b80370, 0x016c01d8
.long 0x48300330, 0x0f3013b0, 0x01c80390, 0x017001e0
.long 0x5a200338, 0x0f3413c0, 0x01d803b0, 0x017401e8
.long 0x6c1003b0, 0x0f3813d0, 0x01e803d0, 0x017801f0
.long 0x7e0003b8, 0x0f3c13d0, 0x01f803f0, 0x017c01f8
.long 0x00640010, 0x0aa00f64, 0x0a980458, 0x0c900450
.long 0x00680030, 0x0aa00f68, 0x0a98045c, 0x0c900454
.long 0x006c0050, 0x04600f6c, 0x04580aa0, 0x0c900a98
.long 0x00700070, 0x04640f70, 0x045c0aa0, 0x06500a98
.long 0x00740090, 0x0aa80f74, 0x0aa00460, 0x0c940458
.long 0x007800b0, 0x0aa80f78, 0x0aa00464, 0x0c94045c
.long 0x007c00d0, 0x04680f7c, 0x04600aa8, 0x06540aa0
.long 0x008000f0, 0x046c0f80, 0x04640aa8, 0x0c980aa0
.long 0x00840110, 0x0ab00f84, 0x0aa80468, 0x0c980460
.long 0x00880130, 0x0ab00f88, 0x0aa8046c, 0x0c980464
.long 0x008c0150, 0x04700f8c, 0x04680ab0, 0x0c980aa8
.long 0x00900170, 0x04740f90, 0x046c0ab0, 0x06580aa8
.long 0x00940190, 0x0ab80f94, 0x0ab00470, 0x0c9c0468
.long 0x009801b0, 0x0ab80f98, 0x0ab00474, 0x0c9c046c
.long 0x009c01d0, 0x04780f9c, 0x04700ab8, 0x065c0ab0
.long 0x00a001f0, 0x047c0fa0, 0x04740ab8, 0x0ca00ab0
.long 0x00440020, 0x0a900f44, 0x0a880448, 0x0c880440
.long 0x00480040, 0x0a900f48, 0x0a88044c, 0x0c880444
.long 0x004c0060, 0x04500f4c, 0x04480a90, 0x0c880a88
.long 0x00500080, 0x04540f50, 0x044c0a90, 0x06480a88
.long 0x005400a0, 0x0a980f54, 0x0a900450, 0x0c8c0448
.long 0x005800c0, 0x0a980f58, 0x0a900454, 0x0c8c044c
.long 0x005c00e0, 0x04580f5c, 0x04500a98, 0x064c0a90
.long 0x00600100, 0x045c0f60, 0x04540a98, 0x0c900a90
.long 0x00640120, 0x0aa00f64, 0x0a980458, 0x0c900450
.long 0x00680140, 0x0aa00f68, 0x0a98045c, 0x0c900454
.long 0x006c0160, 0x04600f6c, 0x04580aa0, 0x0c900a98
.long 0x00700180, 0x04640f70, 0x045c0aa0, 0x06500a98
.long 0x007401a0, 0x0aa80f74, 0x0aa00460, 0x0c940458
.long 0x007801c0, 0x0aa80f78, 0x0aa00464, 0x0c94045c
.long 0x007c01e0, 0x04680f7c, 0x04600aa8, 0x06540aa0
.long 0x00800200, 0x046c0f80, 0x04640aa8, 0x0c980aa0
.long 0x00240030, 0x043c0f24, 0x042c0434, 0x0c800424
.long 0x00280050, 0x0a800f28, 0x04300438, 0x0c800428
.long 0x002c0070, 0x04400f2c, 0x0434043c, 0x0c80042c
.long 0x00300090, 0x04440f30, 0x04380a80, 0x06400430
.long 0x003400b0, 0x0a880f34, 0x043c0440, 0x0c840434
.long 0x003800d0, 0x0a880f38, 0x0a800444, 0x0c840438
.long 0x003c00f0, 0x04480f3c, 0x04400a88, 0x0644043c
.long 0x00400110, 0x044c0f40, 0x04440a88, 0x0c880a80
.long 0x00440130, 0x0a900f44, 0x0a880448, 0x0c880440
.long 0x00480150, 0x0a900f48, 0x0a88044c, 0x0c880444
.long 0x004c0170, 0x04500f4c, 0x04480a90, 0x0c880a88
.long 0x00500190, 0x04540f50, 0x044c0a90, 0x06480a88
.long 0x005401b0, 0x0a980f54, 0x0a900450, 0x0c8c0448
.long 0x005801d0, 0x0a980f58, 0x0a900454, 0x0c8c044c
.long 0x005c01f0, 0x04580f5c, 0x04500a98, 0x064c0a90
.long 0x00600210, 0x045c0f60, 0x04540a98, 0x0c900a90
.long 0x00040040, 0x041c0f04, 0x040c0414, 0x0c700404
.long 0x00080060, 0x04200f08, 0x04100418, 0x0c700408
.long 0x000c0080, 0x04240f0c, 0x0414041c, 0x0630040c
.long 0x001000a0, 0x04280f10, 0x04180420, 0x06340410
.long 0x001400c0, 0x042c0f14, 0x041c0424, 0x0c780414
.long 0x001800e0, 0x04300f18, 0x04200428, 0x0c780418
.long 0x001c0100, 0x04340f1c, 0x0424042c, 0x0638041c
.long 0x00200120, 0x04380f20, 0x04280430, 0x063c0420
.long 0x00240140, 0x043c0f24, 0x042c0434, 0x0c800424
.long 0x00280160, 0x0a800f28, 0x04300438, 0x0c800428
.long 0x002c0180, 0x04400f2c, 0x0434043c, 0x0c80042c
.long 0x003001a0, 0x04440f30, 0x04380a80, 0x06400430
.long 0x003401c0, 0x0a880f34, 0x043c0440, 0x0c840434
.long 0x003801e0, 0x0a880f38, 0x0a800444, 0x0c840438
.long 0x003c0200, 0x04480f3c, 0x04400a88, 0x0644043c
.long 0x00400220, 0x044c0f40, 0x04440a88, 0x0c880a80
.long 0x0c8c064c, 0x00380c88, 0x00380038, 0x06640038
.long 0x0c8c0c90, 0x00380648, 0x00380038, 0x06640038
.long 0x064c0c90, 0x00380c8c, 0x00380038, 0x06640038
.long 0x0c900c90, 0x00380c8c, 0x00380038, 0x06680038
.long 0x0c900c90, 0x0038064c, 0x00380038, 0x06680038
.long 0x0c900650, 0x00380c90, 0x00380038, 0x06680038
.long 0x0c900c94, 0x00380c90, 0x00380038, 0x066c0038
.long 0x06500c94, 0x00380c90, 0x00380038, 0x066c0038
.long 0x0c940654, 0x00380c90, 0x00380038, 0x066c0038
.long 0x0c940c98, 0x00380650, 0x00380038, 0x066c0038
.long 0x06540c98, 0x00380c94, 0x00380038, 0x066c0038
.long 0x0c980c98, 0x00380c94, 0x00380038, 0x06700038
.long 0x0c980c98, 0x00380654, 0x00380038, 0x06700038
.long 0x0c980658, 0x00380c98, 0x00380038, 0x06700038
.long 0x0c980c9c, 0x00380c98, 0x00380038, 0x06740038
.long 0x06580c9c, 0x00380c98, 0x00380038, 0x06740038
.long 0x0c840644, 0x00380c80, 0x0e800038, 0x065c0e80
.long 0x0c840c88, 0x00380640, 0x00000038, 0x065c0e80
.long 0x06440c88, 0x00380c84, 0x00380038, 0x065c0e80
.long 0x0c880c88, 0x00380c84, 0x00380038, 0x06600000
.long 0x0c880c88, 0x00380644, 0x00380038, 0x06600038
.long 0x0c880648, 0x00380c88, 0x00380038, 0x06600038
.long 0x0c880c8c, 0x00380c88, 0x00380038, 0x06640038
.long 0x06480c8c, 0x00380c88, 0x00380038, 0x06640038
.long 0x0c8c064c, 0x00380c88, 0x00380038, 0x06640038
.long 0x0c8c0c90, 0x00380648, 0x00380038, 0x06640038
.long 0x064c0c90, 0x00380c8c, 0x00380038, 0x06640038
.long 0x0c900c90, 0x00380c8c, 0x00380038, 0x06680038
.long 0x0c900c90, 0x0038064c, 0x00380038, 0x06680038
.long 0x0c900650, 0x00380c90, 0x00380038, 0x06680038
.long 0x0c900c94, 0x00380c90, 0x00380038, 0x066c0038
.long 0x06500c94, 0x00380c90, 0x00380038, 0x066c0038
.long 0x0c780638, 0x0e800630, 0x0e7c083c, 0x06540e78
.long 0x0c78063c, 0x0e800634, 0x0e7c0e80, 0x06540838
.long 0x06380c80, 0x0e800c78, 0x083c0e80, 0x06540e7c
.long 0x063c0c80, 0x0e800c78, 0x0e800e80, 0x06580e7c
.long 0x0c800c80, 0x0e800638, 0x0e800e80, 0x0658083c
.long 0x0c800640, 0x0000063c, 0x0e800e80, 0x06580e80
.long 0x0c800c84, 0x00380c80, 0x0e800e80, 0x065c0e80
.long 0x06400c84, 0x00380c80, 0x0e800000, 0x065c0e80
.long 0x0c840644, 0x00380c80, 0x0e800038, 0x065c0e80
.long 0x0c840c88, 0x00380640, 0x00000038, 0x065c0e80
.long 0x06440c88, 0x00380c84, 0x00380038, 0x065c0e80
.long 0x0c880c88, 0x00380c84, 0x00380038, 0x06600000
.long 0x0c880c88, 0x00380644, 0x00380038, 0x06600038
.long 0x0c880648, 0x00380c88, 0x00380038, 0x06600038
.long 0x0c880c8c, 0x00380c88, 0x00380038, 0x06640038
.long 0x06480c8c, 0x00380c88, 0x00380038, 0x06640038
.long 0x0c680628, 0x0e780620, 0x0e740834, 0x064c0e70
.long 0x0c68062c, 0x0e780624, 0x0e740e78, 0x064c0830
.long 0x06280c70, 0x0e780c68, 0x08340e78, 0x064c0e74
.long 0x062c0c70, 0x08380c68, 0x0e780e78, 0x06500e74
.long 0x0c700630, 0x0e7c0628, 0x0e780e78, 0x06500834
.long 0x0c700634, 0x0e7c062c, 0x0e780838, 0x06500e78
.long 0x06300c78, 0x083c0c70, 0x0e780e7c, 0x06540e78
.long 0x06340c78, 0x0e800c70, 0x08380e7c, 0x06540e78
.long 0x0c780638, 0x0e800630, 0x0e7c083c, 0x06540e78
.long 0x0c78063c, 0x0e800634, 0x0e7c0e80, 0x06540838
.long 0x06380c80, 0x0e800c78, 0x083c0e80, 0x06540e7c
.long 0x063c0c80, 0x0e800c78, 0x0e800e80, 0x06580e7c
.long 0x0c800c80, 0x0e800638, 0x0e800e80, 0x0658083c
.long 0x0c800640, 0x0000063c, 0x0e800e80, 0x06580e80
.long 0x0c800c84, 0x00380c80, 0x0e800e80, 0x065c0e80
.long 0x06400c84, 0x00380c80, 0x0e800000, 0x065c0e80
.long 0x0ae01564, 0x0ad80498, 0x08440490, 0x00380038
.long 0x0ae01564, 0x0ad8049c, 0x084c0494, 0x00380844
.long 0x04a01564, 0x04980ae0, 0x08540ad8, 0x0844084c
.long 0x04a41568, 0x049c0ae0, 0x085c0ad8, 0x084c0854
.long 0x0ae81568, 0x0ae004a0, 0x08640498, 0x0854085c
.long 0x0ae81568, 0x0ae004a4, 0x086c049c, 0x085c0864
.long 0x04a8156c, 0x04a00ae8, 0x08740ae0, 0x0864086c
.long 0x04ac156c, 0x04a40ae8, 0x087c0ae0, 0x086c0874
.long 0x0af0156c, 0x0ae804a8, 0x088404a0, 0x0874087c
.long 0x0af0156c, 0x0ae804ac, 0x088c04a4, 0x087c0884
.long 0x04b0156c, 0x04a80af0, 0x08940ae8, 0x0884088c
.long 0x04b41570, 0x04ac0af0, 0x089c0ae8, 0x088c0894
.long 0x0af81570, 0x0af004b0, 0x08a404a8, 0x0894089c
.long 0x0af81570, 0x0af004b4, 0x08ac04ac, 0x089c08a4
.long 0x04b81574, 0x04b00af8, 0x08b40af0, 0x08a408ac
.long 0x04bc1574, 0x04b40af8, 0x08bc0af0, 0x08ac08b4
.long 0x0ad0155c, 0x0ac80488, 0x00380480, 0x00380038
.long 0x0ad0155c, 0x0ac8048c, 0x00380484, 0x00380038
.long 0x0490155c, 0x04880ad0, 0x00380ac8, 0x00380038
.long 0x04941560, 0x048c0ad0, 0x00380ac8, 0x00380038
.long 0x0ad81560, 0x0ad00490, 0x08440488, 0x00380038
.long 0x0ad81560, 0x0ad00494, 0x084c048c, 0x00380844
.long 0x04981564, 0x04900ad8, 0x08540ad0, 0x0844084c
.long 0x049c1564, 0x04940ad8, 0x085c0ad0, 0x084c0854
.long 0x0ae01564, 0x0ad80498, 0x08640490, 0x0854085c
.long 0x0ae01564, 0x0ad8049c, 0x086c0494, 0x085c0864
.long 0x04a01564, 0x04980ae0, 0x08740ad8, 0x0864086c
.long 0x04a41568, 0x049c0ae0, 0x087c0ad8, 0x086c0874
.long 0x0ae81568, 0x0ae004a0, 0x08840498, 0x0874087c
.long 0x0ae81568, 0x0ae004a4, 0x088c049c, 0x087c0884
.long 0x04a8156c, 0x04a00ae8, 0x08940ae0, 0x0884088c
.long 0x04ac156c, 0x04a40ae8, 0x089c0ae0, 0x088c0894
.long 0x0ac01554, 0x0ab80478, 0x00380470, 0x00380038
.long 0x0ac01554, 0x0ab8047c, 0x00380474, 0x00380038
.long 0x04801554, 0x04780ac0, 0x00380ab8, 0x00380038
.long 0x04841558, 0x047c0ac0, 0x00380ab8, 0x00380038
.long 0x0ac81558, 0x0ac00480, 0x00380478, 0x00380038
.long 0x0ac81558, 0x0ac00484, 0x0038047c, 0x00380038
.long 0x0488155c, 0x04800ac8, 0x00380ac0, 0x00380038
.long 0x048c155c, 0x04840ac8, 0x00380ac0, 0x00380038
.long 0x0ad0155c, 0x0ac80488, 0x08440480, 0x00380038
.long 0x0ad0155c, 0x0ac8048c, 0x084c0484, 0x00380844
.long 0x0490155c, 0x04880ad0, 0x08540ac8, 0x0844084c
.long 0x04941560, 0x048c0ad0, 0x085c0ac8, 0x084c0854
.long 0x0ad81560, 0x0ad00490, 0x08640488, 0x0854085c
.long 0x0ad81560, 0x0ad00494, 0x086c048c, 0x085c0864
.long 0x04981564, 0x04900ad8, 0x08740ad0, 0x0864086c
.long 0x049c1564, 0x04940ad8, 0x087c0ad0, 0x086c0874
.long 0x0ab0154c, 0x0aa80468, 0x00380460, 0x00380038
.long 0x0ab0154c, 0x0aa8046c, 0x00380464, 0x00380038
.long 0x0470154c, 0x04680ab0, 0x00380aa8, 0x00380038
.long 0x04741550, 0x046c0ab0, 0x00380aa8, 0x00380038
.long 0x0ab81550, 0x0ab00470, 0x00380468, 0x00380038
.long 0x0ab81550, 0x0ab00474, 0x0038046c, 0x00380038
.long 0x04781554, 0x04700ab8, 0x00380ab0, 0x00380038
.long 0x047c1554, 0x04740ab8, 0x00380ab0, 0x00380038
.long 0x0ac01554, 0x0ab80478, 0x00380470, 0x00380038
.long 0x0ac01554, 0x0ab8047c, 0x00380474, 0x00380038
.long 0x04801554, 0x04780ac0, 0x00380ab8, 0x00380038
.long 0x04841558, 0x047c0ac0, 0x00380ab8, 0x00380038
.long 0x0ac81558, 0x0ac00480, 0x08440478, 0x00380038
.long 0x0ac81558, 0x0ac00484, 0x084c047c, 0x00380844
.long 0x0488155c, 0x04800ac8, 0x08540ac0, 0x0844084c
.long 0x048c155c, 0x04840ac8, 0x085c0ac0, 0x084c0854
.long 0x08ac0038, 0x000017ac, 0x00000000, 0x00000000
.long 0x08b40038, 0x002017b4, 0x00000000, 0x00000000
.long 0x08bc0038, 0x004017bc, 0x00000000, 0x00000000
.long 0x08c40844, 0x006017c4, 0x00000000, 0x00000000
.long 0x08cc084c, 0x008817cc, 0x00001010, 0x00000000
.long 0x08d40854, 0x00a817d4, 0x00001010, 0x00000000
.long 0x08dc085c, 0x00c817dc, 0x00001010, 0x00000000
.long 0x08e40864, 0x00e817e4, 0x00001010, 0x00000000
.long 0x08ec086c, 0x011017ec, 0x00002020, 0x00000000
.long 0x08f40874, 0x013017f4, 0x00002020, 0x00000000
.long 0x08fc087c, 0x015017fc, 0x00002020, 0x00000000
.long 0x09040884, 0x01701804, 0x00002020, 0x00000000
.long 0x090c088c, 0x0198180c, 0x00003030, 0x00000000
.long 0x09140894, 0x01b81814, 0x00003030, 0x00000000
.long 0x091c089c, 0x01d8181c, 0x00003030, 0x00000000
.long 0x092408a4, 0x01f81824, 0x00003030, 0x00000000
.long 0x088c0038, 0x0008178c, 0x00000020, 0x00000000
.long 0x08940038, 0x00281794, 0x00000020, 0x00000000
.long 0x089c0038, 0x0048179c, 0x00000020, 0x00000000
.long 0x08a40038, 0x006817a4, 0x00000020, 0x00000000
.long 0x08ac0038, 0x008017ac, 0x00001030, 0x00000000
.long 0x08b40038, 0x00a017b4, 0x00001030, 0x00000000
.long 0x08bc0038, 0x00c017bc, 0x00001030, 0x00000000
.long 0x08c40844, 0x00e017c4, 0x00001030, 0x00000000
.long 0x08cc084c, 0x011817cc, 0x00002040, 0x00000000
.long 0x08d40854, 0x013817d4, 0x00002040, 0x00000000
.long 0x08dc085c, 0x015817dc, 0x00002040, 0x00000000
.long 0x08e40864, 0x017817e4, 0x00002040, 0x00000000
.long 0x08ec086c, 0x019017ec, 0x00003050, 0x00000000
.long 0x08f40874, 0x01b017f4, 0x00003050, 0x00000000
.long 0x08fc087c, 0x01d017fc, 0x00003050, 0x00000000
.long 0x09040884, 0x01f01804, 0x00003050, 0x00000000
.long 0x086c0038, 0x0010176c, 0x00000040, 0x00000000
.long 0x08740038, 0x00301774, 0x00000040, 0x00000000
.long 0x087c0038, 0x0050177c, 0x00000040, 0x00000000
.long 0x08840038, 0x00701784, 0x00000040, 0x00000000
.long 0x088c0038, 0x0098178c, 0x00001050, 0x00000000
.long 0x08940038, 0x00b81794, 0x00001050, 0x00000000
.long 0x089c0038, 0x00d8179c, 0x00001050, 0x00000000
.long 0x08a40038, 0x00f817a4, 0x00001050, 0x00000000
.long 0x08ac0038, 0x010017ac, 0x00002060, 0x00000000
.long 0x08b40038, 0x012017b4, 0x00002060, 0x00000000
.long 0x08bc0038, 0x014017bc, 0x00002060, 0x00000000
.long 0x08c40844, 0x016017c4, 0x00002060, 0x00000000
.long 0x08cc084c, 0x018817cc, 0x00003070, 0x00000000
.long 0x08d40854, 0x01a817d4, 0x00003070, 0x00000000
.long 0x08dc085c, 0x01c817dc, 0x00003070, 0x00000000
.long 0x08e40864, 0x01e817e4, 0x00003070, 0x00000000
.long 0x084c0038, 0x0018174c, 0x00000060, 0x00000000
.long 0x08540038, 0x00381754, 0x00000060, 0x00000000
.long 0x085c0038, 0x0058175c, 0x00000060, 0x00000000
.long 0x08640038, 0x00781764, 0x00000060, 0x00000000
.long 0x086c0038, 0x0090176c, 0x00001070, 0x00000000
.long 0x08740038, 0x00b01774, 0x00001070, 0x00000000
.long 0x087c0038, 0x00d0177c, 0x00001070, 0x00000000
.long 0x08840038, 0x00f01784, 0x00001070, 0x00000000
.long 0x088c0038, 0x0108178c, 0x00002080, 0x00000000
.long 0x08940038, 0x01281794, 0x00002080, 0x00000000
.long 0x089c0038, 0x0148179c, 0x00002080, 0x00000000
.long 0x08a40038, 0x016817a4, 0x00002080, 0x00000000
.long 0x08ac0038, 0x018017ac, 0x00003090, 0x00000000
.long 0x08b40038, 0x01a017b4, 0x00003090, 0x00000000
.long 0x08bc0038, 0x01c017bc, 0x00003090, 0x00000000
.long 0x08c40844, 0x01e017c4, 0x00003090, 0x00000000
.section .rodata,"a"
.p2align 6
.amdhsa_kernel concat_heads__linear_kernel_hedgehog__ssm_conv_s4d__prompt_kernel
  .amdhsa_next_free_vgpr 512
  .amdhsa_next_free_sgpr 102
  .amdhsa_accum_offset 256
  .amdhsa_group_segment_fixed_size 0
  .amdhsa_kernarg_size 112
  .amdhsa_user_sgpr_count 2
  .amdhsa_user_sgpr_kernarg_segment_ptr 1
  .amdhsa_system_sgpr_workgroup_id_x 1
.end_amdhsa_kernel
```
